```python
import torch

def _softmax(x, axis=-1):
    return torch.softmax(x, dim=axis)
def _gelu(x):
    return torch.nn.functional.gelu(x, approximate="tanh")
def _silu(x):
    return torch.nn.functional.silu(x)
def _sigmoid(x):
    return torch.sigmoid(x)
def _layernorm(x, axis=-1, eps=1e-5):
    m = x.mean(dim=axis, keepdim=True)
    v = x.var(dim=axis, keepdim=True, unbiased=False)
    return (x - m) / torch.sqrt(v + eps)
def _scatter_add(tgt, idx, src, axis=0):
    return tgt.clone().index_add_(axis, idx, src)
def _segment_sum(src, seg, n):
    out = torch.zeros((n,) + src.shape[1:], dtype=src.dtype)
    return out.index_add_(0, seg, src)
def _pad(x, pw):
    flat = tuple(v for pair in reversed(pw) for v in pair)
    return torch.nn.functional.pad(x, flat)

kernel_name = 'parallel_sum__sliding_block__glu_gated_reglu__prompt'

def setup_inputs():

    _w = (lambda a: (lambda t: t.to(torch.bfloat16) if t.is_floating_point() else t)(torch.as_tensor(a)))
    def _A_setup():
        B, S, D = 1, 2048, 1024
        return {
            "x": _w((lambda *s: torch.randn(*s, dtype=torch.bfloat16) * 0.05)(B, S, D)),
            "wqkv": _w((lambda *s: torch.randn(*s, dtype=torch.bfloat16) * 0.05)(D, 3 * D)),
            "wo": _w((lambda *s: torch.randn(*s, dtype=torch.bfloat16) * 0.05)(D, D)),
        }
    _A_in = _A_setup()

    def _B_setup():
        B, S, D, F = 1, 2048, 1024, 3584
        return {
            "x": _w((lambda *s: torch.randn(*s, dtype=torch.bfloat16) * 0.05)(B, S, D)),
            "W_gate": _w((lambda *s: torch.randn(*s, dtype=torch.bfloat16) * 0.8)(D, F) * (2.0 / D) ** 0.5),
            "W_up": _w((lambda *s: torch.randn(*s, dtype=torch.bfloat16) * 0.8)(D, F) * (2.0 / D) ** 0.5),
            "W_down": _w((lambda *s: torch.randn(*s, dtype=torch.bfloat16) * 0.8)(F, D) * (1.0 / F) ** 0.5),
        }
    _B_in = _B_setup()

    return {
        "A_x": _A_in["x"],
        "A_wqkv": _A_in["wqkv"],
        "A_wo": _A_in["wo"],
        "B_x": _B_in["x"],
        "B_W_gate": _B_in["W_gate"],
        "B_W_up": _B_in["W_up"],
        "B_W_down": _B_in["W_down"],
    }

def reference(A_x, A_wqkv, A_wo, B_x, B_W_gate, B_W_up, B_W_down):
    def _A_ref(x, wqkv, wo):
        B, S, D = x.shape
        H = 32; Dh = D // H; W = 256
        qkv = (lambda x, *d: x.permute(*d))((x @ wqkv).reshape(B, S, 3, H, Dh), 2, 0, 3, 1, 4)
        q, k, v = qkv[0], qkv[1], qkv[2]
        scores = torch.einsum("bhqd,bhkd->bhqk", q, k) * (Dh ** -0.5)
        idx = torch.arange(S)
        mask = (idx[:, None] - idx[None, :] >= 0) & (idx[:, None] - idx[None, :] < W)
        scores = torch.where(mask[None, None], scores, -1e9)
        p = _softmax(scores, axis=-1)
        o = torch.einsum("bhqk,bhkd->bhqd", p, v)
        return (lambda x, *d: x.permute(*d))(o, 0, 2, 1, 3).reshape(B, S, D) @ wo

    def _B_ref(x, W_gate, W_up, W_down):
        gate = torch.einsum("bsd,df->bsf", x, W_gate)
        up = torch.einsum("bsd,df->bsf", x, W_up)
        gate = gate * (lambda x, dt: x.to(dt))(gate > 0, gate.dtype)
        h = gate * up
        return torch.einsum("bsf,fd->bsd", h, W_down)

    x = A_x
    xn = _layernorm(x, axis=-1)
    return x + _A_ref(xn, A_wqkv, A_wo) + _B_ref(xn, B_W_gate, B_W_up, B_W_down)
```

```asm
; @launch kernel=ln_kernel grid=(672,1,1) block=(256,1,1) lds=0
; @launch kernel=gemm1_kernel grid=(256,1,1) block=(512,1,1) lds=147456
; @launch kernel=attn_kernel grid=(1096,1,1) block=(256,1,1) lds=40960
; @launch kernel=gemm2_kernel grid=(256,1,1) block=(256,1,1) lds=98304
.amdgcn_target "amdgcn-amd-amdhsa--gfx950"
.text
.globl ln_kernel
.p2align 8
.type ln_kernel,@function
ln_kernel:
    s_cmp_ge_u32 s2, 512
    s_cbranch_scc1 LN_pf
    s_load_dwordx2 s[4:5], s[0:1], 0
    s_load_dwordx2 s[6:7], s[0:1], 72
    v_lshrrev_b32 v1, 6, v0
    v_and_b32 v2, 63, v0
    s_lshl_b32 s3, s2, 2
    v_add_u32 v1, s3, v1
    v_lshlrev_b32 v1, 11, v1
    v_lshlrev_b32 v2, 5, v2
    v_add_u32 v1, v1, v2
    s_waitcnt lgkmcnt(0)
    s_mov_b32 s8, s4
    s_mov_b32 s9, s5
    s_mov_b32 s10, 4194304
    s_mov_b32 s11, 0x00020000
    s_mov_b32 s12, s6
    s_mov_b32 s13, s7
    s_mov_b32 s14, 4194304
    s_mov_b32 s15, 0x00020000
    buffer_load_dwordx4 v[4:7], v1, s[8:11], 0 offen
    buffer_load_dwordx4 v[8:11], v1, s[8:11], 0 offen offset:16
    s_waitcnt vmcnt(0)
    v_lshlrev_b32 v16, 16, v4
    v_and_b32 v17, 0xffff0000, v4
    v_lshlrev_b32 v18, 16, v5
    v_and_b32 v19, 0xffff0000, v5
    v_lshlrev_b32 v20, 16, v6
    v_and_b32 v21, 0xffff0000, v6
    v_lshlrev_b32 v22, 16, v7
    v_and_b32 v23, 0xffff0000, v7
    v_lshlrev_b32 v24, 16, v8
    v_and_b32 v25, 0xffff0000, v8
    v_lshlrev_b32 v26, 16, v9
    v_and_b32 v27, 0xffff0000, v9
    v_lshlrev_b32 v28, 16, v10
    v_and_b32 v29, 0xffff0000, v10
    v_lshlrev_b32 v30, 16, v11
    v_and_b32 v31, 0xffff0000, v11
    v_add_f32 v12, v16, v17
    v_add_f32 v12, v12, v18
    v_add_f32 v12, v12, v19
    v_add_f32 v12, v12, v20
    v_add_f32 v12, v12, v21
    v_add_f32 v12, v12, v22
    v_add_f32 v12, v12, v23
    v_add_f32 v12, v12, v24
    v_add_f32 v12, v12, v25
    v_add_f32 v12, v12, v26
    v_add_f32 v12, v12, v27
    v_add_f32 v12, v12, v28
    v_add_f32 v12, v12, v29
    v_add_f32 v12, v12, v30
    v_add_f32 v12, v12, v31
    ds_swizzle_b32 v13, v12 offset:1055
    s_waitcnt lgkmcnt(0)
    v_add_f32 v12, v12, v13
    ds_swizzle_b32 v13, v12 offset:2079
    s_waitcnt lgkmcnt(0)
    v_add_f32 v12, v12, v13
    ds_swizzle_b32 v13, v12 offset:4127
    s_waitcnt lgkmcnt(0)
    v_add_f32 v12, v12, v13
    ds_swizzle_b32 v13, v12 offset:8223
    s_waitcnt lgkmcnt(0)
    v_add_f32 v12, v12, v13
    ds_swizzle_b32 v13, v12 offset:16415
    s_waitcnt lgkmcnt(0)
    v_add_f32 v12, v12, v13
    s_nop 0
    v_readlane_b32 s20, v12, 32
    s_nop 1
    v_add_f32 v12, s20, v12
    s_nop 0
    v_readlane_b32 s20, v12, 0
    s_nop 3
    v_mov_b32 v14, 0x3a800000
    v_mul_f32 v14, s20, v14
    v_mov_b32 v12, 0
    v_sub_f32 v13, v16, v14
    v_fmac_f32 v12, v13, v13
    v_sub_f32 v13, v17, v14
    v_fmac_f32 v12, v13, v13
    v_sub_f32 v13, v18, v14
    v_fmac_f32 v12, v13, v13
    v_sub_f32 v13, v19, v14
    v_fmac_f32 v12, v13, v13
    v_sub_f32 v13, v20, v14
    v_fmac_f32 v12, v13, v13
    v_sub_f32 v13, v21, v14
    v_fmac_f32 v12, v13, v13
    v_sub_f32 v13, v22, v14
    v_fmac_f32 v12, v13, v13
    v_sub_f32 v13, v23, v14
    v_fmac_f32 v12, v13, v13
    v_sub_f32 v13, v24, v14
    v_fmac_f32 v12, v13, v13
    v_sub_f32 v13, v25, v14
    v_fmac_f32 v12, v13, v13
    v_sub_f32 v13, v26, v14
    v_fmac_f32 v12, v13, v13
    v_sub_f32 v13, v27, v14
    v_fmac_f32 v12, v13, v13
    v_sub_f32 v13, v28, v14
    v_fmac_f32 v12, v13, v13
    v_sub_f32 v13, v29, v14
    v_fmac_f32 v12, v13, v13
    v_sub_f32 v13, v30, v14
    v_fmac_f32 v12, v13, v13
    v_sub_f32 v13, v31, v14
    v_fmac_f32 v12, v13, v13
    ds_swizzle_b32 v13, v12 offset:1055
    s_waitcnt lgkmcnt(0)
    v_add_f32 v12, v12, v13
    ds_swizzle_b32 v13, v12 offset:2079
    s_waitcnt lgkmcnt(0)
    v_add_f32 v12, v12, v13
    ds_swizzle_b32 v13, v12 offset:4127
    s_waitcnt lgkmcnt(0)
    v_add_f32 v12, v12, v13
    ds_swizzle_b32 v13, v12 offset:8223
    s_waitcnt lgkmcnt(0)
    v_add_f32 v12, v12, v13
    ds_swizzle_b32 v13, v12 offset:16415
    s_waitcnt lgkmcnt(0)
    v_add_f32 v12, v12, v13
    s_nop 0
    v_readlane_b32 s21, v12, 32
    s_nop 1
    v_add_f32 v12, s21, v12
    s_nop 0
    v_readlane_b32 s21, v12, 0
    s_nop 3
    v_mov_b32 v15, 0x3a800000
    v_mul_f32 v15, s21, v15
    v_cvt_pk_bf16_f32 v12, v14, v15
    v_lshlrev_b32 v14, 16, v12
    v_and_b32 v15, 0xffff0000, v12
    v_mov_b32 v13, 0x3727c5ac
    v_add_f32 v15, v15, v13
    v_cvt_pk_bf16_f32 v15, v15, v15
    v_lshlrev_b32 v15, 16, v15
    v_sqrt_f32 v15, v15
    s_nop 0
    v_cvt_pk_bf16_f32 v15, v15, v15
    v_lshlrev_b32 v15, 16, v15
    v_rcp_f32 v15, v15
    s_nop 0
    v_sub_f32 v16, v16, v14
    v_sub_f32 v17, v17, v14
    v_cvt_pk_bf16_f32 v12, v16, v17
    v_lshlrev_b32 v16, 16, v12
    v_and_b32 v17, 0xffff0000, v12
    v_mul_f32 v16, v16, v15
    v_mul_f32 v17, v17, v15
    v_cvt_pk_bf16_f32 v4, v16, v17
    v_sub_f32 v18, v18, v14
    v_sub_f32 v19, v19, v14
    v_cvt_pk_bf16_f32 v12, v18, v19
    v_lshlrev_b32 v18, 16, v12
    v_and_b32 v19, 0xffff0000, v12
    v_mul_f32 v18, v18, v15
    v_mul_f32 v19, v19, v15
    v_cvt_pk_bf16_f32 v5, v18, v19
    v_sub_f32 v20, v20, v14
    v_sub_f32 v21, v21, v14
    v_cvt_pk_bf16_f32 v12, v20, v21
    v_lshlrev_b32 v20, 16, v12
    v_and_b32 v21, 0xffff0000, v12
    v_mul_f32 v20, v20, v15
    v_mul_f32 v21, v21, v15
    v_cvt_pk_bf16_f32 v6, v20, v21
    v_sub_f32 v22, v22, v14
    v_sub_f32 v23, v23, v14
    v_cvt_pk_bf16_f32 v12, v22, v23
    v_lshlrev_b32 v22, 16, v12
    v_and_b32 v23, 0xffff0000, v12
    v_mul_f32 v22, v22, v15
    v_mul_f32 v23, v23, v15
    v_cvt_pk_bf16_f32 v7, v22, v23
    v_sub_f32 v24, v24, v14
    v_sub_f32 v25, v25, v14
    v_cvt_pk_bf16_f32 v12, v24, v25
    v_lshlrev_b32 v24, 16, v12
    v_and_b32 v25, 0xffff0000, v12
    v_mul_f32 v24, v24, v15
    v_mul_f32 v25, v25, v15
    v_cvt_pk_bf16_f32 v8, v24, v25
    v_sub_f32 v26, v26, v14
    v_sub_f32 v27, v27, v14
    v_cvt_pk_bf16_f32 v12, v26, v27
    v_lshlrev_b32 v26, 16, v12
    v_and_b32 v27, 0xffff0000, v12
    v_mul_f32 v26, v26, v15
    v_mul_f32 v27, v27, v15
    v_cvt_pk_bf16_f32 v9, v26, v27
    v_sub_f32 v28, v28, v14
    v_sub_f32 v29, v29, v14
    v_cvt_pk_bf16_f32 v12, v28, v29
    v_lshlrev_b32 v28, 16, v12
    v_and_b32 v29, 0xffff0000, v12
    v_mul_f32 v28, v28, v15
    v_mul_f32 v29, v29, v15
    v_cvt_pk_bf16_f32 v10, v28, v29
    v_sub_f32 v30, v30, v14
    v_sub_f32 v31, v31, v14
    v_cvt_pk_bf16_f32 v12, v30, v31
    v_lshlrev_b32 v30, 16, v12
    v_and_b32 v31, 0xffff0000, v12
    v_mul_f32 v30, v30, v15
    v_mul_f32 v31, v31, v15
    v_cvt_pk_bf16_f32 v11, v30, v31
    buffer_store_dwordx4 v[4:7], v1, s[12:15], 0 offen
    buffer_store_dwordx4 v[8:11], v1, s[12:15], 0 offen offset:16
    s_branch LN_done
LN_pf:
    s_sub_u32 s3, s2, 512
    s_cmp_ge_u32 s3, 160
    s_cbranch_scc1 LN_done
    s_mov_b32 s4, 8
    s_mov_b32 s5, 0
    s_cmp_ge_u32 s3, 48
    s_cselect_b32 s4, 32, s4
    s_cselect_b32 s5, 48, s5
    s_cmp_ge_u32 s3, 104
    s_cselect_b32 s4, 40, s4
    s_cselect_b32 s5, 104, s5
    s_sub_u32 s3, s3, s5
    s_load_dwordx2 s[6:7], s[0:1], s4
    s_lshl_b32 s3, s3, 17
    s_waitcnt lgkmcnt(0)
    s_mov_b32 s8, s6
    s_mov_b32 s9, s7
    s_mov_b32 s10, 7340032
    s_mov_b32 s11, 0x00020000
    v_lshlrev_b32 v1, 4, v0
    v_add_u32 v1, s3, v1
    buffer_load_dwordx4 v[4:7], v1, s[8:11], 0 offen
    v_add_u32 v1, 4096, v1
    buffer_load_dwordx4 v[8:11], v1, s[8:11], 0 offen
    v_add_u32 v1, 4096, v1
    buffer_load_dwordx4 v[12:15], v1, s[8:11], 0 offen
    v_add_u32 v1, 4096, v1
    buffer_load_dwordx4 v[16:19], v1, s[8:11], 0 offen
    v_add_u32 v1, 4096, v1
    buffer_load_dwordx4 v[4:7], v1, s[8:11], 0 offen
    v_add_u32 v1, 4096, v1
    buffer_load_dwordx4 v[8:11], v1, s[8:11], 0 offen
    v_add_u32 v1, 4096, v1
    buffer_load_dwordx4 v[12:15], v1, s[8:11], 0 offen
    v_add_u32 v1, 4096, v1
    buffer_load_dwordx4 v[16:19], v1, s[8:11], 0 offen
    v_add_u32 v1, 4096, v1
    buffer_load_dwordx4 v[4:7], v1, s[8:11], 0 offen
    v_add_u32 v1, 4096, v1
    buffer_load_dwordx4 v[8:11], v1, s[8:11], 0 offen
    v_add_u32 v1, 4096, v1
    buffer_load_dwordx4 v[12:15], v1, s[8:11], 0 offen
    v_add_u32 v1, 4096, v1
    buffer_load_dwordx4 v[16:19], v1, s[8:11], 0 offen
    v_add_u32 v1, 4096, v1
    buffer_load_dwordx4 v[4:7], v1, s[8:11], 0 offen
    v_add_u32 v1, 4096, v1
    buffer_load_dwordx4 v[8:11], v1, s[8:11], 0 offen
    v_add_u32 v1, 4096, v1
    buffer_load_dwordx4 v[12:15], v1, s[8:11], 0 offen
    v_add_u32 v1, 4096, v1
    buffer_load_dwordx4 v[16:19], v1, s[8:11], 0 offen
    v_add_u32 v1, 4096, v1
    buffer_load_dwordx4 v[4:7], v1, s[8:11], 0 offen
    v_add_u32 v1, 4096, v1
    buffer_load_dwordx4 v[8:11], v1, s[8:11], 0 offen
    v_add_u32 v1, 4096, v1
    buffer_load_dwordx4 v[12:15], v1, s[8:11], 0 offen
    v_add_u32 v1, 4096, v1
    buffer_load_dwordx4 v[16:19], v1, s[8:11], 0 offen
    v_add_u32 v1, 4096, v1
    buffer_load_dwordx4 v[4:7], v1, s[8:11], 0 offen
    v_add_u32 v1, 4096, v1
    buffer_load_dwordx4 v[8:11], v1, s[8:11], 0 offen
    v_add_u32 v1, 4096, v1
    buffer_load_dwordx4 v[12:15], v1, s[8:11], 0 offen
    v_add_u32 v1, 4096, v1
    buffer_load_dwordx4 v[16:19], v1, s[8:11], 0 offen
    v_add_u32 v1, 4096, v1
    buffer_load_dwordx4 v[4:7], v1, s[8:11], 0 offen
    v_add_u32 v1, 4096, v1
    buffer_load_dwordx4 v[8:11], v1, s[8:11], 0 offen
    v_add_u32 v1, 4096, v1
    buffer_load_dwordx4 v[12:15], v1, s[8:11], 0 offen
    v_add_u32 v1, 4096, v1
    buffer_load_dwordx4 v[16:19], v1, s[8:11], 0 offen
    v_add_u32 v1, 4096, v1
    buffer_load_dwordx4 v[4:7], v1, s[8:11], 0 offen
    v_add_u32 v1, 4096, v1
    buffer_load_dwordx4 v[8:11], v1, s[8:11], 0 offen
    v_add_u32 v1, 4096, v1
    buffer_load_dwordx4 v[12:15], v1, s[8:11], 0 offen
    v_add_u32 v1, 4096, v1
    buffer_load_dwordx4 v[16:19], v1, s[8:11], 0 offen
    s_waitcnt vmcnt(0)
LN_done:
    s_endpgm
.globl gemm1_kernel
.p2align 8
.type gemm1_kernel,@function
gemm1_kernel:
    s_cmp_ge_u32 s2, 256
    s_cbranch_scc1 G1_done
    s_load_dwordx2 s[16:17], s[0:1], 8
    s_load_dwordx2 s[18:19], s[0:1], 32
    s_load_dwordx2 s[20:21], s[0:1], 40
    s_load_dwordx2 s[22:23], s[0:1], 72
    v_lshrrev_b32 v1, 6, v0
    v_and_b32 v0, 63, v0
    s_nop 0
    v_readfirstlane_b32 s24, v1
    s_and_b32 s25, s2, 7
    s_lshr_b32 s26, s2, 3
    s_and_b32 s27, s26, 7
    s_lshr_b32 s28, s26, 3
    s_lshl_b32 s29, s25, 2
    s_add_u32 s28, s28, s29
    s_lshr_b32 s30, s24, 1
    s_and_b32 s31, s24, 1
    s_waitcnt lgkmcnt(0)
    s_mov_b32 s4, s22
    s_mov_b32 s5, s23
    s_mov_b32 s6, 4194304
    s_mov_b32 s7, 0x00020000
    v_lshrrev_b32 v10, 2, v0
    v_and_b32 v11, 3, v0
    v_lshrrev_b32 v12, 4, v0
    v_sub_u32 v12, 0, v12
    v_and_b32 v12, 3, v12
    v_xor_b32 v11, v11, v12
    v_lshlrev_b32 v11, 4, v11
    s_lshl_b32 s34, s27, 8
    s_lshl_b32 s35, s24, 5
    s_add_u32 s34, s34, s35
    v_add_u32 v13, s34, v10
    v_lshlrev_b32 v13, 11, v13
    v_add_u32 v2, v13, v11
    v_add_u32 v3, 0x8000, v2
    s_mul_i32 s34, s28, 192
    s_mul_i32 s35, s28, 224
    s_lshl_b32 s36, s24, 6
    s_add_u32 s36, s36, 0
    v_add_u32 v21, s36, v0
    v_mul_u32_u24 v22, 0xcccd, v21
    v_lshrrev_b32 v22, 21, v22
    v_mul_u32_u24 v23, 40, v22
    v_sub_u32 v23, v21, v23
    v_bfe_u32 v21, v22, 1, 1
    v_bfe_u32 v24, v22, 3, 1
    v_lshlrev_b32 v24, 1, v24
    v_add_u32 v21, v21, v24
    v_lshlrev_b32 v21, 1, v21
    v_xor_b32 v23, v23, v21
    v_lshlrev_b32 v24, 4, v23
    v_add_u32 v25, s35, v24
    v_subrev_u32 v26, 416, v25
    v_mov_b32 v27, s20
    v_mov_b32 v28, s21
    v_mov_b32 v29, 7168
    v_cmp_gt_u32 vcc, 30, v23
    v_subrev_u32 v21, 256, v25
    s_nop 0
    v_cndmask_b32 v26, v26, v21, vcc
    v_mov_b32 v21, s18
    v_cndmask_b32 v27, v27, v21, vcc
    v_mov_b32 v21, s19
    v_cndmask_b32 v28, v28, v21, vcc
    v_cmp_gt_u32 vcc, 20, v23
    v_subrev_u32 v21, 256, v25
    s_nop 0
    v_cndmask_b32 v26, v26, v21, vcc
    v_mov_b32 v21, s20
    v_cndmask_b32 v27, v27, v21, vcc
    v_mov_b32 v21, s21
    v_cndmask_b32 v28, v28, v21, vcc
    v_cmp_gt_u32 vcc, 16, v23
    v_subrev_u32 v21, 192, v25
    s_nop 0
    v_cndmask_b32 v26, v26, v21, vcc
    v_mov_b32 v21, s18
    v_cndmask_b32 v27, v27, v21, vcc
    v_mov_b32 v21, s19
    v_cndmask_b32 v28, v28, v21, vcc
    v_cmp_gt_u32 vcc, 12, v23
    v_add_u32 v21, s34, v24
    s_nop 0
    v_cndmask_b32 v26, v26, v21, vcc
    v_mov_b32 v21, s16
    v_cndmask_b32 v27, v27, v21, vcc
    v_mov_b32 v21, s17
    v_cndmask_b32 v28, v28, v21, vcc
    v_mov_b32 v21, 6144
    v_cndmask_b32 v29, v29, v21, vcc
    v_mul_lo_u32 v21, v22, v29
    v_add_u32 v21, v21, v26
    v_add_co_u32 v6, vcc, v27, v21
    s_nop 1
    v_addc_co_u32 v7, vcc, 0, v28, vcc
    v_lshlrev_b32 v16, 5, v29
    s_lshl_b32 s36, s24, 6
    s_add_u32 s36, s36, 512
    v_add_u32 v21, s36, v0
    v_mul_u32_u24 v22, 0xcccd, v21
    v_lshrrev_b32 v22, 21, v22
    v_mul_u32_u24 v23, 40, v22
    v_sub_u32 v23, v21, v23
    v_bfe_u32 v21, v22, 1, 1
    v_bfe_u32 v24, v22, 3, 1
    v_lshlrev_b32 v24, 1, v24
    v_add_u32 v21, v21, v24
    v_lshlrev_b32 v21, 1, v21
    v_xor_b32 v23, v23, v21
    v_lshlrev_b32 v24, 4, v23
    v_add_u32 v25, s35, v24
    v_subrev_u32 v26, 416, v25
    v_mov_b32 v27, s20
    v_mov_b32 v28, s21
    v_mov_b32 v29, 7168
    v_cmp_gt_u32 vcc, 30, v23
    v_subrev_u32 v21, 256, v25
    s_nop 0
    v_cndmask_b32 v26, v26, v21, vcc
    v_mov_b32 v21, s18
    v_cndmask_b32 v27, v27, v21, vcc
    v_mov_b32 v21, s19
    v_cndmask_b32 v28, v28, v21, vcc
    v_cmp_gt_u32 vcc, 20, v23
    v_subrev_u32 v21, 256, v25
    s_nop 0
    v_cndmask_b32 v26, v26, v21, vcc
    v_mov_b32 v21, s20
    v_cndmask_b32 v27, v27, v21, vcc
    v_mov_b32 v21, s21
    v_cndmask_b32 v28, v28, v21, vcc
    v_cmp_gt_u32 vcc, 16, v23
    v_subrev_u32 v21, 192, v25
    s_nop 0
    v_cndmask_b32 v26, v26, v21, vcc
    v_mov_b32 v21, s18
    v_cndmask_b32 v27, v27, v21, vcc
    v_mov_b32 v21, s19
    v_cndmask_b32 v28, v28, v21, vcc
    v_cmp_gt_u32 vcc, 12, v23
    v_add_u32 v21, s34, v24
    s_nop 0
    v_cndmask_b32 v26, v26, v21, vcc
    v_mov_b32 v21, s16
    v_cndmask_b32 v27, v27, v21, vcc
    v_mov_b32 v21, s17
    v_cndmask_b32 v28, v28, v21, vcc
    v_mov_b32 v21, 6144
    v_cndmask_b32 v29, v29, v21, vcc
    v_mul_lo_u32 v21, v22, v29
    v_add_u32 v21, v21, v26
    v_add_co_u32 v8, vcc, v27, v21
    s_nop 1
    v_addc_co_u32 v9, vcc, 0, v28, vcc
    v_lshlrev_b32 v17, 5, v29
    s_lshl_b32 s36, s24, 6
    s_add_u32 s36, s36, 1024
    v_add_u32 v21, s36, v0
    v_mul_u32_u24 v22, 0xcccd, v21
    v_lshrrev_b32 v22, 21, v22
    v_mul_u32_u24 v23, 40, v22
    v_sub_u32 v23, v21, v23
    v_bfe_u32 v21, v22, 1, 1
    v_bfe_u32 v24, v22, 3, 1
    v_lshlrev_b32 v24, 1, v24
    v_add_u32 v21, v21, v24
    v_lshlrev_b32 v21, 1, v21
    v_xor_b32 v23, v23, v21
    v_lshlrev_b32 v24, 4, v23
    v_add_u32 v25, s35, v24
    v_subrev_u32 v26, 416, v25
    v_mov_b32 v27, s20
    v_mov_b32 v28, s21
    v_mov_b32 v29, 7168
    v_cmp_gt_u32 vcc, 30, v23
    v_subrev_u32 v21, 256, v25
    s_nop 0
    v_cndmask_b32 v26, v26, v21, vcc
    v_mov_b32 v21, s18
    v_cndmask_b32 v27, v27, v21, vcc
    v_mov_b32 v21, s19
    v_cndmask_b32 v28, v28, v21, vcc
    v_cmp_gt_u32 vcc, 20, v23
    v_subrev_u32 v21, 256, v25
    s_nop 0
    v_cndmask_b32 v26, v26, v21, vcc
    v_mov_b32 v21, s20
    v_cndmask_b32 v27, v27, v21, vcc
    v_mov_b32 v21, s21
    v_cndmask_b32 v28, v28, v21, vcc
    v_cmp_gt_u32 vcc, 16, v23
    v_subrev_u32 v21, 192, v25
    s_nop 0
    v_cndmask_b32 v26, v26, v21, vcc
    v_mov_b32 v21, s18
    v_cndmask_b32 v27, v27, v21, vcc
    v_mov_b32 v21, s19
    v_cndmask_b32 v28, v28, v21, vcc
    v_cmp_gt_u32 vcc, 12, v23
    v_add_u32 v21, s34, v24
    s_nop 0
    v_cndmask_b32 v26, v26, v21, vcc
    v_mov_b32 v21, s16
    v_cndmask_b32 v27, v27, v21, vcc
    v_mov_b32 v21, s17
    v_cndmask_b32 v28, v28, v21, vcc
    v_mov_b32 v21, 6144
    v_cndmask_b32 v29, v29, v21, vcc
    v_mul_lo_u32 v21, v22, v29
    v_add_u32 v21, v21, v26
    v_add_co_u32 v10, vcc, v27, v21
    s_nop 1
    v_addc_co_u32 v11, vcc, 0, v28, vcc
    v_lshlrev_b32 v18, 5, v29
    s_lshl_b32 s38, s24, 11
    s_lshl_b32 s39, s24, 10
    v_and_b32 v24, 15, v0
    v_lshrrev_b32 v25, 4, v0
    s_lshl_b32 s35, s30, 6
    v_add_u32 v26, s35, v24
    v_lshlrev_b32 v26, 6, v26
    v_lshrrev_b32 v27, 2, v24
    v_sub_u32 v27, 0, v27
    v_and_b32 v27, 3, v27
    v_xor_b32 v27, v27, v25
    v_lshlrev_b32 v27, 4, v27
    v_add_u32 v21, v26, v27
    v_lshlrev_b32 v26, 3, v25
    v_lshrrev_b32 v27, 2, v24
    v_add_u32 v26, v26, v27
    v_mul_u32_u24 v26, 640, v26
    v_and_b32 v27, 1, v24
    v_lshlrev_b32 v27, 3, v27
    v_add_u32 v26, v26, v27
    v_add_u32 v26, 16384, v26
    v_bfe_u32 v27, v24, 3, 1
    v_lshlrev_b32 v27, 1, v27
    v_and_b32 v32, 1, v25
    v_lshlrev_b32 v32, 2, v32
    v_add_u32 v27, v27, v32
    v_bfe_u32 v32, v24, 1, 1
    s_lshl_b32 s35, s31, 1
    s_mul_i32 s36, s31, 10
    s_add_u32 s37, s35, 0
    s_and_b32 s37, s37, 3
    s_lshl_b32 s37, s37, 1
    v_add_u32 v33, s37, v32
    v_xor_b32 v33, v33, v27
    v_lshlrev_b32 v33, 4, v33
    s_add_u32 s37, s36, 0
    s_lshr_b32 s37, s37, 2
    s_lshl_b32 s37, s37, 7
    v_add_u32 v33, s37, v33
    v_add_u32 v28, v26, v33
    s_add_u32 s37, s35, 1
    s_and_b32 s37, s37, 3
    s_lshl_b32 s37, s37, 1
    v_add_u32 v33, s37, v32
    v_xor_b32 v33, v33, v27
    v_lshlrev_b32 v33, 4, v33
    s_add_u32 s37, s36, 1
    s_lshr_b32 s37, s37, 2
    s_lshl_b32 s37, s37, 7
    v_add_u32 v33, s37, v33
    v_add_u32 v29, v26, v33
    s_add_u32 s37, s35, 2
    s_and_b32 s37, s37, 3
    s_lshl_b32 s37, s37, 1
    v_add_u32 v33, s37, v32
    v_xor_b32 v33, v33, v27
    v_lshlrev_b32 v33, 4, v33
    s_add_u32 s37, s36, 2
    s_lshr_b32 s37, s37, 2
    s_lshl_b32 s37, s37, 7
    v_add_u32 v33, s37, v33
    v_add_u32 v30, v26, v33
    s_add_u32 s37, s35, 3
    s_and_b32 s37, s37, 3
    s_lshl_b32 s37, s37, 1
    v_add_u32 v33, s37, v32
    v_xor_b32 v33, v33, v27
    v_lshlrev_b32 v33, 4, v33
    s_add_u32 s37, s36, 3
    s_lshr_b32 s37, s37, 2
    s_lshl_b32 s37, s37, 7
    v_add_u32 v33, s37, v33
    v_add_u32 v31, v26, v33
    v_add_u32 v22, 73728, v21
    v_add_u32 v32, 73728, v28
    v_add_u32 v33, 73728, v29
    v_add_u32 v34, 73728, v30
    v_add_u32 v35, 73728, v31
    v_mov_b32 v96, 0
    v_mov_b32 v97, 0
    v_mov_b32 v98, 0
    v_mov_b32 v99, 0
    v_mov_b32 v100, 0
    v_mov_b32 v101, 0
    v_mov_b32 v102, 0
    v_mov_b32 v103, 0
    v_mov_b32 v104, 0
    v_mov_b32 v105, 0
    v_mov_b32 v106, 0
    v_mov_b32 v107, 0
    v_mov_b32 v108, 0
    v_mov_b32 v109, 0
    v_mov_b32 v110, 0
    v_mov_b32 v111, 0
    v_mov_b32 v112, 0
    v_mov_b32 v113, 0
    v_mov_b32 v114, 0
    v_mov_b32 v115, 0
    v_mov_b32 v116, 0
    v_mov_b32 v117, 0
    v_mov_b32 v118, 0
    v_mov_b32 v119, 0
    v_mov_b32 v120, 0
    v_mov_b32 v121, 0
    v_mov_b32 v122, 0
    v_mov_b32 v123, 0
    v_mov_b32 v124, 0
    v_mov_b32 v125, 0
    v_mov_b32 v126, 0
    v_mov_b32 v127, 0
    v_mov_b32 v128, 0
    v_mov_b32 v129, 0
    v_mov_b32 v130, 0
    v_mov_b32 v131, 0
    v_mov_b32 v132, 0
    v_mov_b32 v133, 0
    v_mov_b32 v134, 0
    v_mov_b32 v135, 0
    v_mov_b32 v136, 0
    v_mov_b32 v137, 0
    v_mov_b32 v138, 0
    v_mov_b32 v139, 0
    v_mov_b32 v140, 0
    v_mov_b32 v141, 0
    v_mov_b32 v142, 0
    v_mov_b32 v143, 0
    v_mov_b32 v144, 0
    v_mov_b32 v145, 0
    v_mov_b32 v146, 0
    v_mov_b32 v147, 0
    v_mov_b32 v148, 0
    v_mov_b32 v149, 0
    v_mov_b32 v150, 0
    v_mov_b32 v151, 0
    v_mov_b32 v152, 0
    v_mov_b32 v153, 0
    v_mov_b32 v154, 0
    v_mov_b32 v155, 0
    v_mov_b32 v156, 0
    v_mov_b32 v157, 0
    v_mov_b32 v158, 0
    v_mov_b32 v159, 0
    v_mov_b32 v160, 0
    v_mov_b32 v161, 0
    v_mov_b32 v162, 0
    v_mov_b32 v163, 0
    v_mov_b32 v164, 0
    v_mov_b32 v165, 0
    v_mov_b32 v166, 0
    v_mov_b32 v167, 0
    v_mov_b32 v168, 0
    v_mov_b32 v169, 0
    v_mov_b32 v170, 0
    v_mov_b32 v171, 0
    v_mov_b32 v172, 0
    v_mov_b32 v173, 0
    v_mov_b32 v174, 0
    v_mov_b32 v175, 0
    v_mov_b32 v176, 0
    v_mov_b32 v177, 0
    v_mov_b32 v178, 0
    v_mov_b32 v179, 0
    v_mov_b32 v180, 0
    v_mov_b32 v181, 0
    v_mov_b32 v182, 0
    v_mov_b32 v183, 0
    v_mov_b32 v184, 0
    v_mov_b32 v185, 0
    v_mov_b32 v186, 0
    v_mov_b32 v187, 0
    v_mov_b32 v188, 0
    v_mov_b32 v189, 0
    v_mov_b32 v190, 0
    v_mov_b32 v191, 0
    v_mov_b32 v192, 0
    v_mov_b32 v193, 0
    v_mov_b32 v194, 0
    v_mov_b32 v195, 0
    v_mov_b32 v196, 0
    v_mov_b32 v197, 0
    v_mov_b32 v198, 0
    v_mov_b32 v199, 0
    v_mov_b32 v200, 0
    v_mov_b32 v201, 0
    v_mov_b32 v202, 0
    v_mov_b32 v203, 0
    v_mov_b32 v204, 0
    v_mov_b32 v205, 0
    v_mov_b32 v206, 0
    v_mov_b32 v207, 0
    v_mov_b32 v208, 0
    v_mov_b32 v209, 0
    v_mov_b32 v210, 0
    v_mov_b32 v211, 0
    v_mov_b32 v212, 0
    v_mov_b32 v213, 0
    v_mov_b32 v214, 0
    v_mov_b32 v215, 0
    v_mov_b32 v216, 0
    v_mov_b32 v217, 0
    v_mov_b32 v218, 0
    v_mov_b32 v219, 0
    v_mov_b32 v220, 0
    v_mov_b32 v221, 0
    v_mov_b32 v222, 0
    v_mov_b32 v223, 0
    v_mov_b32 v224, 0
    v_mov_b32 v225, 0
    v_mov_b32 v226, 0
    v_mov_b32 v227, 0
    v_mov_b32 v228, 0
    v_mov_b32 v229, 0
    v_mov_b32 v230, 0
    v_mov_b32 v231, 0
    v_mov_b32 v232, 0
    v_mov_b32 v233, 0
    v_mov_b32 v234, 0
    v_mov_b32 v235, 0
    v_mov_b32 v236, 0
    v_mov_b32 v237, 0
    v_mov_b32 v238, 0
    v_mov_b32 v239, 0
    v_mov_b32 v240, 0
    v_mov_b32 v241, 0
    v_mov_b32 v242, 0
    v_mov_b32 v243, 0
    v_mov_b32 v244, 0
    v_mov_b32 v245, 0
    v_mov_b32 v246, 0
    v_mov_b32 v247, 0
    v_mov_b32 v248, 0
    v_mov_b32 v249, 0
    v_mov_b32 v250, 0
    v_mov_b32 v251, 0
    v_mov_b32 v252, 0
    v_mov_b32 v253, 0
    v_mov_b32 v254, 0
    v_mov_b32 v255, 0
    s_mov_b32 s40, 0
    s_add_u32 m0, s38, 0
    s_nop 0
    buffer_load_dwordx4 v2, s[4:7], s40 offen lds
    s_add_u32 m0, s38, 1024
    s_nop 0
    buffer_load_dwordx4 v3, s[4:7], s40 offen lds
    s_add_u32 s40, s40, 64
    s_add_u32 m0, s39, 16384
    s_nop 0
    global_load_lds_dwordx4 v[6:7], off
    v_add_co_u32 v6, vcc, v6, v16
    s_nop 1
    v_addc_co_u32 v7, vcc, 0, v7, vcc
    s_add_u32 m0, s39, 24576
    s_nop 0
    global_load_lds_dwordx4 v[8:9], off
    v_add_co_u32 v8, vcc, v8, v17
    s_nop 1
    v_addc_co_u32 v9, vcc, 0, v9, vcc
    s_cmp_ge_u32 s24, 4
    s_cbranch_scc1 G1_sk0
    s_add_u32 m0, s39, 32768
    s_nop 0
    global_load_lds_dwordx4 v[10:11], off
    v_add_co_u32 v10, vcc, v10, v18
    s_nop 1
    v_addc_co_u32 v11, vcc, 0, v11, vcc
G1_sk0:
    s_add_u32 m0, s38, 36864
    s_nop 0
    buffer_load_dwordx4 v2, s[4:7], s40 offen lds
    s_add_u32 m0, s38, 37888
    s_nop 0
    buffer_load_dwordx4 v3, s[4:7], s40 offen lds
    s_add_u32 s40, s40, 64
    s_add_u32 m0, s39, 53248
    s_nop 0
    global_load_lds_dwordx4 v[6:7], off
    v_add_co_u32 v6, vcc, v6, v16
    s_nop 1
    v_addc_co_u32 v7, vcc, 0, v7, vcc
    s_add_u32 m0, s39, 61440
    s_nop 0
    global_load_lds_dwordx4 v[8:9], off
    v_add_co_u32 v8, vcc, v8, v17
    s_nop 1
    v_addc_co_u32 v9, vcc, 0, v9, vcc
    s_cmp_ge_u32 s24, 4
    s_cbranch_scc1 G1_sk1
    s_add_u32 m0, s39, 69632
    s_nop 0
    global_load_lds_dwordx4 v[10:11], off
    v_add_co_u32 v10, vcc, v10, v18
    s_nop 1
    v_addc_co_u32 v11, vcc, 0, v11, vcc
G1_sk1:
    s_add_u32 m0, s38, 73728
    s_nop 0
    buffer_load_dwordx4 v2, s[4:7], s40 offen lds
    s_add_u32 m0, s38, 74752
    s_nop 0
    buffer_load_dwordx4 v3, s[4:7], s40 offen lds
    s_add_u32 s40, s40, 64
    s_add_u32 m0, s39, 90112
    s_nop 0
    global_load_lds_dwordx4 v[6:7], off
    v_add_co_u32 v6, vcc, v6, v16
    s_nop 1
    v_addc_co_u32 v7, vcc, 0, v7, vcc
    s_add_u32 m0, s39, 98304
    s_nop 0
    global_load_lds_dwordx4 v[8:9], off
    v_add_co_u32 v8, vcc, v8, v17
    s_nop 1
    v_addc_co_u32 v9, vcc, 0, v9, vcc
    s_cmp_ge_u32 s24, 4
    s_cbranch_scc1 G1_sk2
    s_add_u32 m0, s39, 106496
    s_nop 0
    global_load_lds_dwordx4 v[10:11], off
    v_add_co_u32 v10, vcc, v10, v18
    s_nop 1
    v_addc_co_u32 v11, vcc, 0, v11, vcc
G1_sk2:
    s_waitcnt vmcnt(8)
    s_barrier
    ds_read_b128 v[36:39], v21 offset:0
    ds_read_b128 v[40:43], v21 offset:1024
    ds_read_b128 v[44:47], v21 offset:2048
    ds_read_b128 v[48:51], v21 offset:3072
    ds_read_b64_tr_b16 v[68:69], v28 offset:0
    ds_read_b64_tr_b16 v[70:71], v28 offset:2560
    ds_read_b64_tr_b16 v[72:73], v29 offset:0
    ds_read_b64_tr_b16 v[74:75], v29 offset:2560
    ds_read_b64_tr_b16 v[76:77], v30 offset:0
    ds_read_b64_tr_b16 v[78:79], v30 offset:2560
    ds_read_b64_tr_b16 v[80:81], v31 offset:0
    ds_read_b64_tr_b16 v[82:83], v31 offset:2560
    s_waitcnt vmcnt(4)
    s_barrier
    ds_read_b64_tr_b16 v[84:85], v28 offset:128
    ds_read_b64_tr_b16 v[86:87], v28 offset:2688
    s_waitcnt lgkmcnt(8)
    v_mfma_f32_16x16x32_bf16 v[96:99], v[68:71], v[36:39], v[96:99]
    v_mfma_f32_16x16x32_bf16 v[100:103], v[68:71], v[40:43], v[100:103]
    v_mfma_f32_16x16x32_bf16 v[104:107], v[68:71], v[44:47], v[104:107]
    v_mfma_f32_16x16x32_bf16 v[108:111], v[68:71], v[48:51], v[108:111]
    s_add_u32 m0, s38, 110592
    s_nop 0
    buffer_load_dwordx4 v2, s[4:7], s40 offen lds
    ds_read_b64_tr_b16 v[88:89], v29 offset:128
    ds_read_b64_tr_b16 v[90:91], v29 offset:2688
    s_waitcnt lgkmcnt(8)
    v_mfma_f32_16x16x32_bf16 v[112:115], v[72:75], v[36:39], v[112:115]
    v_mfma_f32_16x16x32_bf16 v[116:119], v[72:75], v[40:43], v[116:119]
    v_mfma_f32_16x16x32_bf16 v[120:123], v[72:75], v[44:47], v[120:123]
    v_mfma_f32_16x16x32_bf16 v[124:127], v[72:75], v[48:51], v[124:127]
    s_add_u32 m0, s38, 111616
    s_nop 0
    buffer_load_dwordx4 v3, s[4:7], s40 offen lds
    s_add_u32 s40, s40, 64
    ds_read_b64_tr_b16 v[68:69], v30 offset:128
    ds_read_b64_tr_b16 v[70:71], v30 offset:2688
    s_waitcnt lgkmcnt(8)
    v_mfma_f32_16x16x32_bf16 v[128:131], v[76:79], v[36:39], v[128:131]
    v_mfma_f32_16x16x32_bf16 v[132:135], v[76:79], v[40:43], v[132:135]
    v_mfma_f32_16x16x32_bf16 v[136:139], v[76:79], v[44:47], v[136:139]
    v_mfma_f32_16x16x32_bf16 v[140:143], v[76:79], v[48:51], v[140:143]
    s_add_u32 m0, s39, 126976
    s_nop 0
    global_load_lds_dwordx4 v[6:7], off
    v_add_co_u32 v6, vcc, v6, v16
    s_nop 1
    v_addc_co_u32 v7, vcc, 0, v7, vcc
    ds_read_b64_tr_b16 v[72:73], v31 offset:128
    ds_read_b64_tr_b16 v[74:75], v31 offset:2688
    s_waitcnt lgkmcnt(8)
    v_mfma_f32_16x16x32_bf16 v[144:147], v[80:83], v[36:39], v[144:147]
    v_mfma_f32_16x16x32_bf16 v[148:151], v[80:83], v[40:43], v[148:151]
    v_mfma_f32_16x16x32_bf16 v[152:155], v[80:83], v[44:47], v[152:155]
    v_mfma_f32_16x16x32_bf16 v[156:159], v[80:83], v[48:51], v[156:159]
    s_add_u32 m0, s39, 135168
    s_nop 0
    global_load_lds_dwordx4 v[8:9], off
    v_add_co_u32 v8, vcc, v8, v17
    s_nop 1
    v_addc_co_u32 v9, vcc, 0, v9, vcc
    ds_read_b64_tr_b16 v[76:77], v28 offset:256
    ds_read_b64_tr_b16 v[78:79], v28 offset:2816
    s_waitcnt lgkmcnt(8)
    v_mfma_f32_16x16x32_bf16 v[160:163], v[84:87], v[36:39], v[160:163]
    v_mfma_f32_16x16x32_bf16 v[164:167], v[84:87], v[40:43], v[164:167]
    v_mfma_f32_16x16x32_bf16 v[168:171], v[84:87], v[44:47], v[168:171]
    v_mfma_f32_16x16x32_bf16 v[172:175], v[84:87], v[48:51], v[172:175]
    s_cmp_ge_u32 s24, 4
    s_cbranch_scc1 G1_sk3
    s_add_u32 m0, s39, 143360
    s_nop 0
    global_load_lds_dwordx4 v[10:11], off
    v_add_co_u32 v10, vcc, v10, v18
    s_nop 1
    v_addc_co_u32 v11, vcc, 0, v11, vcc
G1_sk3:
    ds_read_b64_tr_b16 v[80:81], v29 offset:256
    ds_read_b64_tr_b16 v[82:83], v29 offset:2816
    ds_read_b128 v[52:55], v21 offset:36864
    s_waitcnt lgkmcnt(9)
    v_mfma_f32_16x16x32_bf16 v[176:179], v[88:91], v[36:39], v[176:179]
    v_mfma_f32_16x16x32_bf16 v[180:183], v[88:91], v[40:43], v[180:183]
    v_mfma_f32_16x16x32_bf16 v[184:187], v[88:91], v[44:47], v[184:187]
    v_mfma_f32_16x16x32_bf16 v[188:191], v[88:91], v[48:51], v[188:191]
    ds_read_b64_tr_b16 v[84:85], v28 offset:36864
    ds_read_b64_tr_b16 v[86:87], v28 offset:39424
    ds_read_b128 v[56:59], v21 offset:37888
    s_waitcnt lgkmcnt(10)
    v_mfma_f32_16x16x32_bf16 v[192:195], v[68:71], v[36:39], v[192:195]
    v_mfma_f32_16x16x32_bf16 v[196:199], v[68:71], v[40:43], v[196:199]
    v_mfma_f32_16x16x32_bf16 v[200:203], v[68:71], v[44:47], v[200:203]
    v_mfma_f32_16x16x32_bf16 v[204:207], v[68:71], v[48:51], v[204:207]
    ds_read_b64_tr_b16 v[88:89], v29 offset:36864
    ds_read_b64_tr_b16 v[90:91], v29 offset:39424
    ds_read_b128 v[60:63], v21 offset:38912
    s_waitcnt lgkmcnt(11)
    v_mfma_f32_16x16x32_bf16 v[208:211], v[72:75], v[36:39], v[208:211]
    v_mfma_f32_16x16x32_bf16 v[212:215], v[72:75], v[40:43], v[212:215]
    v_mfma_f32_16x16x32_bf16 v[216:219], v[72:75], v[44:47], v[216:219]
    v_mfma_f32_16x16x32_bf16 v[220:223], v[72:75], v[48:51], v[220:223]
    ds_read_b64_tr_b16 v[68:69], v30 offset:36864
    ds_read_b64_tr_b16 v[70:71], v30 offset:39424
    ds_read_b128 v[64:67], v21 offset:39936
    s_waitcnt lgkmcnt(12)
    v_mfma_f32_16x16x32_bf16 v[224:227], v[76:79], v[36:39], v[224:227]
    v_mfma_f32_16x16x32_bf16 v[228:231], v[76:79], v[40:43], v[228:231]
    v_mfma_f32_16x16x32_bf16 v[232:235], v[76:79], v[44:47], v[232:235]
    v_mfma_f32_16x16x32_bf16 v[236:239], v[76:79], v[48:51], v[236:239]
    ds_read_b64_tr_b16 v[72:73], v31 offset:36864
    ds_read_b64_tr_b16 v[74:75], v31 offset:39424
    s_waitcnt lgkmcnt(12)
    v_mfma_f32_16x16x32_bf16 v[240:243], v[80:83], v[36:39], v[240:243]
    v_mfma_f32_16x16x32_bf16 v[244:247], v[80:83], v[40:43], v[244:247]
    v_mfma_f32_16x16x32_bf16 v[248:251], v[80:83], v[44:47], v[248:251]
    v_mfma_f32_16x16x32_bf16 v[252:255], v[80:83], v[48:51], v[252:255]
    s_waitcnt vmcnt(4)
    s_barrier
    ds_read_b64_tr_b16 v[76:77], v28 offset:36992
    ds_read_b64_tr_b16 v[78:79], v28 offset:39552
    s_waitcnt lgkmcnt(4)
    v_mfma_f32_16x16x32_bf16 v[96:99], v[84:87], v[52:55], v[96:99]
    v_mfma_f32_16x16x32_bf16 v[100:103], v[84:87], v[56:59], v[100:103]
    v_mfma_f32_16x16x32_bf16 v[104:107], v[84:87], v[60:63], v[104:107]
    v_mfma_f32_16x16x32_bf16 v[108:111], v[84:87], v[64:67], v[108:111]
    s_add_u32 m0, s38, 0
    s_nop 0
    buffer_load_dwordx4 v2, s[4:7], s40 offen lds
    ds_read_b64_tr_b16 v[80:81], v29 offset:36992
    ds_read_b64_tr_b16 v[82:83], v29 offset:39552
    v_mfma_f32_16x16x32_bf16 v[112:115], v[88:91], v[52:55], v[112:115]
    v_mfma_f32_16x16x32_bf16 v[116:119], v[88:91], v[56:59], v[116:119]
    v_mfma_f32_16x16x32_bf16 v[120:123], v[88:91], v[60:63], v[120:123]
    v_mfma_f32_16x16x32_bf16 v[124:127], v[88:91], v[64:67], v[124:127]
    s_add_u32 m0, s38, 1024
    s_nop 0
    buffer_load_dwordx4 v3, s[4:7], s40 offen lds
    s_add_u32 s40, s40, 64
    ds_read_b64_tr_b16 v[84:85], v30 offset:36992
    ds_read_b64_tr_b16 v[86:87], v30 offset:39552
    v_mfma_f32_16x16x32_bf16 v[128:131], v[68:71], v[52:55], v[128:131]
    v_mfma_f32_16x16x32_bf16 v[132:135], v[68:71], v[56:59], v[132:135]
    v_mfma_f32_16x16x32_bf16 v[136:139], v[68:71], v[60:63], v[136:139]
    v_mfma_f32_16x16x32_bf16 v[140:143], v[68:71], v[64:67], v[140:143]
    s_add_u32 m0, s39, 16384
    s_nop 0
    global_load_lds_dwordx4 v[6:7], off
    v_add_co_u32 v6, vcc, v6, v16
    s_nop 1
    v_addc_co_u32 v7, vcc, 0, v7, vcc
    ds_read_b64_tr_b16 v[88:89], v31 offset:36992
    ds_read_b64_tr_b16 v[90:91], v31 offset:39552
    s_waitcnt lgkmcnt(8)
    v_mfma_f32_16x16x32_bf16 v[144:147], v[72:75], v[52:55], v[144:147]
    v_mfma_f32_16x16x32_bf16 v[148:151], v[72:75], v[56:59], v[148:151]
    v_mfma_f32_16x16x32_bf16 v[152:155], v[72:75], v[60:63], v[152:155]
    v_mfma_f32_16x16x32_bf16 v[156:159], v[72:75], v[64:67], v[156:159]
    s_add_u32 m0, s39, 24576
    s_nop 0
    global_load_lds_dwordx4 v[8:9], off
    v_add_co_u32 v8, vcc, v8, v17
    s_nop 1
    v_addc_co_u32 v9, vcc, 0, v9, vcc
    ds_read_b64_tr_b16 v[68:69], v28 offset:37120
    ds_read_b64_tr_b16 v[70:71], v28 offset:39680
    s_waitcnt lgkmcnt(8)
    v_mfma_f32_16x16x32_bf16 v[160:163], v[76:79], v[52:55], v[160:163]
    v_mfma_f32_16x16x32_bf16 v[164:167], v[76:79], v[56:59], v[164:167]
    v_mfma_f32_16x16x32_bf16 v[168:171], v[76:79], v[60:63], v[168:171]
    v_mfma_f32_16x16x32_bf16 v[172:175], v[76:79], v[64:67], v[172:175]
    s_cmp_ge_u32 s24, 4
    s_cbranch_scc1 G1_sk4
    s_add_u32 m0, s39, 32768
    s_nop 0
    global_load_lds_dwordx4 v[10:11], off
    v_add_co_u32 v10, vcc, v10, v18
    s_nop 1
    v_addc_co_u32 v11, vcc, 0, v11, vcc
G1_sk4:
    ds_read_b64_tr_b16 v[72:73], v29 offset:37120
    ds_read_b64_tr_b16 v[74:75], v29 offset:39680
    ds_read_b128 v[36:39], v22 offset:0
    s_waitcnt lgkmcnt(9)
    v_mfma_f32_16x16x32_bf16 v[176:179], v[80:83], v[52:55], v[176:179]
    v_mfma_f32_16x16x32_bf16 v[180:183], v[80:83], v[56:59], v[180:183]
    v_mfma_f32_16x16x32_bf16 v[184:187], v[80:83], v[60:63], v[184:187]
    v_mfma_f32_16x16x32_bf16 v[188:191], v[80:83], v[64:67], v[188:191]
    ds_read_b64_tr_b16 v[76:77], v32 offset:0
    ds_read_b64_tr_b16 v[78:79], v32 offset:2560
    ds_read_b128 v[40:43], v22 offset:1024
    s_waitcnt lgkmcnt(10)
    v_mfma_f32_16x16x32_bf16 v[192:195], v[84:87], v[52:55], v[192:195]
    v_mfma_f32_16x16x32_bf16 v[196:199], v[84:87], v[56:59], v[196:199]
    v_mfma_f32_16x16x32_bf16 v[200:203], v[84:87], v[60:63], v[200:203]
    v_mfma_f32_16x16x32_bf16 v[204:207], v[84:87], v[64:67], v[204:207]
    ds_read_b64_tr_b16 v[80:81], v33 offset:0
    ds_read_b64_tr_b16 v[82:83], v33 offset:2560
    ds_read_b128 v[44:47], v22 offset:2048
    s_waitcnt lgkmcnt(11)
    v_mfma_f32_16x16x32_bf16 v[208:211], v[88:91], v[52:55], v[208:211]
    v_mfma_f32_16x16x32_bf16 v[212:215], v[88:91], v[56:59], v[212:215]
    v_mfma_f32_16x16x32_bf16 v[216:219], v[88:91], v[60:63], v[216:219]
    v_mfma_f32_16x16x32_bf16 v[220:223], v[88:91], v[64:67], v[220:223]
    ds_read_b64_tr_b16 v[84:85], v34 offset:0
    ds_read_b64_tr_b16 v[86:87], v34 offset:2560
    ds_read_b128 v[48:51], v22 offset:3072
    s_waitcnt lgkmcnt(12)
    v_mfma_f32_16x16x32_bf16 v[224:227], v[68:71], v[52:55], v[224:227]
    v_mfma_f32_16x16x32_bf16 v[228:231], v[68:71], v[56:59], v[228:231]
    v_mfma_f32_16x16x32_bf16 v[232:235], v[68:71], v[60:63], v[232:235]
    v_mfma_f32_16x16x32_bf16 v[236:239], v[68:71], v[64:67], v[236:239]
    ds_read_b64_tr_b16 v[88:89], v35 offset:0
    ds_read_b64_tr_b16 v[90:91], v35 offset:2560
    s_waitcnt lgkmcnt(12)
    v_mfma_f32_16x16x32_bf16 v[240:243], v[72:75], v[52:55], v[240:243]
    v_mfma_f32_16x16x32_bf16 v[244:247], v[72:75], v[56:59], v[244:247]
    v_mfma_f32_16x16x32_bf16 v[248:251], v[72:75], v[60:63], v[248:251]
    v_mfma_f32_16x16x32_bf16 v[252:255], v[72:75], v[64:67], v[252:255]
    s_waitcnt vmcnt(4)
    s_barrier
    ds_read_b64_tr_b16 v[68:69], v32 offset:128
    ds_read_b64_tr_b16 v[70:71], v32 offset:2688
    s_waitcnt lgkmcnt(4)
    v_mfma_f32_16x16x32_bf16 v[96:99], v[76:79], v[36:39], v[96:99]
    v_mfma_f32_16x16x32_bf16 v[100:103], v[76:79], v[40:43], v[100:103]
    v_mfma_f32_16x16x32_bf16 v[104:107], v[76:79], v[44:47], v[104:107]
    v_mfma_f32_16x16x32_bf16 v[108:111], v[76:79], v[48:51], v[108:111]
    s_add_u32 m0, s38, 36864
    s_nop 0
    buffer_load_dwordx4 v2, s[4:7], s40 offen lds
    ds_read_b64_tr_b16 v[72:73], v33 offset:128
    ds_read_b64_tr_b16 v[74:75], v33 offset:2688
    v_mfma_f32_16x16x32_bf16 v[112:115], v[80:83], v[36:39], v[112:115]
    v_mfma_f32_16x16x32_bf16 v[116:119], v[80:83], v[40:43], v[116:119]
    v_mfma_f32_16x16x32_bf16 v[120:123], v[80:83], v[44:47], v[120:123]
    v_mfma_f32_16x16x32_bf16 v[124:127], v[80:83], v[48:51], v[124:127]
    s_add_u32 m0, s38, 37888
    s_nop 0
    buffer_load_dwordx4 v3, s[4:7], s40 offen lds
    s_add_u32 s40, s40, 64
    ds_read_b64_tr_b16 v[76:77], v34 offset:128
    ds_read_b64_tr_b16 v[78:79], v34 offset:2688
    v_mfma_f32_16x16x32_bf16 v[128:131], v[84:87], v[36:39], v[128:131]
    v_mfma_f32_16x16x32_bf16 v[132:135], v[84:87], v[40:43], v[132:135]
    v_mfma_f32_16x16x32_bf16 v[136:139], v[84:87], v[44:47], v[136:139]
    v_mfma_f32_16x16x32_bf16 v[140:143], v[84:87], v[48:51], v[140:143]
    s_add_u32 m0, s39, 53248
    s_nop 0
    global_load_lds_dwordx4 v[6:7], off
    v_add_co_u32 v6, vcc, v6, v16
    s_nop 1
    v_addc_co_u32 v7, vcc, 0, v7, vcc
    ds_read_b64_tr_b16 v[80:81], v35 offset:128
    ds_read_b64_tr_b16 v[82:83], v35 offset:2688
    s_waitcnt lgkmcnt(8)
    v_mfma_f32_16x16x32_bf16 v[144:147], v[88:91], v[36:39], v[144:147]
    v_mfma_f32_16x16x32_bf16 v[148:151], v[88:91], v[40:43], v[148:151]
    v_mfma_f32_16x16x32_bf16 v[152:155], v[88:91], v[44:47], v[152:155]
    v_mfma_f32_16x16x32_bf16 v[156:159], v[88:91], v[48:51], v[156:159]
    s_add_u32 m0, s39, 61440
    s_nop 0
    global_load_lds_dwordx4 v[8:9], off
    v_add_co_u32 v8, vcc, v8, v17
    s_nop 1
    v_addc_co_u32 v9, vcc, 0, v9, vcc
    ds_read_b64_tr_b16 v[84:85], v32 offset:256
    ds_read_b64_tr_b16 v[86:87], v32 offset:2816
    s_waitcnt lgkmcnt(8)
    v_mfma_f32_16x16x32_bf16 v[160:163], v[68:71], v[36:39], v[160:163]
    v_mfma_f32_16x16x32_bf16 v[164:167], v[68:71], v[40:43], v[164:167]
    v_mfma_f32_16x16x32_bf16 v[168:171], v[68:71], v[44:47], v[168:171]
    v_mfma_f32_16x16x32_bf16 v[172:175], v[68:71], v[48:51], v[172:175]
    s_cmp_ge_u32 s24, 4
    s_cbranch_scc1 G1_sk5
    s_add_u32 m0, s39, 69632
    s_nop 0
    global_load_lds_dwordx4 v[10:11], off
    v_add_co_u32 v10, vcc, v10, v18
    s_nop 1
    v_addc_co_u32 v11, vcc, 0, v11, vcc
G1_sk5:
    ds_read_b64_tr_b16 v[88:89], v33 offset:256
    ds_read_b64_tr_b16 v[90:91], v33 offset:2816
    ds_read_b128 v[52:55], v22 offset:36864
    s_waitcnt lgkmcnt(9)
    v_mfma_f32_16x16x32_bf16 v[176:179], v[72:75], v[36:39], v[176:179]
    v_mfma_f32_16x16x32_bf16 v[180:183], v[72:75], v[40:43], v[180:183]
    v_mfma_f32_16x16x32_bf16 v[184:187], v[72:75], v[44:47], v[184:187]
    v_mfma_f32_16x16x32_bf16 v[188:191], v[72:75], v[48:51], v[188:191]
    ds_read_b64_tr_b16 v[68:69], v32 offset:36864
    ds_read_b64_tr_b16 v[70:71], v32 offset:39424
    ds_read_b128 v[56:59], v22 offset:37888
    s_waitcnt lgkmcnt(10)
    v_mfma_f32_16x16x32_bf16 v[192:195], v[76:79], v[36:39], v[192:195]
    v_mfma_f32_16x16x32_bf16 v[196:199], v[76:79], v[40:43], v[196:199]
    v_mfma_f32_16x16x32_bf16 v[200:203], v[76:79], v[44:47], v[200:203]
    v_mfma_f32_16x16x32_bf16 v[204:207], v[76:79], v[48:51], v[204:207]
    ds_read_b64_tr_b16 v[72:73], v33 offset:36864
    ds_read_b64_tr_b16 v[74:75], v33 offset:39424
    ds_read_b128 v[60:63], v22 offset:38912
    s_waitcnt lgkmcnt(11)
    v_mfma_f32_16x16x32_bf16 v[208:211], v[80:83], v[36:39], v[208:211]
    v_mfma_f32_16x16x32_bf16 v[212:215], v[80:83], v[40:43], v[212:215]
    v_mfma_f32_16x16x32_bf16 v[216:219], v[80:83], v[44:47], v[216:219]
    v_mfma_f32_16x16x32_bf16 v[220:223], v[80:83], v[48:51], v[220:223]
    ds_read_b64_tr_b16 v[76:77], v34 offset:36864
    ds_read_b64_tr_b16 v[78:79], v34 offset:39424
    ds_read_b128 v[64:67], v22 offset:39936
    s_waitcnt lgkmcnt(12)
    v_mfma_f32_16x16x32_bf16 v[224:227], v[84:87], v[36:39], v[224:227]
    v_mfma_f32_16x16x32_bf16 v[228:231], v[84:87], v[40:43], v[228:231]
    v_mfma_f32_16x16x32_bf16 v[232:235], v[84:87], v[44:47], v[232:235]
    v_mfma_f32_16x16x32_bf16 v[236:239], v[84:87], v[48:51], v[236:239]
    ds_read_b64_tr_b16 v[80:81], v35 offset:36864
    ds_read_b64_tr_b16 v[82:83], v35 offset:39424
    s_waitcnt lgkmcnt(12)
    v_mfma_f32_16x16x32_bf16 v[240:243], v[88:91], v[36:39], v[240:243]
    v_mfma_f32_16x16x32_bf16 v[244:247], v[88:91], v[40:43], v[244:247]
    v_mfma_f32_16x16x32_bf16 v[248:251], v[88:91], v[44:47], v[248:251]
    v_mfma_f32_16x16x32_bf16 v[252:255], v[88:91], v[48:51], v[252:255]
    s_waitcnt vmcnt(4)
    s_barrier
    ds_read_b64_tr_b16 v[84:85], v32 offset:36992
    ds_read_b64_tr_b16 v[86:87], v32 offset:39552
    s_waitcnt lgkmcnt(4)
    v_mfma_f32_16x16x32_bf16 v[96:99], v[68:71], v[52:55], v[96:99]
    v_mfma_f32_16x16x32_bf16 v[100:103], v[68:71], v[56:59], v[100:103]
    v_mfma_f32_16x16x32_bf16 v[104:107], v[68:71], v[60:63], v[104:107]
    v_mfma_f32_16x16x32_bf16 v[108:111], v[68:71], v[64:67], v[108:111]
    s_add_u32 m0, s38, 73728
    s_nop 0
    buffer_load_dwordx4 v2, s[4:7], s40 offen lds
    ds_read_b64_tr_b16 v[88:89], v33 offset:36992
    ds_read_b64_tr_b16 v[90:91], v33 offset:39552
    v_mfma_f32_16x16x32_bf16 v[112:115], v[72:75], v[52:55], v[112:115]
    v_mfma_f32_16x16x32_bf16 v[116:119], v[72:75], v[56:59], v[116:119]
    v_mfma_f32_16x16x32_bf16 v[120:123], v[72:75], v[60:63], v[120:123]
    v_mfma_f32_16x16x32_bf16 v[124:127], v[72:75], v[64:67], v[124:127]
    s_add_u32 m0, s38, 74752
    s_nop 0
    buffer_load_dwordx4 v3, s[4:7], s40 offen lds
    s_add_u32 s40, s40, 64
    ds_read_b64_tr_b16 v[68:69], v34 offset:36992
    ds_read_b64_tr_b16 v[70:71], v34 offset:39552
    v_mfma_f32_16x16x32_bf16 v[128:131], v[76:79], v[52:55], v[128:131]
    v_mfma_f32_16x16x32_bf16 v[132:135], v[76:79], v[56:59], v[132:135]
    v_mfma_f32_16x16x32_bf16 v[136:139], v[76:79], v[60:63], v[136:139]
    v_mfma_f32_16x16x32_bf16 v[140:143], v[76:79], v[64:67], v[140:143]
    s_add_u32 m0, s39, 90112
    s_nop 0
    global_load_lds_dwordx4 v[6:7], off
    v_add_co_u32 v6, vcc, v6, v16
    s_nop 1
    v_addc_co_u32 v7, vcc, 0, v7, vcc
    ds_read_b64_tr_b16 v[72:73], v35 offset:36992
    ds_read_b64_tr_b16 v[74:75], v35 offset:39552
    s_waitcnt lgkmcnt(8)
    v_mfma_f32_16x16x32_bf16 v[144:147], v[80:83], v[52:55], v[144:147]
    v_mfma_f32_16x16x32_bf16 v[148:151], v[80:83], v[56:59], v[148:151]
    v_mfma_f32_16x16x32_bf16 v[152:155], v[80:83], v[60:63], v[152:155]
    v_mfma_f32_16x16x32_bf16 v[156:159], v[80:83], v[64:67], v[156:159]
    s_add_u32 m0, s39, 98304
    s_nop 0
    global_load_lds_dwordx4 v[8:9], off
    v_add_co_u32 v8, vcc, v8, v17
    s_nop 1
    v_addc_co_u32 v9, vcc, 0, v9, vcc
    ds_read_b64_tr_b16 v[76:77], v32 offset:37120
    ds_read_b64_tr_b16 v[78:79], v32 offset:39680
    s_waitcnt lgkmcnt(8)
    v_mfma_f32_16x16x32_bf16 v[160:163], v[84:87], v[52:55], v[160:163]
    v_mfma_f32_16x16x32_bf16 v[164:167], v[84:87], v[56:59], v[164:167]
    v_mfma_f32_16x16x32_bf16 v[168:171], v[84:87], v[60:63], v[168:171]
    v_mfma_f32_16x16x32_bf16 v[172:175], v[84:87], v[64:67], v[172:175]
    s_cmp_ge_u32 s24, 4
    s_cbranch_scc1 G1_sk6
    s_add_u32 m0, s39, 106496
    s_nop 0
    global_load_lds_dwordx4 v[10:11], off
    v_add_co_u32 v10, vcc, v10, v18
    s_nop 1
    v_addc_co_u32 v11, vcc, 0, v11, vcc
G1_sk6:
    ds_read_b64_tr_b16 v[80:81], v33 offset:37120
    ds_read_b64_tr_b16 v[82:83], v33 offset:39680
    ds_read_b128 v[36:39], v21 offset:0
    s_waitcnt lgkmcnt(9)
    v_mfma_f32_16x16x32_bf16 v[176:179], v[88:91], v[52:55], v[176:179]
    v_mfma_f32_16x16x32_bf16 v[180:183], v[88:91], v[56:59], v[180:183]
    v_mfma_f32_16x16x32_bf16 v[184:187], v[88:91], v[60:63], v[184:187]
    v_mfma_f32_16x16x32_bf16 v[188:191], v[88:91], v[64:67], v[188:191]
    ds_read_b64_tr_b16 v[84:85], v28 offset:0
    ds_read_b64_tr_b16 v[86:87], v28 offset:2560
    ds_read_b128 v[40:43], v21 offset:1024
    s_waitcnt lgkmcnt(10)
    v_mfma_f32_16x16x32_bf16 v[192:195], v[68:71], v[52:55], v[192:195]
    v_mfma_f32_16x16x32_bf16 v[196:199], v[68:71], v[56:59], v[196:199]
    v_mfma_f32_16x16x32_bf16 v[200:203], v[68:71], v[60:63], v[200:203]
    v_mfma_f32_16x16x32_bf16 v[204:207], v[68:71], v[64:67], v[204:207]
    ds_read_b64_tr_b16 v[88:89], v29 offset:0
    ds_read_b64_tr_b16 v[90:91], v29 offset:2560
    ds_read_b128 v[44:47], v21 offset:2048
    s_waitcnt lgkmcnt(11)
    v_mfma_f32_16x16x32_bf16 v[208:211], v[72:75], v[52:55], v[208:211]
    v_mfma_f32_16x16x32_bf16 v[212:215], v[72:75], v[56:59], v[212:215]
    v_mfma_f32_16x16x32_bf16 v[216:219], v[72:75], v[60:63], v[216:219]
    v_mfma_f32_16x16x32_bf16 v[220:223], v[72:75], v[64:67], v[220:223]
    ds_read_b64_tr_b16 v[68:69], v30 offset:0
    ds_read_b64_tr_b16 v[70:71], v30 offset:2560
    ds_read_b128 v[48:51], v21 offset:3072
    s_waitcnt lgkmcnt(12)
    v_mfma_f32_16x16x32_bf16 v[224:227], v[76:79], v[52:55], v[224:227]
    v_mfma_f32_16x16x32_bf16 v[228:231], v[76:79], v[56:59], v[228:231]
    v_mfma_f32_16x16x32_bf16 v[232:235], v[76:79], v[60:63], v[232:235]
    v_mfma_f32_16x16x32_bf16 v[236:239], v[76:79], v[64:67], v[236:239]
    ds_read_b64_tr_b16 v[72:73], v31 offset:0
    ds_read_b64_tr_b16 v[74:75], v31 offset:2560
    s_waitcnt lgkmcnt(12)
    v_mfma_f32_16x16x32_bf16 v[240:243], v[80:83], v[52:55], v[240:243]
    v_mfma_f32_16x16x32_bf16 v[244:247], v[80:83], v[56:59], v[244:247]
    v_mfma_f32_16x16x32_bf16 v[248:251], v[80:83], v[60:63], v[248:251]
    v_mfma_f32_16x16x32_bf16 v[252:255], v[80:83], v[64:67], v[252:255]
    s_waitcnt vmcnt(4)
    s_barrier
    ds_read_b64_tr_b16 v[76:77], v28 offset:128
    ds_read_b64_tr_b16 v[78:79], v28 offset:2688
    s_waitcnt lgkmcnt(4)
    v_mfma_f32_16x16x32_bf16 v[96:99], v[84:87], v[36:39], v[96:99]
    v_mfma_f32_16x16x32_bf16 v[100:103], v[84:87], v[40:43], v[100:103]
    v_mfma_f32_16x16x32_bf16 v[104:107], v[84:87], v[44:47], v[104:107]
    v_mfma_f32_16x16x32_bf16 v[108:111], v[84:87], v[48:51], v[108:111]
    s_add_u32 m0, s38, 110592
    s_nop 0
    buffer_load_dwordx4 v2, s[4:7], s40 offen lds
    ds_read_b64_tr_b16 v[80:81], v29 offset:128
    ds_read_b64_tr_b16 v[82:83], v29 offset:2688
    v_mfma_f32_16x16x32_bf16 v[112:115], v[88:91], v[36:39], v[112:115]
    v_mfma_f32_16x16x32_bf16 v[116:119], v[88:91], v[40:43], v[116:119]
    v_mfma_f32_16x16x32_bf16 v[120:123], v[88:91], v[44:47], v[120:123]
    v_mfma_f32_16x16x32_bf16 v[124:127], v[88:91], v[48:51], v[124:127]
    s_add_u32 m0, s38, 111616
    s_nop 0
    buffer_load_dwordx4 v3, s[4:7], s40 offen lds
    s_add_u32 s40, s40, 64
    ds_read_b64_tr_b16 v[84:85], v30 offset:128
    ds_read_b64_tr_b16 v[86:87], v30 offset:2688
    v_mfma_f32_16x16x32_bf16 v[128:131], v[68:71], v[36:39], v[128:131]
    v_mfma_f32_16x16x32_bf16 v[132:135], v[68:71], v[40:43], v[132:135]
    v_mfma_f32_16x16x32_bf16 v[136:139], v[68:71], v[44:47], v[136:139]
    v_mfma_f32_16x16x32_bf16 v[140:143], v[68:71], v[48:51], v[140:143]
    s_add_u32 m0, s39, 126976
    s_nop 0
    global_load_lds_dwordx4 v[6:7], off
    v_add_co_u32 v6, vcc, v6, v16
    s_nop 1
    v_addc_co_u32 v7, vcc, 0, v7, vcc
    ds_read_b64_tr_b16 v[88:89], v31 offset:128
    ds_read_b64_tr_b16 v[90:91], v31 offset:2688
    s_waitcnt lgkmcnt(8)
    v_mfma_f32_16x16x32_bf16 v[144:147], v[72:75], v[36:39], v[144:147]
    v_mfma_f32_16x16x32_bf16 v[148:151], v[72:75], v[40:43], v[148:151]
    v_mfma_f32_16x16x32_bf16 v[152:155], v[72:75], v[44:47], v[152:155]
    v_mfma_f32_16x16x32_bf16 v[156:159], v[72:75], v[48:51], v[156:159]
    s_add_u32 m0, s39, 135168
    s_nop 0
    global_load_lds_dwordx4 v[8:9], off
    v_add_co_u32 v8, vcc, v8, v17
    s_nop 1
    v_addc_co_u32 v9, vcc, 0, v9, vcc
    ds_read_b64_tr_b16 v[68:69], v28 offset:256
    ds_read_b64_tr_b16 v[70:71], v28 offset:2816
    s_waitcnt lgkmcnt(8)
    v_mfma_f32_16x16x32_bf16 v[160:163], v[76:79], v[36:39], v[160:163]
    v_mfma_f32_16x16x32_bf16 v[164:167], v[76:79], v[40:43], v[164:167]
    v_mfma_f32_16x16x32_bf16 v[168:171], v[76:79], v[44:47], v[168:171]
    v_mfma_f32_16x16x32_bf16 v[172:175], v[76:79], v[48:51], v[172:175]
    s_cmp_ge_u32 s24, 4
    s_cbranch_scc1 G1_sk7
    s_add_u32 m0, s39, 143360
    s_nop 0
    global_load_lds_dwordx4 v[10:11], off
    v_add_co_u32 v10, vcc, v10, v18
    s_nop 1
    v_addc_co_u32 v11, vcc, 0, v11, vcc
G1_sk7:
    ds_read_b64_tr_b16 v[72:73], v29 offset:256
    ds_read_b64_tr_b16 v[74:75], v29 offset:2816
    ds_read_b128 v[52:55], v21 offset:36864
    s_waitcnt lgkmcnt(9)
    v_mfma_f32_16x16x32_bf16 v[176:179], v[80:83], v[36:39], v[176:179]
    v_mfma_f32_16x16x32_bf16 v[180:183], v[80:83], v[40:43], v[180:183]
    v_mfma_f32_16x16x32_bf16 v[184:187], v[80:83], v[44:47], v[184:187]
    v_mfma_f32_16x16x32_bf16 v[188:191], v[80:83], v[48:51], v[188:191]
    ds_read_b64_tr_b16 v[76:77], v28 offset:36864
    ds_read_b64_tr_b16 v[78:79], v28 offset:39424
    ds_read_b128 v[56:59], v21 offset:37888
    s_waitcnt lgkmcnt(10)
    v_mfma_f32_16x16x32_bf16 v[192:195], v[84:87], v[36:39], v[192:195]
    v_mfma_f32_16x16x32_bf16 v[196:199], v[84:87], v[40:43], v[196:199]
    v_mfma_f32_16x16x32_bf16 v[200:203], v[84:87], v[44:47], v[200:203]
    v_mfma_f32_16x16x32_bf16 v[204:207], v[84:87], v[48:51], v[204:207]
    ds_read_b64_tr_b16 v[80:81], v29 offset:36864
    ds_read_b64_tr_b16 v[82:83], v29 offset:39424
    ds_read_b128 v[60:63], v21 offset:38912
    s_waitcnt lgkmcnt(11)
    v_mfma_f32_16x16x32_bf16 v[208:211], v[88:91], v[36:39], v[208:211]
    v_mfma_f32_16x16x32_bf16 v[212:215], v[88:91], v[40:43], v[212:215]
    v_mfma_f32_16x16x32_bf16 v[216:219], v[88:91], v[44:47], v[216:219]
    v_mfma_f32_16x16x32_bf16 v[220:223], v[88:91], v[48:51], v[220:223]
    ds_read_b64_tr_b16 v[84:85], v30 offset:36864
    ds_read_b64_tr_b16 v[86:87], v30 offset:39424
    ds_read_b128 v[64:67], v21 offset:39936
    s_waitcnt lgkmcnt(12)
    v_mfma_f32_16x16x32_bf16 v[224:227], v[68:71], v[36:39], v[224:227]
    v_mfma_f32_16x16x32_bf16 v[228:231], v[68:71], v[40:43], v[228:231]
    v_mfma_f32_16x16x32_bf16 v[232:235], v[68:71], v[44:47], v[232:235]
    v_mfma_f32_16x16x32_bf16 v[236:239], v[68:71], v[48:51], v[236:239]
    ds_read_b64_tr_b16 v[88:89], v31 offset:36864
    ds_read_b64_tr_b16 v[90:91], v31 offset:39424
    s_waitcnt lgkmcnt(12)
    v_mfma_f32_16x16x32_bf16 v[240:243], v[72:75], v[36:39], v[240:243]
    v_mfma_f32_16x16x32_bf16 v[244:247], v[72:75], v[40:43], v[244:247]
    v_mfma_f32_16x16x32_bf16 v[248:251], v[72:75], v[44:47], v[248:251]
    v_mfma_f32_16x16x32_bf16 v[252:255], v[72:75], v[48:51], v[252:255]
    s_waitcnt vmcnt(4)
    s_barrier
    ds_read_b64_tr_b16 v[68:69], v28 offset:36992
    ds_read_b64_tr_b16 v[70:71], v28 offset:39552
    s_waitcnt lgkmcnt(4)
    v_mfma_f32_16x16x32_bf16 v[96:99], v[76:79], v[52:55], v[96:99]
    v_mfma_f32_16x16x32_bf16 v[100:103], v[76:79], v[56:59], v[100:103]
    v_mfma_f32_16x16x32_bf16 v[104:107], v[76:79], v[60:63], v[104:107]
    v_mfma_f32_16x16x32_bf16 v[108:111], v[76:79], v[64:67], v[108:111]
    s_add_u32 m0, s38, 0
    s_nop 0
    buffer_load_dwordx4 v2, s[4:7], s40 offen lds
    ds_read_b64_tr_b16 v[72:73], v29 offset:36992
    ds_read_b64_tr_b16 v[74:75], v29 offset:39552
    v_mfma_f32_16x16x32_bf16 v[112:115], v[80:83], v[52:55], v[112:115]
    v_mfma_f32_16x16x32_bf16 v[116:119], v[80:83], v[56:59], v[116:119]
    v_mfma_f32_16x16x32_bf16 v[120:123], v[80:83], v[60:63], v[120:123]
    v_mfma_f32_16x16x32_bf16 v[124:127], v[80:83], v[64:67], v[124:127]
    s_add_u32 m0, s38, 1024
    s_nop 0
    buffer_load_dwordx4 v3, s[4:7], s40 offen lds
    s_add_u32 s40, s40, 64
    ds_read_b64_tr_b16 v[76:77], v30 offset:36992
    ds_read_b64_tr_b16 v[78:79], v30 offset:39552
    v_mfma_f32_16x16x32_bf16 v[128:131], v[84:87], v[52:55], v[128:131]
    v_mfma_f32_16x16x32_bf16 v[132:135], v[84:87], v[56:59], v[132:135]
    v_mfma_f32_16x16x32_bf16 v[136:139], v[84:87], v[60:63], v[136:139]
    v_mfma_f32_16x16x32_bf16 v[140:143], v[84:87], v[64:67], v[140:143]
    s_add_u32 m0, s39, 16384
    s_nop 0
    global_load_lds_dwordx4 v[6:7], off
    v_add_co_u32 v6, vcc, v6, v16
    s_nop 1
    v_addc_co_u32 v7, vcc, 0, v7, vcc
    ds_read_b64_tr_b16 v[80:81], v31 offset:36992
    ds_read_b64_tr_b16 v[82:83], v31 offset:39552
    s_waitcnt lgkmcnt(8)
    v_mfma_f32_16x16x32_bf16 v[144:147], v[88:91], v[52:55], v[144:147]
    v_mfma_f32_16x16x32_bf16 v[148:151], v[88:91], v[56:59], v[148:151]
    v_mfma_f32_16x16x32_bf16 v[152:155], v[88:91], v[60:63], v[152:155]
    v_mfma_f32_16x16x32_bf16 v[156:159], v[88:91], v[64:67], v[156:159]
    s_add_u32 m0, s39, 24576
    s_nop 0
    global_load_lds_dwordx4 v[8:9], off
    v_add_co_u32 v8, vcc, v8, v17
    s_nop 1
    v_addc_co_u32 v9, vcc, 0, v9, vcc
    ds_read_b64_tr_b16 v[84:85], v28 offset:37120
    ds_read_b64_tr_b16 v[86:87], v28 offset:39680
    s_waitcnt lgkmcnt(8)
    v_mfma_f32_16x16x32_bf16 v[160:163], v[68:71], v[52:55], v[160:163]
    v_mfma_f32_16x16x32_bf16 v[164:167], v[68:71], v[56:59], v[164:167]
    v_mfma_f32_16x16x32_bf16 v[168:171], v[68:71], v[60:63], v[168:171]
    v_mfma_f32_16x16x32_bf16 v[172:175], v[68:71], v[64:67], v[172:175]
    s_cmp_ge_u32 s24, 4
    s_cbranch_scc1 G1_sk8
    s_add_u32 m0, s39, 32768
    s_nop 0
    global_load_lds_dwordx4 v[10:11], off
    v_add_co_u32 v10, vcc, v10, v18
    s_nop 1
    v_addc_co_u32 v11, vcc, 0, v11, vcc
G1_sk8:
    ds_read_b64_tr_b16 v[88:89], v29 offset:37120
    ds_read_b64_tr_b16 v[90:91], v29 offset:39680
    ds_read_b128 v[36:39], v22 offset:0
    s_waitcnt lgkmcnt(9)
    v_mfma_f32_16x16x32_bf16 v[176:179], v[72:75], v[52:55], v[176:179]
    v_mfma_f32_16x16x32_bf16 v[180:183], v[72:75], v[56:59], v[180:183]
    v_mfma_f32_16x16x32_bf16 v[184:187], v[72:75], v[60:63], v[184:187]
    v_mfma_f32_16x16x32_bf16 v[188:191], v[72:75], v[64:67], v[188:191]
    ds_read_b64_tr_b16 v[68:69], v32 offset:0
    ds_read_b64_tr_b16 v[70:71], v32 offset:2560
    ds_read_b128 v[40:43], v22 offset:1024
    s_waitcnt lgkmcnt(10)
    v_mfma_f32_16x16x32_bf16 v[192:195], v[76:79], v[52:55], v[192:195]
    v_mfma_f32_16x16x32_bf16 v[196:199], v[76:79], v[56:59], v[196:199]
    v_mfma_f32_16x16x32_bf16 v[200:203], v[76:79], v[60:63], v[200:203]
    v_mfma_f32_16x16x32_bf16 v[204:207], v[76:79], v[64:67], v[204:207]
    ds_read_b64_tr_b16 v[72:73], v33 offset:0
    ds_read_b64_tr_b16 v[74:75], v33 offset:2560
    ds_read_b128 v[44:47], v22 offset:2048
    s_waitcnt lgkmcnt(11)
    v_mfma_f32_16x16x32_bf16 v[208:211], v[80:83], v[52:55], v[208:211]
    v_mfma_f32_16x16x32_bf16 v[212:215], v[80:83], v[56:59], v[212:215]
    v_mfma_f32_16x16x32_bf16 v[216:219], v[80:83], v[60:63], v[216:219]
    v_mfma_f32_16x16x32_bf16 v[220:223], v[80:83], v[64:67], v[220:223]
    ds_read_b64_tr_b16 v[76:77], v34 offset:0
    ds_read_b64_tr_b16 v[78:79], v34 offset:2560
    ds_read_b128 v[48:51], v22 offset:3072
    s_waitcnt lgkmcnt(12)
    v_mfma_f32_16x16x32_bf16 v[224:227], v[84:87], v[52:55], v[224:227]
    v_mfma_f32_16x16x32_bf16 v[228:231], v[84:87], v[56:59], v[228:231]
    v_mfma_f32_16x16x32_bf16 v[232:235], v[84:87], v[60:63], v[232:235]
    v_mfma_f32_16x16x32_bf16 v[236:239], v[84:87], v[64:67], v[236:239]
    ds_read_b64_tr_b16 v[80:81], v35 offset:0
    ds_read_b64_tr_b16 v[82:83], v35 offset:2560
    s_waitcnt lgkmcnt(12)
    v_mfma_f32_16x16x32_bf16 v[240:243], v[88:91], v[52:55], v[240:243]
    v_mfma_f32_16x16x32_bf16 v[244:247], v[88:91], v[56:59], v[244:247]
    v_mfma_f32_16x16x32_bf16 v[248:251], v[88:91], v[60:63], v[248:251]
    v_mfma_f32_16x16x32_bf16 v[252:255], v[88:91], v[64:67], v[252:255]
    s_waitcnt vmcnt(4)
    s_barrier
    ds_read_b64_tr_b16 v[84:85], v32 offset:128
    ds_read_b64_tr_b16 v[86:87], v32 offset:2688
    s_waitcnt lgkmcnt(4)
    v_mfma_f32_16x16x32_bf16 v[96:99], v[68:71], v[36:39], v[96:99]
    v_mfma_f32_16x16x32_bf16 v[100:103], v[68:71], v[40:43], v[100:103]
    v_mfma_f32_16x16x32_bf16 v[104:107], v[68:71], v[44:47], v[104:107]
    v_mfma_f32_16x16x32_bf16 v[108:111], v[68:71], v[48:51], v[108:111]
    s_add_u32 m0, s38, 36864
    s_nop 0
    buffer_load_dwordx4 v2, s[4:7], s40 offen lds
    ds_read_b64_tr_b16 v[88:89], v33 offset:128
    ds_read_b64_tr_b16 v[90:91], v33 offset:2688
    v_mfma_f32_16x16x32_bf16 v[112:115], v[72:75], v[36:39], v[112:115]
    v_mfma_f32_16x16x32_bf16 v[116:119], v[72:75], v[40:43], v[116:119]
    v_mfma_f32_16x16x32_bf16 v[120:123], v[72:75], v[44:47], v[120:123]
    v_mfma_f32_16x16x32_bf16 v[124:127], v[72:75], v[48:51], v[124:127]
    s_add_u32 m0, s38, 37888
    s_nop 0
    buffer_load_dwordx4 v3, s[4:7], s40 offen lds
    s_add_u32 s40, s40, 64
    ds_read_b64_tr_b16 v[68:69], v34 offset:128
    ds_read_b64_tr_b16 v[70:71], v34 offset:2688
    v_mfma_f32_16x16x32_bf16 v[128:131], v[76:79], v[36:39], v[128:131]
    v_mfma_f32_16x16x32_bf16 v[132:135], v[76:79], v[40:43], v[132:135]
    v_mfma_f32_16x16x32_bf16 v[136:139], v[76:79], v[44:47], v[136:139]
    v_mfma_f32_16x16x32_bf16 v[140:143], v[76:79], v[48:51], v[140:143]
    s_add_u32 m0, s39, 53248
    s_nop 0
    global_load_lds_dwordx4 v[6:7], off
    v_add_co_u32 v6, vcc, v6, v16
    s_nop 1
    v_addc_co_u32 v7, vcc, 0, v7, vcc
    ds_read_b64_tr_b16 v[72:73], v35 offset:128
    ds_read_b64_tr_b16 v[74:75], v35 offset:2688
    s_waitcnt lgkmcnt(8)
    v_mfma_f32_16x16x32_bf16 v[144:147], v[80:83], v[36:39], v[144:147]
    v_mfma_f32_16x16x32_bf16 v[148:151], v[80:83], v[40:43], v[148:151]
    v_mfma_f32_16x16x32_bf16 v[152:155], v[80:83], v[44:47], v[152:155]
    v_mfma_f32_16x16x32_bf16 v[156:159], v[80:83], v[48:51], v[156:159]
    s_add_u32 m0, s39, 61440
    s_nop 0
    global_load_lds_dwordx4 v[8:9], off
    v_add_co_u32 v8, vcc, v8, v17
    s_nop 1
    v_addc_co_u32 v9, vcc, 0, v9, vcc
    ds_read_b64_tr_b16 v[76:77], v32 offset:256
    ds_read_b64_tr_b16 v[78:79], v32 offset:2816
    s_waitcnt lgkmcnt(8)
    v_mfma_f32_16x16x32_bf16 v[160:163], v[84:87], v[36:39], v[160:163]
    v_mfma_f32_16x16x32_bf16 v[164:167], v[84:87], v[40:43], v[164:167]
    v_mfma_f32_16x16x32_bf16 v[168:171], v[84:87], v[44:47], v[168:171]
    v_mfma_f32_16x16x32_bf16 v[172:175], v[84:87], v[48:51], v[172:175]
    s_cmp_ge_u32 s24, 4
    s_cbranch_scc1 G1_sk9
    s_add_u32 m0, s39, 69632
    s_nop 0
    global_load_lds_dwordx4 v[10:11], off
    v_add_co_u32 v10, vcc, v10, v18
    s_nop 1
    v_addc_co_u32 v11, vcc, 0, v11, vcc
G1_sk9:
    ds_read_b64_tr_b16 v[80:81], v33 offset:256
    ds_read_b64_tr_b16 v[82:83], v33 offset:2816
    ds_read_b128 v[52:55], v22 offset:36864
    s_waitcnt lgkmcnt(9)
    v_mfma_f32_16x16x32_bf16 v[176:179], v[88:91], v[36:39], v[176:179]
    v_mfma_f32_16x16x32_bf16 v[180:183], v[88:91], v[40:43], v[180:183]
    v_mfma_f32_16x16x32_bf16 v[184:187], v[88:91], v[44:47], v[184:187]
    v_mfma_f32_16x16x32_bf16 v[188:191], v[88:91], v[48:51], v[188:191]
    ds_read_b64_tr_b16 v[84:85], v32 offset:36864
    ds_read_b64_tr_b16 v[86:87], v32 offset:39424
    ds_read_b128 v[56:59], v22 offset:37888
    s_waitcnt lgkmcnt(10)
    v_mfma_f32_16x16x32_bf16 v[192:195], v[68:71], v[36:39], v[192:195]
    v_mfma_f32_16x16x32_bf16 v[196:199], v[68:71], v[40:43], v[196:199]
    v_mfma_f32_16x16x32_bf16 v[200:203], v[68:71], v[44:47], v[200:203]
    v_mfma_f32_16x16x32_bf16 v[204:207], v[68:71], v[48:51], v[204:207]
    ds_read_b64_tr_b16 v[88:89], v33 offset:36864
    ds_read_b64_tr_b16 v[90:91], v33 offset:39424
    ds_read_b128 v[60:63], v22 offset:38912
    s_waitcnt lgkmcnt(11)
    v_mfma_f32_16x16x32_bf16 v[208:211], v[72:75], v[36:39], v[208:211]
    v_mfma_f32_16x16x32_bf16 v[212:215], v[72:75], v[40:43], v[212:215]
    v_mfma_f32_16x16x32_bf16 v[216:219], v[72:75], v[44:47], v[216:219]
    v_mfma_f32_16x16x32_bf16 v[220:223], v[72:75], v[48:51], v[220:223]
    ds_read_b64_tr_b16 v[68:69], v34 offset:36864
    ds_read_b64_tr_b16 v[70:71], v34 offset:39424
    ds_read_b128 v[64:67], v22 offset:39936
    s_waitcnt lgkmcnt(12)
    v_mfma_f32_16x16x32_bf16 v[224:227], v[76:79], v[36:39], v[224:227]
    v_mfma_f32_16x16x32_bf16 v[228:231], v[76:79], v[40:43], v[228:231]
    v_mfma_f32_16x16x32_bf16 v[232:235], v[76:79], v[44:47], v[232:235]
    v_mfma_f32_16x16x32_bf16 v[236:239], v[76:79], v[48:51], v[236:239]
    ds_read_b64_tr_b16 v[72:73], v35 offset:36864
    ds_read_b64_tr_b16 v[74:75], v35 offset:39424
    s_waitcnt lgkmcnt(12)
    v_mfma_f32_16x16x32_bf16 v[240:243], v[80:83], v[36:39], v[240:243]
    v_mfma_f32_16x16x32_bf16 v[244:247], v[80:83], v[40:43], v[244:247]
    v_mfma_f32_16x16x32_bf16 v[248:251], v[80:83], v[44:47], v[248:251]
    v_mfma_f32_16x16x32_bf16 v[252:255], v[80:83], v[48:51], v[252:255]
    s_waitcnt vmcnt(4)
    s_barrier
    ds_read_b64_tr_b16 v[76:77], v32 offset:36992
    ds_read_b64_tr_b16 v[78:79], v32 offset:39552
    s_waitcnt lgkmcnt(4)
    v_mfma_f32_16x16x32_bf16 v[96:99], v[84:87], v[52:55], v[96:99]
    v_mfma_f32_16x16x32_bf16 v[100:103], v[84:87], v[56:59], v[100:103]
    v_mfma_f32_16x16x32_bf16 v[104:107], v[84:87], v[60:63], v[104:107]
    v_mfma_f32_16x16x32_bf16 v[108:111], v[84:87], v[64:67], v[108:111]
    s_add_u32 m0, s38, 73728
    s_nop 0
    buffer_load_dwordx4 v2, s[4:7], s40 offen lds
    ds_read_b64_tr_b16 v[80:81], v33 offset:36992
    ds_read_b64_tr_b16 v[82:83], v33 offset:39552
    v_mfma_f32_16x16x32_bf16 v[112:115], v[88:91], v[52:55], v[112:115]
    v_mfma_f32_16x16x32_bf16 v[116:119], v[88:91], v[56:59], v[116:119]
    v_mfma_f32_16x16x32_bf16 v[120:123], v[88:91], v[60:63], v[120:123]
    v_mfma_f32_16x16x32_bf16 v[124:127], v[88:91], v[64:67], v[124:127]
    s_add_u32 m0, s38, 74752
    s_nop 0
    buffer_load_dwordx4 v3, s[4:7], s40 offen lds
    s_add_u32 s40, s40, 64
    ds_read_b64_tr_b16 v[84:85], v34 offset:36992
    ds_read_b64_tr_b16 v[86:87], v34 offset:39552
    v_mfma_f32_16x16x32_bf16 v[128:131], v[68:71], v[52:55], v[128:131]
    v_mfma_f32_16x16x32_bf16 v[132:135], v[68:71], v[56:59], v[132:135]
    v_mfma_f32_16x16x32_bf16 v[136:139], v[68:71], v[60:63], v[136:139]
    v_mfma_f32_16x16x32_bf16 v[140:143], v[68:71], v[64:67], v[140:143]
    s_add_u32 m0, s39, 90112
    s_nop 0
    global_load_lds_dwordx4 v[6:7], off
    v_add_co_u32 v6, vcc, v6, v16
    s_nop 1
    v_addc_co_u32 v7, vcc, 0, v7, vcc
    ds_read_b64_tr_b16 v[88:89], v35 offset:36992
    ds_read_b64_tr_b16 v[90:91], v35 offset:39552
    s_waitcnt lgkmcnt(8)
    v_mfma_f32_16x16x32_bf16 v[144:147], v[72:75], v[52:55], v[144:147]
    v_mfma_f32_16x16x32_bf16 v[148:151], v[72:75], v[56:59], v[148:151]
    v_mfma_f32_16x16x32_bf16 v[152:155], v[72:75], v[60:63], v[152:155]
    v_mfma_f32_16x16x32_bf16 v[156:159], v[72:75], v[64:67], v[156:159]
    s_add_u32 m0, s39, 98304
    s_nop 0
    global_load_lds_dwordx4 v[8:9], off
    v_add_co_u32 v8, vcc, v8, v17
    s_nop 1
    v_addc_co_u32 v9, vcc, 0, v9, vcc
    ds_read_b64_tr_b16 v[68:69], v32 offset:37120
    ds_read_b64_tr_b16 v[70:71], v32 offset:39680
    s_waitcnt lgkmcnt(8)
    v_mfma_f32_16x16x32_bf16 v[160:163], v[76:79], v[52:55], v[160:163]
    v_mfma_f32_16x16x32_bf16 v[164:167], v[76:79], v[56:59], v[164:167]
    v_mfma_f32_16x16x32_bf16 v[168:171], v[76:79], v[60:63], v[168:171]
    v_mfma_f32_16x16x32_bf16 v[172:175], v[76:79], v[64:67], v[172:175]
    s_cmp_ge_u32 s24, 4
    s_cbranch_scc1 G1_sk10
    s_add_u32 m0, s39, 106496
    s_nop 0
    global_load_lds_dwordx4 v[10:11], off
    v_add_co_u32 v10, vcc, v10, v18
    s_nop 1
    v_addc_co_u32 v11, vcc, 0, v11, vcc
G1_sk10:
    ds_read_b64_tr_b16 v[72:73], v33 offset:37120
    ds_read_b64_tr_b16 v[74:75], v33 offset:39680
    ds_read_b128 v[36:39], v21 offset:0
    s_waitcnt lgkmcnt(9)
    v_mfma_f32_16x16x32_bf16 v[176:179], v[80:83], v[52:55], v[176:179]
    v_mfma_f32_16x16x32_bf16 v[180:183], v[80:83], v[56:59], v[180:183]
    v_mfma_f32_16x16x32_bf16 v[184:187], v[80:83], v[60:63], v[184:187]
    v_mfma_f32_16x16x32_bf16 v[188:191], v[80:83], v[64:67], v[188:191]
    ds_read_b64_tr_b16 v[76:77], v28 offset:0
    ds_read_b64_tr_b16 v[78:79], v28 offset:2560
    ds_read_b128 v[40:43], v21 offset:1024
    s_waitcnt lgkmcnt(10)
    v_mfma_f32_16x16x32_bf16 v[192:195], v[84:87], v[52:55], v[192:195]
    v_mfma_f32_16x16x32_bf16 v[196:199], v[84:87], v[56:59], v[196:199]
    v_mfma_f32_16x16x32_bf16 v[200:203], v[84:87], v[60:63], v[200:203]
    v_mfma_f32_16x16x32_bf16 v[204:207], v[84:87], v[64:67], v[204:207]
    ds_read_b64_tr_b16 v[80:81], v29 offset:0
    ds_read_b64_tr_b16 v[82:83], v29 offset:2560
    ds_read_b128 v[44:47], v21 offset:2048
    s_waitcnt lgkmcnt(11)
    v_mfma_f32_16x16x32_bf16 v[208:211], v[88:91], v[52:55], v[208:211]
    v_mfma_f32_16x16x32_bf16 v[212:215], v[88:91], v[56:59], v[212:215]
    v_mfma_f32_16x16x32_bf16 v[216:219], v[88:91], v[60:63], v[216:219]
    v_mfma_f32_16x16x32_bf16 v[220:223], v[88:91], v[64:67], v[220:223]
    ds_read_b64_tr_b16 v[84:85], v30 offset:0
    ds_read_b64_tr_b16 v[86:87], v30 offset:2560
    ds_read_b128 v[48:51], v21 offset:3072
    s_waitcnt lgkmcnt(12)
    v_mfma_f32_16x16x32_bf16 v[224:227], v[68:71], v[52:55], v[224:227]
    v_mfma_f32_16x16x32_bf16 v[228:231], v[68:71], v[56:59], v[228:231]
    v_mfma_f32_16x16x32_bf16 v[232:235], v[68:71], v[60:63], v[232:235]
    v_mfma_f32_16x16x32_bf16 v[236:239], v[68:71], v[64:67], v[236:239]
    ds_read_b64_tr_b16 v[88:89], v31 offset:0
    ds_read_b64_tr_b16 v[90:91], v31 offset:2560
    s_waitcnt lgkmcnt(12)
    v_mfma_f32_16x16x32_bf16 v[240:243], v[72:75], v[52:55], v[240:243]
    v_mfma_f32_16x16x32_bf16 v[244:247], v[72:75], v[56:59], v[244:247]
    v_mfma_f32_16x16x32_bf16 v[248:251], v[72:75], v[60:63], v[248:251]
    v_mfma_f32_16x16x32_bf16 v[252:255], v[72:75], v[64:67], v[252:255]
    s_waitcnt vmcnt(4)
    s_barrier
    ds_read_b64_tr_b16 v[68:69], v28 offset:128
    ds_read_b64_tr_b16 v[70:71], v28 offset:2688
    s_waitcnt lgkmcnt(4)
    v_mfma_f32_16x16x32_bf16 v[96:99], v[76:79], v[36:39], v[96:99]
    v_mfma_f32_16x16x32_bf16 v[100:103], v[76:79], v[40:43], v[100:103]
    v_mfma_f32_16x16x32_bf16 v[104:107], v[76:79], v[44:47], v[104:107]
    v_mfma_f32_16x16x32_bf16 v[108:111], v[76:79], v[48:51], v[108:111]
    s_add_u32 m0, s38, 110592
    s_nop 0
    buffer_load_dwordx4 v2, s[4:7], s40 offen lds
    ds_read_b64_tr_b16 v[72:73], v29 offset:128
    ds_read_b64_tr_b16 v[74:75], v29 offset:2688
    v_mfma_f32_16x16x32_bf16 v[112:115], v[80:83], v[36:39], v[112:115]
    v_mfma_f32_16x16x32_bf16 v[116:119], v[80:83], v[40:43], v[116:119]
    v_mfma_f32_16x16x32_bf16 v[120:123], v[80:83], v[44:47], v[120:123]
    v_mfma_f32_16x16x32_bf16 v[124:127], v[80:83], v[48:51], v[124:127]
    s_add_u32 m0, s38, 111616
    s_nop 0
    buffer_load_dwordx4 v3, s[4:7], s40 offen lds
    s_add_u32 s40, s40, 64
    ds_read_b64_tr_b16 v[76:77], v30 offset:128
    ds_read_b64_tr_b16 v[78:79], v30 offset:2688
    v_mfma_f32_16x16x32_bf16 v[128:131], v[84:87], v[36:39], v[128:131]
    v_mfma_f32_16x16x32_bf16 v[132:135], v[84:87], v[40:43], v[132:135]
    v_mfma_f32_16x16x32_bf16 v[136:139], v[84:87], v[44:47], v[136:139]
    v_mfma_f32_16x16x32_bf16 v[140:143], v[84:87], v[48:51], v[140:143]
    s_add_u32 m0, s39, 126976
    s_nop 0
    global_load_lds_dwordx4 v[6:7], off
    v_add_co_u32 v6, vcc, v6, v16
    s_nop 1
    v_addc_co_u32 v7, vcc, 0, v7, vcc
    ds_read_b64_tr_b16 v[80:81], v31 offset:128
    ds_read_b64_tr_b16 v[82:83], v31 offset:2688
    s_waitcnt lgkmcnt(8)
    v_mfma_f32_16x16x32_bf16 v[144:147], v[88:91], v[36:39], v[144:147]
    v_mfma_f32_16x16x32_bf16 v[148:151], v[88:91], v[40:43], v[148:151]
    v_mfma_f32_16x16x32_bf16 v[152:155], v[88:91], v[44:47], v[152:155]
    v_mfma_f32_16x16x32_bf16 v[156:159], v[88:91], v[48:51], v[156:159]
    s_add_u32 m0, s39, 135168
    s_nop 0
    global_load_lds_dwordx4 v[8:9], off
    v_add_co_u32 v8, vcc, v8, v17
    s_nop 1
    v_addc_co_u32 v9, vcc, 0, v9, vcc
    ds_read_b64_tr_b16 v[84:85], v28 offset:256
    ds_read_b64_tr_b16 v[86:87], v28 offset:2816
    s_waitcnt lgkmcnt(8)
    v_mfma_f32_16x16x32_bf16 v[160:163], v[68:71], v[36:39], v[160:163]
    v_mfma_f32_16x16x32_bf16 v[164:167], v[68:71], v[40:43], v[164:167]
    v_mfma_f32_16x16x32_bf16 v[168:171], v[68:71], v[44:47], v[168:171]
    v_mfma_f32_16x16x32_bf16 v[172:175], v[68:71], v[48:51], v[172:175]
    s_cmp_ge_u32 s24, 4
    s_cbranch_scc1 G1_sk11
    s_add_u32 m0, s39, 143360
    s_nop 0
    global_load_lds_dwordx4 v[10:11], off
    v_add_co_u32 v10, vcc, v10, v18
    s_nop 1
    v_addc_co_u32 v11, vcc, 0, v11, vcc
G1_sk11:
    ds_read_b64_tr_b16 v[88:89], v29 offset:256
    ds_read_b64_tr_b16 v[90:91], v29 offset:2816
    ds_read_b128 v[52:55], v21 offset:36864
    s_waitcnt lgkmcnt(9)
    v_mfma_f32_16x16x32_bf16 v[176:179], v[72:75], v[36:39], v[176:179]
    v_mfma_f32_16x16x32_bf16 v[180:183], v[72:75], v[40:43], v[180:183]
    v_mfma_f32_16x16x32_bf16 v[184:187], v[72:75], v[44:47], v[184:187]
    v_mfma_f32_16x16x32_bf16 v[188:191], v[72:75], v[48:51], v[188:191]
    ds_read_b64_tr_b16 v[68:69], v28 offset:36864
    ds_read_b64_tr_b16 v[70:71], v28 offset:39424
    ds_read_b128 v[56:59], v21 offset:37888
    s_waitcnt lgkmcnt(10)
    v_mfma_f32_16x16x32_bf16 v[192:195], v[76:79], v[36:39], v[192:195]
    v_mfma_f32_16x16x32_bf16 v[196:199], v[76:79], v[40:43], v[196:199]
    v_mfma_f32_16x16x32_bf16 v[200:203], v[76:79], v[44:47], v[200:203]
    v_mfma_f32_16x16x32_bf16 v[204:207], v[76:79], v[48:51], v[204:207]
    ds_read_b64_tr_b16 v[72:73], v29 offset:36864
    ds_read_b64_tr_b16 v[74:75], v29 offset:39424
    ds_read_b128 v[60:63], v21 offset:38912
    s_waitcnt lgkmcnt(11)
    v_mfma_f32_16x16x32_bf16 v[208:211], v[80:83], v[36:39], v[208:211]
    v_mfma_f32_16x16x32_bf16 v[212:215], v[80:83], v[40:43], v[212:215]
    v_mfma_f32_16x16x32_bf16 v[216:219], v[80:83], v[44:47], v[216:219]
    v_mfma_f32_16x16x32_bf16 v[220:223], v[80:83], v[48:51], v[220:223]
    ds_read_b64_tr_b16 v[76:77], v30 offset:36864
    ds_read_b64_tr_b16 v[78:79], v30 offset:39424
    ds_read_b128 v[64:67], v21 offset:39936
    s_waitcnt lgkmcnt(12)
    v_mfma_f32_16x16x32_bf16 v[224:227], v[84:87], v[36:39], v[224:227]
    v_mfma_f32_16x16x32_bf16 v[228:231], v[84:87], v[40:43], v[228:231]
    v_mfma_f32_16x16x32_bf16 v[232:235], v[84:87], v[44:47], v[232:235]
    v_mfma_f32_16x16x32_bf16 v[236:239], v[84:87], v[48:51], v[236:239]
    ds_read_b64_tr_b16 v[80:81], v31 offset:36864
    ds_read_b64_tr_b16 v[82:83], v31 offset:39424
    s_waitcnt lgkmcnt(12)
    v_mfma_f32_16x16x32_bf16 v[240:243], v[88:91], v[36:39], v[240:243]
    v_mfma_f32_16x16x32_bf16 v[244:247], v[88:91], v[40:43], v[244:247]
    v_mfma_f32_16x16x32_bf16 v[248:251], v[88:91], v[44:47], v[248:251]
    v_mfma_f32_16x16x32_bf16 v[252:255], v[88:91], v[48:51], v[252:255]
    s_waitcnt vmcnt(4)
    s_barrier
    ds_read_b64_tr_b16 v[84:85], v28 offset:36992
    ds_read_b64_tr_b16 v[86:87], v28 offset:39552
    s_waitcnt lgkmcnt(4)
    v_mfma_f32_16x16x32_bf16 v[96:99], v[68:71], v[52:55], v[96:99]
    v_mfma_f32_16x16x32_bf16 v[100:103], v[68:71], v[56:59], v[100:103]
    v_mfma_f32_16x16x32_bf16 v[104:107], v[68:71], v[60:63], v[104:107]
    v_mfma_f32_16x16x32_bf16 v[108:111], v[68:71], v[64:67], v[108:111]
    s_add_u32 m0, s38, 0
    s_nop 0
    buffer_load_dwordx4 v2, s[4:7], s40 offen lds
    ds_read_b64_tr_b16 v[88:89], v29 offset:36992
    ds_read_b64_tr_b16 v[90:91], v29 offset:39552
    v_mfma_f32_16x16x32_bf16 v[112:115], v[72:75], v[52:55], v[112:115]
    v_mfma_f32_16x16x32_bf16 v[116:119], v[72:75], v[56:59], v[116:119]
    v_mfma_f32_16x16x32_bf16 v[120:123], v[72:75], v[60:63], v[120:123]
    v_mfma_f32_16x16x32_bf16 v[124:127], v[72:75], v[64:67], v[124:127]
    s_add_u32 m0, s38, 1024
    s_nop 0
    buffer_load_dwordx4 v3, s[4:7], s40 offen lds
    s_add_u32 s40, s40, 64
    ds_read_b64_tr_b16 v[68:69], v30 offset:36992
    ds_read_b64_tr_b16 v[70:71], v30 offset:39552
    v_mfma_f32_16x16x32_bf16 v[128:131], v[76:79], v[52:55], v[128:131]
    v_mfma_f32_16x16x32_bf16 v[132:135], v[76:79], v[56:59], v[132:135]
    v_mfma_f32_16x16x32_bf16 v[136:139], v[76:79], v[60:63], v[136:139]
    v_mfma_f32_16x16x32_bf16 v[140:143], v[76:79], v[64:67], v[140:143]
    s_add_u32 m0, s39, 16384
    s_nop 0
    global_load_lds_dwordx4 v[6:7], off
    v_add_co_u32 v6, vcc, v6, v16
    s_nop 1
    v_addc_co_u32 v7, vcc, 0, v7, vcc
    ds_read_b64_tr_b16 v[72:73], v31 offset:36992
    ds_read_b64_tr_b16 v[74:75], v31 offset:39552
    s_waitcnt lgkmcnt(8)
    v_mfma_f32_16x16x32_bf16 v[144:147], v[80:83], v[52:55], v[144:147]
    v_mfma_f32_16x16x32_bf16 v[148:151], v[80:83], v[56:59], v[148:151]
    v_mfma_f32_16x16x32_bf16 v[152:155], v[80:83], v[60:63], v[152:155]
    v_mfma_f32_16x16x32_bf16 v[156:159], v[80:83], v[64:67], v[156:159]
    s_add_u32 m0, s39, 24576
    s_nop 0
    global_load_lds_dwordx4 v[8:9], off
    v_add_co_u32 v8, vcc, v8, v17
    s_nop 1
    v_addc_co_u32 v9, vcc, 0, v9, vcc
    ds_read_b64_tr_b16 v[76:77], v28 offset:37120
    ds_read_b64_tr_b16 v[78:79], v28 offset:39680
    s_waitcnt lgkmcnt(8)
    v_mfma_f32_16x16x32_bf16 v[160:163], v[84:87], v[52:55], v[160:163]
    v_mfma_f32_16x16x32_bf16 v[164:167], v[84:87], v[56:59], v[164:167]
    v_mfma_f32_16x16x32_bf16 v[168:171], v[84:87], v[60:63], v[168:171]
    v_mfma_f32_16x16x32_bf16 v[172:175], v[84:87], v[64:67], v[172:175]
    s_cmp_ge_u32 s24, 4
    s_cbranch_scc1 G1_sk12
    s_add_u32 m0, s39, 32768
    s_nop 0
    global_load_lds_dwordx4 v[10:11], off
    v_add_co_u32 v10, vcc, v10, v18
    s_nop 1
    v_addc_co_u32 v11, vcc, 0, v11, vcc
G1_sk12:
    ds_read_b64_tr_b16 v[80:81], v29 offset:37120
    ds_read_b64_tr_b16 v[82:83], v29 offset:39680
    ds_read_b128 v[36:39], v22 offset:0
    s_waitcnt lgkmcnt(9)
    v_mfma_f32_16x16x32_bf16 v[176:179], v[88:91], v[52:55], v[176:179]
    v_mfma_f32_16x16x32_bf16 v[180:183], v[88:91], v[56:59], v[180:183]
    v_mfma_f32_16x16x32_bf16 v[184:187], v[88:91], v[60:63], v[184:187]
    v_mfma_f32_16x16x32_bf16 v[188:191], v[88:91], v[64:67], v[188:191]
    ds_read_b64_tr_b16 v[84:85], v32 offset:0
    ds_read_b64_tr_b16 v[86:87], v32 offset:2560
    ds_read_b128 v[40:43], v22 offset:1024
    s_waitcnt lgkmcnt(10)
    v_mfma_f32_16x16x32_bf16 v[192:195], v[68:71], v[52:55], v[192:195]
    v_mfma_f32_16x16x32_bf16 v[196:199], v[68:71], v[56:59], v[196:199]
    v_mfma_f32_16x16x32_bf16 v[200:203], v[68:71], v[60:63], v[200:203]
    v_mfma_f32_16x16x32_bf16 v[204:207], v[68:71], v[64:67], v[204:207]
    ds_read_b64_tr_b16 v[88:89], v33 offset:0
    ds_read_b64_tr_b16 v[90:91], v33 offset:2560
    ds_read_b128 v[44:47], v22 offset:2048
    s_waitcnt lgkmcnt(11)
    v_mfma_f32_16x16x32_bf16 v[208:211], v[72:75], v[52:55], v[208:211]
    v_mfma_f32_16x16x32_bf16 v[212:215], v[72:75], v[56:59], v[212:215]
    v_mfma_f32_16x16x32_bf16 v[216:219], v[72:75], v[60:63], v[216:219]
    v_mfma_f32_16x16x32_bf16 v[220:223], v[72:75], v[64:67], v[220:223]
    ds_read_b64_tr_b16 v[68:69], v34 offset:0
    ds_read_b64_tr_b16 v[70:71], v34 offset:2560
    ds_read_b128 v[48:51], v22 offset:3072
    s_waitcnt lgkmcnt(12)
    v_mfma_f32_16x16x32_bf16 v[224:227], v[76:79], v[52:55], v[224:227]
    v_mfma_f32_16x16x32_bf16 v[228:231], v[76:79], v[56:59], v[228:231]
    v_mfma_f32_16x16x32_bf16 v[232:235], v[76:79], v[60:63], v[232:235]
    v_mfma_f32_16x16x32_bf16 v[236:239], v[76:79], v[64:67], v[236:239]
    ds_read_b64_tr_b16 v[72:73], v35 offset:0
    ds_read_b64_tr_b16 v[74:75], v35 offset:2560
    s_waitcnt lgkmcnt(12)
    v_mfma_f32_16x16x32_bf16 v[240:243], v[80:83], v[52:55], v[240:243]
    v_mfma_f32_16x16x32_bf16 v[244:247], v[80:83], v[56:59], v[244:247]
    v_mfma_f32_16x16x32_bf16 v[248:251], v[80:83], v[60:63], v[248:251]
    v_mfma_f32_16x16x32_bf16 v[252:255], v[80:83], v[64:67], v[252:255]
    s_waitcnt vmcnt(4)
    s_barrier
    ds_read_b64_tr_b16 v[76:77], v32 offset:128
    ds_read_b64_tr_b16 v[78:79], v32 offset:2688
    s_waitcnt lgkmcnt(4)
    v_mfma_f32_16x16x32_bf16 v[96:99], v[84:87], v[36:39], v[96:99]
    v_mfma_f32_16x16x32_bf16 v[100:103], v[84:87], v[40:43], v[100:103]
    v_mfma_f32_16x16x32_bf16 v[104:107], v[84:87], v[44:47], v[104:107]
    v_mfma_f32_16x16x32_bf16 v[108:111], v[84:87], v[48:51], v[108:111]
    s_add_u32 m0, s38, 36864
    s_nop 0
    buffer_load_dwordx4 v2, s[4:7], s40 offen lds
    ds_read_b64_tr_b16 v[80:81], v33 offset:128
    ds_read_b64_tr_b16 v[82:83], v33 offset:2688
    v_mfma_f32_16x16x32_bf16 v[112:115], v[88:91], v[36:39], v[112:115]
    v_mfma_f32_16x16x32_bf16 v[116:119], v[88:91], v[40:43], v[116:119]
    v_mfma_f32_16x16x32_bf16 v[120:123], v[88:91], v[44:47], v[120:123]
    v_mfma_f32_16x16x32_bf16 v[124:127], v[88:91], v[48:51], v[124:127]
    s_add_u32 m0, s38, 37888
    s_nop 0
    buffer_load_dwordx4 v3, s[4:7], s40 offen lds
    s_add_u32 s40, s40, 64
    ds_read_b64_tr_b16 v[84:85], v34 offset:128
    ds_read_b64_tr_b16 v[86:87], v34 offset:2688
    v_mfma_f32_16x16x32_bf16 v[128:131], v[68:71], v[36:39], v[128:131]
    v_mfma_f32_16x16x32_bf16 v[132:135], v[68:71], v[40:43], v[132:135]
    v_mfma_f32_16x16x32_bf16 v[136:139], v[68:71], v[44:47], v[136:139]
    v_mfma_f32_16x16x32_bf16 v[140:143], v[68:71], v[48:51], v[140:143]
    s_add_u32 m0, s39, 53248
    s_nop 0
    global_load_lds_dwordx4 v[6:7], off
    v_add_co_u32 v6, vcc, v6, v16
    s_nop 1
    v_addc_co_u32 v7, vcc, 0, v7, vcc
    ds_read_b64_tr_b16 v[88:89], v35 offset:128
    ds_read_b64_tr_b16 v[90:91], v35 offset:2688
    s_waitcnt lgkmcnt(8)
    v_mfma_f32_16x16x32_bf16 v[144:147], v[72:75], v[36:39], v[144:147]
    v_mfma_f32_16x16x32_bf16 v[148:151], v[72:75], v[40:43], v[148:151]
    v_mfma_f32_16x16x32_bf16 v[152:155], v[72:75], v[44:47], v[152:155]
    v_mfma_f32_16x16x32_bf16 v[156:159], v[72:75], v[48:51], v[156:159]
    s_add_u32 m0, s39, 61440
    s_nop 0
    global_load_lds_dwordx4 v[8:9], off
    v_add_co_u32 v8, vcc, v8, v17
    s_nop 1
    v_addc_co_u32 v9, vcc, 0, v9, vcc
    ds_read_b64_tr_b16 v[68:69], v32 offset:256
    ds_read_b64_tr_b16 v[70:71], v32 offset:2816
    s_waitcnt lgkmcnt(8)
    v_mfma_f32_16x16x32_bf16 v[160:163], v[76:79], v[36:39], v[160:163]
    v_mfma_f32_16x16x32_bf16 v[164:167], v[76:79], v[40:43], v[164:167]
    v_mfma_f32_16x16x32_bf16 v[168:171], v[76:79], v[44:47], v[168:171]
    v_mfma_f32_16x16x32_bf16 v[172:175], v[76:79], v[48:51], v[172:175]
    s_cmp_ge_u32 s24, 4
    s_cbranch_scc1 G1_sk13
    s_add_u32 m0, s39, 69632
    s_nop 0
    global_load_lds_dwordx4 v[10:11], off
    v_add_co_u32 v10, vcc, v10, v18
    s_nop 1
    v_addc_co_u32 v11, vcc, 0, v11, vcc
G1_sk13:
    ds_read_b64_tr_b16 v[72:73], v33 offset:256
    ds_read_b64_tr_b16 v[74:75], v33 offset:2816
    ds_read_b128 v[52:55], v22 offset:36864
    s_waitcnt lgkmcnt(9)
    v_mfma_f32_16x16x32_bf16 v[176:179], v[80:83], v[36:39], v[176:179]
    v_mfma_f32_16x16x32_bf16 v[180:183], v[80:83], v[40:43], v[180:183]
    v_mfma_f32_16x16x32_bf16 v[184:187], v[80:83], v[44:47], v[184:187]
    v_mfma_f32_16x16x32_bf16 v[188:191], v[80:83], v[48:51], v[188:191]
    ds_read_b64_tr_b16 v[76:77], v32 offset:36864
    ds_read_b64_tr_b16 v[78:79], v32 offset:39424
    ds_read_b128 v[56:59], v22 offset:37888
    s_waitcnt lgkmcnt(10)
    v_mfma_f32_16x16x32_bf16 v[192:195], v[84:87], v[36:39], v[192:195]
    v_mfma_f32_16x16x32_bf16 v[196:199], v[84:87], v[40:43], v[196:199]
    v_mfma_f32_16x16x32_bf16 v[200:203], v[84:87], v[44:47], v[200:203]
    v_mfma_f32_16x16x32_bf16 v[204:207], v[84:87], v[48:51], v[204:207]
    ds_read_b64_tr_b16 v[80:81], v33 offset:36864
    ds_read_b64_tr_b16 v[82:83], v33 offset:39424
    ds_read_b128 v[60:63], v22 offset:38912
    s_waitcnt lgkmcnt(11)
    v_mfma_f32_16x16x32_bf16 v[208:211], v[88:91], v[36:39], v[208:211]
    v_mfma_f32_16x16x32_bf16 v[212:215], v[88:91], v[40:43], v[212:215]
    v_mfma_f32_16x16x32_bf16 v[216:219], v[88:91], v[44:47], v[216:219]
    v_mfma_f32_16x16x32_bf16 v[220:223], v[88:91], v[48:51], v[220:223]
    ds_read_b64_tr_b16 v[84:85], v34 offset:36864
    ds_read_b64_tr_b16 v[86:87], v34 offset:39424
    ds_read_b128 v[64:67], v22 offset:39936
    s_waitcnt lgkmcnt(12)
    v_mfma_f32_16x16x32_bf16 v[224:227], v[68:71], v[36:39], v[224:227]
    v_mfma_f32_16x16x32_bf16 v[228:231], v[68:71], v[40:43], v[228:231]
    v_mfma_f32_16x16x32_bf16 v[232:235], v[68:71], v[44:47], v[232:235]
    v_mfma_f32_16x16x32_bf16 v[236:239], v[68:71], v[48:51], v[236:239]
    ds_read_b64_tr_b16 v[88:89], v35 offset:36864
    ds_read_b64_tr_b16 v[90:91], v35 offset:39424
    s_waitcnt lgkmcnt(12)
    v_mfma_f32_16x16x32_bf16 v[240:243], v[72:75], v[36:39], v[240:243]
    v_mfma_f32_16x16x32_bf16 v[244:247], v[72:75], v[40:43], v[244:247]
    v_mfma_f32_16x16x32_bf16 v[248:251], v[72:75], v[44:47], v[248:251]
    v_mfma_f32_16x16x32_bf16 v[252:255], v[72:75], v[48:51], v[252:255]
    s_waitcnt vmcnt(4)
    s_barrier
    ds_read_b64_tr_b16 v[68:69], v32 offset:36992
    ds_read_b64_tr_b16 v[70:71], v32 offset:39552
    s_waitcnt lgkmcnt(4)
    v_mfma_f32_16x16x32_bf16 v[96:99], v[76:79], v[52:55], v[96:99]
    v_mfma_f32_16x16x32_bf16 v[100:103], v[76:79], v[56:59], v[100:103]
    v_mfma_f32_16x16x32_bf16 v[104:107], v[76:79], v[60:63], v[104:107]
    v_mfma_f32_16x16x32_bf16 v[108:111], v[76:79], v[64:67], v[108:111]
    s_add_u32 m0, s38, 73728
    s_nop 0
    buffer_load_dwordx4 v2, s[4:7], s40 offen lds
    ds_read_b64_tr_b16 v[72:73], v33 offset:36992
    ds_read_b64_tr_b16 v[74:75], v33 offset:39552
    v_mfma_f32_16x16x32_bf16 v[112:115], v[80:83], v[52:55], v[112:115]
    v_mfma_f32_16x16x32_bf16 v[116:119], v[80:83], v[56:59], v[116:119]
    v_mfma_f32_16x16x32_bf16 v[120:123], v[80:83], v[60:63], v[120:123]
    v_mfma_f32_16x16x32_bf16 v[124:127], v[80:83], v[64:67], v[124:127]
    s_add_u32 m0, s38, 74752
    s_nop 0
    buffer_load_dwordx4 v3, s[4:7], s40 offen lds
    s_add_u32 s40, s40, 64
    ds_read_b64_tr_b16 v[76:77], v34 offset:36992
    ds_read_b64_tr_b16 v[78:79], v34 offset:39552
    v_mfma_f32_16x16x32_bf16 v[128:131], v[84:87], v[52:55], v[128:131]
    v_mfma_f32_16x16x32_bf16 v[132:135], v[84:87], v[56:59], v[132:135]
    v_mfma_f32_16x16x32_bf16 v[136:139], v[84:87], v[60:63], v[136:139]
    v_mfma_f32_16x16x32_bf16 v[140:143], v[84:87], v[64:67], v[140:143]
    s_add_u32 m0, s39, 90112
    s_nop 0
    global_load_lds_dwordx4 v[6:7], off
    v_add_co_u32 v6, vcc, v6, v16
    s_nop 1
    v_addc_co_u32 v7, vcc, 0, v7, vcc
    ds_read_b64_tr_b16 v[80:81], v35 offset:36992
    ds_read_b64_tr_b16 v[82:83], v35 offset:39552
    s_waitcnt lgkmcnt(8)
    v_mfma_f32_16x16x32_bf16 v[144:147], v[88:91], v[52:55], v[144:147]
    v_mfma_f32_16x16x32_bf16 v[148:151], v[88:91], v[56:59], v[148:151]
    v_mfma_f32_16x16x32_bf16 v[152:155], v[88:91], v[60:63], v[152:155]
    v_mfma_f32_16x16x32_bf16 v[156:159], v[88:91], v[64:67], v[156:159]
    s_add_u32 m0, s39, 98304
    s_nop 0
    global_load_lds_dwordx4 v[8:9], off
    v_add_co_u32 v8, vcc, v8, v17
    s_nop 1
    v_addc_co_u32 v9, vcc, 0, v9, vcc
    ds_read_b64_tr_b16 v[84:85], v32 offset:37120
    ds_read_b64_tr_b16 v[86:87], v32 offset:39680
    s_waitcnt lgkmcnt(8)
    v_mfma_f32_16x16x32_bf16 v[160:163], v[68:71], v[52:55], v[160:163]
    v_mfma_f32_16x16x32_bf16 v[164:167], v[68:71], v[56:59], v[164:167]
    v_mfma_f32_16x16x32_bf16 v[168:171], v[68:71], v[60:63], v[168:171]
    v_mfma_f32_16x16x32_bf16 v[172:175], v[68:71], v[64:67], v[172:175]
    s_cmp_ge_u32 s24, 4
    s_cbranch_scc1 G1_sk14
    s_add_u32 m0, s39, 106496
    s_nop 0
    global_load_lds_dwordx4 v[10:11], off
    v_add_co_u32 v10, vcc, v10, v18
    s_nop 1
    v_addc_co_u32 v11, vcc, 0, v11, vcc
G1_sk14:
    ds_read_b64_tr_b16 v[88:89], v33 offset:37120
    ds_read_b64_tr_b16 v[90:91], v33 offset:39680
    ds_read_b128 v[36:39], v21 offset:0
    s_waitcnt lgkmcnt(9)
    v_mfma_f32_16x16x32_bf16 v[176:179], v[72:75], v[52:55], v[176:179]
    v_mfma_f32_16x16x32_bf16 v[180:183], v[72:75], v[56:59], v[180:183]
    v_mfma_f32_16x16x32_bf16 v[184:187], v[72:75], v[60:63], v[184:187]
    v_mfma_f32_16x16x32_bf16 v[188:191], v[72:75], v[64:67], v[188:191]
    ds_read_b64_tr_b16 v[68:69], v28 offset:0
    ds_read_b64_tr_b16 v[70:71], v28 offset:2560
    ds_read_b128 v[40:43], v21 offset:1024
    s_waitcnt lgkmcnt(10)
    v_mfma_f32_16x16x32_bf16 v[192:195], v[76:79], v[52:55], v[192:195]
    v_mfma_f32_16x16x32_bf16 v[196:199], v[76:79], v[56:59], v[196:199]
    v_mfma_f32_16x16x32_bf16 v[200:203], v[76:79], v[60:63], v[200:203]
    v_mfma_f32_16x16x32_bf16 v[204:207], v[76:79], v[64:67], v[204:207]
    ds_read_b64_tr_b16 v[72:73], v29 offset:0
    ds_read_b64_tr_b16 v[74:75], v29 offset:2560
    ds_read_b128 v[44:47], v21 offset:2048
    s_waitcnt lgkmcnt(11)
    v_mfma_f32_16x16x32_bf16 v[208:211], v[80:83], v[52:55], v[208:211]
    v_mfma_f32_16x16x32_bf16 v[212:215], v[80:83], v[56:59], v[212:215]
    v_mfma_f32_16x16x32_bf16 v[216:219], v[80:83], v[60:63], v[216:219]
    v_mfma_f32_16x16x32_bf16 v[220:223], v[80:83], v[64:67], v[220:223]
    ds_read_b64_tr_b16 v[76:77], v30 offset:0
    ds_read_b64_tr_b16 v[78:79], v30 offset:2560
    ds_read_b128 v[48:51], v21 offset:3072
    s_waitcnt lgkmcnt(12)
    v_mfma_f32_16x16x32_bf16 v[224:227], v[84:87], v[52:55], v[224:227]
    v_mfma_f32_16x16x32_bf16 v[228:231], v[84:87], v[56:59], v[228:231]
    v_mfma_f32_16x16x32_bf16 v[232:235], v[84:87], v[60:63], v[232:235]
    v_mfma_f32_16x16x32_bf16 v[236:239], v[84:87], v[64:67], v[236:239]
    ds_read_b64_tr_b16 v[80:81], v31 offset:0
    ds_read_b64_tr_b16 v[82:83], v31 offset:2560
    s_waitcnt lgkmcnt(12)
    v_mfma_f32_16x16x32_bf16 v[240:243], v[88:91], v[52:55], v[240:243]
    v_mfma_f32_16x16x32_bf16 v[244:247], v[88:91], v[56:59], v[244:247]
    v_mfma_f32_16x16x32_bf16 v[248:251], v[88:91], v[60:63], v[248:251]
    v_mfma_f32_16x16x32_bf16 v[252:255], v[88:91], v[64:67], v[252:255]
    s_waitcnt vmcnt(4)
    s_barrier
    ds_read_b64_tr_b16 v[84:85], v28 offset:128
    ds_read_b64_tr_b16 v[86:87], v28 offset:2688
    s_waitcnt lgkmcnt(4)
    v_mfma_f32_16x16x32_bf16 v[96:99], v[68:71], v[36:39], v[96:99]
    v_mfma_f32_16x16x32_bf16 v[100:103], v[68:71], v[40:43], v[100:103]
    v_mfma_f32_16x16x32_bf16 v[104:107], v[68:71], v[44:47], v[104:107]
    v_mfma_f32_16x16x32_bf16 v[108:111], v[68:71], v[48:51], v[108:111]
    s_add_u32 m0, s38, 110592
    s_nop 0
    buffer_load_dwordx4 v2, s[4:7], s40 offen lds
    ds_read_b64_tr_b16 v[88:89], v29 offset:128
    ds_read_b64_tr_b16 v[90:91], v29 offset:2688
    v_mfma_f32_16x16x32_bf16 v[112:115], v[72:75], v[36:39], v[112:115]
    v_mfma_f32_16x16x32_bf16 v[116:119], v[72:75], v[40:43], v[116:119]
    v_mfma_f32_16x16x32_bf16 v[120:123], v[72:75], v[44:47], v[120:123]
    v_mfma_f32_16x16x32_bf16 v[124:127], v[72:75], v[48:51], v[124:127]
    s_add_u32 m0, s38, 111616
    s_nop 0
    buffer_load_dwordx4 v3, s[4:7], s40 offen lds
    s_add_u32 s40, s40, 64
    ds_read_b64_tr_b16 v[68:69], v30 offset:128
    ds_read_b64_tr_b16 v[70:71], v30 offset:2688
    v_mfma_f32_16x16x32_bf16 v[128:131], v[76:79], v[36:39], v[128:131]
    v_mfma_f32_16x16x32_bf16 v[132:135], v[76:79], v[40:43], v[132:135]
    v_mfma_f32_16x16x32_bf16 v[136:139], v[76:79], v[44:47], v[136:139]
    v_mfma_f32_16x16x32_bf16 v[140:143], v[76:79], v[48:51], v[140:143]
    s_add_u32 m0, s39, 126976
    s_nop 0
    global_load_lds_dwordx4 v[6:7], off
    v_add_co_u32 v6, vcc, v6, v16
    s_nop 1
    v_addc_co_u32 v7, vcc, 0, v7, vcc
    ds_read_b64_tr_b16 v[72:73], v31 offset:128
    ds_read_b64_tr_b16 v[74:75], v31 offset:2688
    s_waitcnt lgkmcnt(8)
    v_mfma_f32_16x16x32_bf16 v[144:147], v[80:83], v[36:39], v[144:147]
    v_mfma_f32_16x16x32_bf16 v[148:151], v[80:83], v[40:43], v[148:151]
    v_mfma_f32_16x16x32_bf16 v[152:155], v[80:83], v[44:47], v[152:155]
    v_mfma_f32_16x16x32_bf16 v[156:159], v[80:83], v[48:51], v[156:159]
    s_add_u32 m0, s39, 135168
    s_nop 0
    global_load_lds_dwordx4 v[8:9], off
    v_add_co_u32 v8, vcc, v8, v17
    s_nop 1
    v_addc_co_u32 v9, vcc, 0, v9, vcc
    ds_read_b64_tr_b16 v[76:77], v28 offset:256
    ds_read_b64_tr_b16 v[78:79], v28 offset:2816
    s_waitcnt lgkmcnt(8)
    v_mfma_f32_16x16x32_bf16 v[160:163], v[84:87], v[36:39], v[160:163]
    v_mfma_f32_16x16x32_bf16 v[164:167], v[84:87], v[40:43], v[164:167]
    v_mfma_f32_16x16x32_bf16 v[168:171], v[84:87], v[44:47], v[168:171]
    v_mfma_f32_16x16x32_bf16 v[172:175], v[84:87], v[48:51], v[172:175]
    s_cmp_ge_u32 s24, 4
    s_cbranch_scc1 G1_sk15
    s_add_u32 m0, s39, 143360
    s_nop 0
    global_load_lds_dwordx4 v[10:11], off
    v_add_co_u32 v10, vcc, v10, v18
    s_nop 1
    v_addc_co_u32 v11, vcc, 0, v11, vcc
G1_sk15:
    ds_read_b64_tr_b16 v[80:81], v29 offset:256
    ds_read_b64_tr_b16 v[82:83], v29 offset:2816
    ds_read_b128 v[52:55], v21 offset:36864
    s_waitcnt lgkmcnt(9)
    v_mfma_f32_16x16x32_bf16 v[176:179], v[88:91], v[36:39], v[176:179]
    v_mfma_f32_16x16x32_bf16 v[180:183], v[88:91], v[40:43], v[180:183]
    v_mfma_f32_16x16x32_bf16 v[184:187], v[88:91], v[44:47], v[184:187]
    v_mfma_f32_16x16x32_bf16 v[188:191], v[88:91], v[48:51], v[188:191]
    ds_read_b64_tr_b16 v[84:85], v28 offset:36864
    ds_read_b64_tr_b16 v[86:87], v28 offset:39424
    ds_read_b128 v[56:59], v21 offset:37888
    s_waitcnt lgkmcnt(10)
    v_mfma_f32_16x16x32_bf16 v[192:195], v[68:71], v[36:39], v[192:195]
    v_mfma_f32_16x16x32_bf16 v[196:199], v[68:71], v[40:43], v[196:199]
    v_mfma_f32_16x16x32_bf16 v[200:203], v[68:71], v[44:47], v[200:203]
    v_mfma_f32_16x16x32_bf16 v[204:207], v[68:71], v[48:51], v[204:207]
    ds_read_b64_tr_b16 v[88:89], v29 offset:36864
    ds_read_b64_tr_b16 v[90:91], v29 offset:39424
    ds_read_b128 v[60:63], v21 offset:38912
    s_waitcnt lgkmcnt(11)
    v_mfma_f32_16x16x32_bf16 v[208:211], v[72:75], v[36:39], v[208:211]
    v_mfma_f32_16x16x32_bf16 v[212:215], v[72:75], v[40:43], v[212:215]
    v_mfma_f32_16x16x32_bf16 v[216:219], v[72:75], v[44:47], v[216:219]
    v_mfma_f32_16x16x32_bf16 v[220:223], v[72:75], v[48:51], v[220:223]
    ds_read_b64_tr_b16 v[68:69], v30 offset:36864
    ds_read_b64_tr_b16 v[70:71], v30 offset:39424
    ds_read_b128 v[64:67], v21 offset:39936
    s_waitcnt lgkmcnt(12)
    v_mfma_f32_16x16x32_bf16 v[224:227], v[76:79], v[36:39], v[224:227]
    v_mfma_f32_16x16x32_bf16 v[228:231], v[76:79], v[40:43], v[228:231]
    v_mfma_f32_16x16x32_bf16 v[232:235], v[76:79], v[44:47], v[232:235]
    v_mfma_f32_16x16x32_bf16 v[236:239], v[76:79], v[48:51], v[236:239]
    ds_read_b64_tr_b16 v[72:73], v31 offset:36864
    ds_read_b64_tr_b16 v[74:75], v31 offset:39424
    s_waitcnt lgkmcnt(12)
    v_mfma_f32_16x16x32_bf16 v[240:243], v[80:83], v[36:39], v[240:243]
    v_mfma_f32_16x16x32_bf16 v[244:247], v[80:83], v[40:43], v[244:247]
    v_mfma_f32_16x16x32_bf16 v[248:251], v[80:83], v[44:47], v[248:251]
    v_mfma_f32_16x16x32_bf16 v[252:255], v[80:83], v[48:51], v[252:255]
    s_waitcnt vmcnt(4)
    s_barrier
    ds_read_b64_tr_b16 v[76:77], v28 offset:36992
    ds_read_b64_tr_b16 v[78:79], v28 offset:39552
    s_waitcnt lgkmcnt(4)
    v_mfma_f32_16x16x32_bf16 v[96:99], v[84:87], v[52:55], v[96:99]
    v_mfma_f32_16x16x32_bf16 v[100:103], v[84:87], v[56:59], v[100:103]
    v_mfma_f32_16x16x32_bf16 v[104:107], v[84:87], v[60:63], v[104:107]
    v_mfma_f32_16x16x32_bf16 v[108:111], v[84:87], v[64:67], v[108:111]
    s_add_u32 m0, s38, 0
    s_nop 0
    buffer_load_dwordx4 v2, s[4:7], s40 offen lds
    ds_read_b64_tr_b16 v[80:81], v29 offset:36992
    ds_read_b64_tr_b16 v[82:83], v29 offset:39552
    v_mfma_f32_16x16x32_bf16 v[112:115], v[88:91], v[52:55], v[112:115]
    v_mfma_f32_16x16x32_bf16 v[116:119], v[88:91], v[56:59], v[116:119]
    v_mfma_f32_16x16x32_bf16 v[120:123], v[88:91], v[60:63], v[120:123]
    v_mfma_f32_16x16x32_bf16 v[124:127], v[88:91], v[64:67], v[124:127]
    s_add_u32 m0, s38, 1024
    s_nop 0
    buffer_load_dwordx4 v3, s[4:7], s40 offen lds
    s_add_u32 s40, s40, 64
    ds_read_b64_tr_b16 v[84:85], v30 offset:36992
    ds_read_b64_tr_b16 v[86:87], v30 offset:39552
    v_mfma_f32_16x16x32_bf16 v[128:131], v[68:71], v[52:55], v[128:131]
    v_mfma_f32_16x16x32_bf16 v[132:135], v[68:71], v[56:59], v[132:135]
    v_mfma_f32_16x16x32_bf16 v[136:139], v[68:71], v[60:63], v[136:139]
    v_mfma_f32_16x16x32_bf16 v[140:143], v[68:71], v[64:67], v[140:143]
    s_add_u32 m0, s39, 16384
    s_nop 0
    global_load_lds_dwordx4 v[6:7], off
    v_add_co_u32 v6, vcc, v6, v16
    s_nop 1
    v_addc_co_u32 v7, vcc, 0, v7, vcc
    ds_read_b64_tr_b16 v[88:89], v31 offset:36992
    ds_read_b64_tr_b16 v[90:91], v31 offset:39552
    s_waitcnt lgkmcnt(8)
    v_mfma_f32_16x16x32_bf16 v[144:147], v[72:75], v[52:55], v[144:147]
    v_mfma_f32_16x16x32_bf16 v[148:151], v[72:75], v[56:59], v[148:151]
    v_mfma_f32_16x16x32_bf16 v[152:155], v[72:75], v[60:63], v[152:155]
    v_mfma_f32_16x16x32_bf16 v[156:159], v[72:75], v[64:67], v[156:159]
    s_add_u32 m0, s39, 24576
    s_nop 0
    global_load_lds_dwordx4 v[8:9], off
    v_add_co_u32 v8, vcc, v8, v17
    s_nop 1
    v_addc_co_u32 v9, vcc, 0, v9, vcc
    ds_read_b64_tr_b16 v[68:69], v28 offset:37120
    ds_read_b64_tr_b16 v[70:71], v28 offset:39680
    s_waitcnt lgkmcnt(8)
    v_mfma_f32_16x16x32_bf16 v[160:163], v[76:79], v[52:55], v[160:163]
    v_mfma_f32_16x16x32_bf16 v[164:167], v[76:79], v[56:59], v[164:167]
    v_mfma_f32_16x16x32_bf16 v[168:171], v[76:79], v[60:63], v[168:171]
    v_mfma_f32_16x16x32_bf16 v[172:175], v[76:79], v[64:67], v[172:175]
    s_cmp_ge_u32 s24, 4
    s_cbranch_scc1 G1_sk16
    s_add_u32 m0, s39, 32768
    s_nop 0
    global_load_lds_dwordx4 v[10:11], off
    v_add_co_u32 v10, vcc, v10, v18
    s_nop 1
    v_addc_co_u32 v11, vcc, 0, v11, vcc
G1_sk16:
    ds_read_b64_tr_b16 v[72:73], v29 offset:37120
    ds_read_b64_tr_b16 v[74:75], v29 offset:39680
    ds_read_b128 v[36:39], v22 offset:0
    s_waitcnt lgkmcnt(9)
    v_mfma_f32_16x16x32_bf16 v[176:179], v[80:83], v[52:55], v[176:179]
    v_mfma_f32_16x16x32_bf16 v[180:183], v[80:83], v[56:59], v[180:183]
    v_mfma_f32_16x16x32_bf16 v[184:187], v[80:83], v[60:63], v[184:187]
    v_mfma_f32_16x16x32_bf16 v[188:191], v[80:83], v[64:67], v[188:191]
    ds_read_b64_tr_b16 v[76:77], v32 offset:0
    ds_read_b64_tr_b16 v[78:79], v32 offset:2560
    ds_read_b128 v[40:43], v22 offset:1024
    s_waitcnt lgkmcnt(10)
    v_mfma_f32_16x16x32_bf16 v[192:195], v[84:87], v[52:55], v[192:195]
    v_mfma_f32_16x16x32_bf16 v[196:199], v[84:87], v[56:59], v[196:199]
    v_mfma_f32_16x16x32_bf16 v[200:203], v[84:87], v[60:63], v[200:203]
    v_mfma_f32_16x16x32_bf16 v[204:207], v[84:87], v[64:67], v[204:207]
    ds_read_b64_tr_b16 v[80:81], v33 offset:0
    ds_read_b64_tr_b16 v[82:83], v33 offset:2560
    ds_read_b128 v[44:47], v22 offset:2048
    s_waitcnt lgkmcnt(11)
    v_mfma_f32_16x16x32_bf16 v[208:211], v[88:91], v[52:55], v[208:211]
    v_mfma_f32_16x16x32_bf16 v[212:215], v[88:91], v[56:59], v[212:215]
    v_mfma_f32_16x16x32_bf16 v[216:219], v[88:91], v[60:63], v[216:219]
    v_mfma_f32_16x16x32_bf16 v[220:223], v[88:91], v[64:67], v[220:223]
    ds_read_b64_tr_b16 v[84:85], v34 offset:0
    ds_read_b64_tr_b16 v[86:87], v34 offset:2560
    ds_read_b128 v[48:51], v22 offset:3072
    s_waitcnt lgkmcnt(12)
    v_mfma_f32_16x16x32_bf16 v[224:227], v[68:71], v[52:55], v[224:227]
    v_mfma_f32_16x16x32_bf16 v[228:231], v[68:71], v[56:59], v[228:231]
    v_mfma_f32_16x16x32_bf16 v[232:235], v[68:71], v[60:63], v[232:235]
    v_mfma_f32_16x16x32_bf16 v[236:239], v[68:71], v[64:67], v[236:239]
    ds_read_b64_tr_b16 v[88:89], v35 offset:0
    ds_read_b64_tr_b16 v[90:91], v35 offset:2560
    s_waitcnt lgkmcnt(12)
    v_mfma_f32_16x16x32_bf16 v[240:243], v[72:75], v[52:55], v[240:243]
    v_mfma_f32_16x16x32_bf16 v[244:247], v[72:75], v[56:59], v[244:247]
    v_mfma_f32_16x16x32_bf16 v[248:251], v[72:75], v[60:63], v[248:251]
    v_mfma_f32_16x16x32_bf16 v[252:255], v[72:75], v[64:67], v[252:255]
    s_waitcnt vmcnt(4)
    s_barrier
    ds_read_b64_tr_b16 v[68:69], v32 offset:128
    ds_read_b64_tr_b16 v[70:71], v32 offset:2688
    s_waitcnt lgkmcnt(4)
    v_mfma_f32_16x16x32_bf16 v[96:99], v[76:79], v[36:39], v[96:99]
    v_mfma_f32_16x16x32_bf16 v[100:103], v[76:79], v[40:43], v[100:103]
    v_mfma_f32_16x16x32_bf16 v[104:107], v[76:79], v[44:47], v[104:107]
    v_mfma_f32_16x16x32_bf16 v[108:111], v[76:79], v[48:51], v[108:111]
    s_add_u32 m0, s38, 36864
    s_nop 0
    buffer_load_dwordx4 v2, s[4:7], s40 offen lds
    ds_read_b64_tr_b16 v[72:73], v33 offset:128
    ds_read_b64_tr_b16 v[74:75], v33 offset:2688
    v_mfma_f32_16x16x32_bf16 v[112:115], v[80:83], v[36:39], v[112:115]
    v_mfma_f32_16x16x32_bf16 v[116:119], v[80:83], v[40:43], v[116:119]
    v_mfma_f32_16x16x32_bf16 v[120:123], v[80:83], v[44:47], v[120:123]
    v_mfma_f32_16x16x32_bf16 v[124:127], v[80:83], v[48:51], v[124:127]
    s_add_u32 m0, s38, 37888
    s_nop 0
    buffer_load_dwordx4 v3, s[4:7], s40 offen lds
    s_add_u32 s40, s40, 64
    ds_read_b64_tr_b16 v[76:77], v34 offset:128
    ds_read_b64_tr_b16 v[78:79], v34 offset:2688
    v_mfma_f32_16x16x32_bf16 v[128:131], v[84:87], v[36:39], v[128:131]
    v_mfma_f32_16x16x32_bf16 v[132:135], v[84:87], v[40:43], v[132:135]
    v_mfma_f32_16x16x32_bf16 v[136:139], v[84:87], v[44:47], v[136:139]
    v_mfma_f32_16x16x32_bf16 v[140:143], v[84:87], v[48:51], v[140:143]
    s_add_u32 m0, s39, 53248
    s_nop 0
    global_load_lds_dwordx4 v[6:7], off
    v_add_co_u32 v6, vcc, v6, v16
    s_nop 1
    v_addc_co_u32 v7, vcc, 0, v7, vcc
    ds_read_b64_tr_b16 v[80:81], v35 offset:128
    ds_read_b64_tr_b16 v[82:83], v35 offset:2688
    s_waitcnt lgkmcnt(8)
    v_mfma_f32_16x16x32_bf16 v[144:147], v[88:91], v[36:39], v[144:147]
    v_mfma_f32_16x16x32_bf16 v[148:151], v[88:91], v[40:43], v[148:151]
    v_mfma_f32_16x16x32_bf16 v[152:155], v[88:91], v[44:47], v[152:155]
    v_mfma_f32_16x16x32_bf16 v[156:159], v[88:91], v[48:51], v[156:159]
    s_add_u32 m0, s39, 61440
    s_nop 0
    global_load_lds_dwordx4 v[8:9], off
    v_add_co_u32 v8, vcc, v8, v17
    s_nop 1
    v_addc_co_u32 v9, vcc, 0, v9, vcc
    ds_read_b64_tr_b16 v[84:85], v32 offset:256
    ds_read_b64_tr_b16 v[86:87], v32 offset:2816
    s_waitcnt lgkmcnt(8)
    v_mfma_f32_16x16x32_bf16 v[160:163], v[68:71], v[36:39], v[160:163]
    v_mfma_f32_16x16x32_bf16 v[164:167], v[68:71], v[40:43], v[164:167]
    v_mfma_f32_16x16x32_bf16 v[168:171], v[68:71], v[44:47], v[168:171]
    v_mfma_f32_16x16x32_bf16 v[172:175], v[68:71], v[48:51], v[172:175]
    s_cmp_ge_u32 s24, 4
    s_cbranch_scc1 G1_sk17
    s_add_u32 m0, s39, 69632
    s_nop 0
    global_load_lds_dwordx4 v[10:11], off
    v_add_co_u32 v10, vcc, v10, v18
    s_nop 1
    v_addc_co_u32 v11, vcc, 0, v11, vcc
G1_sk17:
    ds_read_b64_tr_b16 v[88:89], v33 offset:256
    ds_read_b64_tr_b16 v[90:91], v33 offset:2816
    ds_read_b128 v[52:55], v22 offset:36864
    s_waitcnt lgkmcnt(9)
    v_mfma_f32_16x16x32_bf16 v[176:179], v[72:75], v[36:39], v[176:179]
    v_mfma_f32_16x16x32_bf16 v[180:183], v[72:75], v[40:43], v[180:183]
    v_mfma_f32_16x16x32_bf16 v[184:187], v[72:75], v[44:47], v[184:187]
    v_mfma_f32_16x16x32_bf16 v[188:191], v[72:75], v[48:51], v[188:191]
    ds_read_b64_tr_b16 v[68:69], v32 offset:36864
    ds_read_b64_tr_b16 v[70:71], v32 offset:39424
    ds_read_b128 v[56:59], v22 offset:37888
    s_waitcnt lgkmcnt(10)
    v_mfma_f32_16x16x32_bf16 v[192:195], v[76:79], v[36:39], v[192:195]
    v_mfma_f32_16x16x32_bf16 v[196:199], v[76:79], v[40:43], v[196:199]
    v_mfma_f32_16x16x32_bf16 v[200:203], v[76:79], v[44:47], v[200:203]
    v_mfma_f32_16x16x32_bf16 v[204:207], v[76:79], v[48:51], v[204:207]
    ds_read_b64_tr_b16 v[72:73], v33 offset:36864
    ds_read_b64_tr_b16 v[74:75], v33 offset:39424
    ds_read_b128 v[60:63], v22 offset:38912
    s_waitcnt lgkmcnt(11)
    v_mfma_f32_16x16x32_bf16 v[208:211], v[80:83], v[36:39], v[208:211]
    v_mfma_f32_16x16x32_bf16 v[212:215], v[80:83], v[40:43], v[212:215]
    v_mfma_f32_16x16x32_bf16 v[216:219], v[80:83], v[44:47], v[216:219]
    v_mfma_f32_16x16x32_bf16 v[220:223], v[80:83], v[48:51], v[220:223]
    ds_read_b64_tr_b16 v[76:77], v34 offset:36864
    ds_read_b64_tr_b16 v[78:79], v34 offset:39424
    ds_read_b128 v[64:67], v22 offset:39936
    s_waitcnt lgkmcnt(12)
    v_mfma_f32_16x16x32_bf16 v[224:227], v[84:87], v[36:39], v[224:227]
    v_mfma_f32_16x16x32_bf16 v[228:231], v[84:87], v[40:43], v[228:231]
    v_mfma_f32_16x16x32_bf16 v[232:235], v[84:87], v[44:47], v[232:235]
    v_mfma_f32_16x16x32_bf16 v[236:239], v[84:87], v[48:51], v[236:239]
    ds_read_b64_tr_b16 v[80:81], v35 offset:36864
    ds_read_b64_tr_b16 v[82:83], v35 offset:39424
    s_waitcnt lgkmcnt(12)
    v_mfma_f32_16x16x32_bf16 v[240:243], v[88:91], v[36:39], v[240:243]
    v_mfma_f32_16x16x32_bf16 v[244:247], v[88:91], v[40:43], v[244:247]
    v_mfma_f32_16x16x32_bf16 v[248:251], v[88:91], v[44:47], v[248:251]
    v_mfma_f32_16x16x32_bf16 v[252:255], v[88:91], v[48:51], v[252:255]
    s_waitcnt vmcnt(4)
    s_barrier
    ds_read_b64_tr_b16 v[84:85], v32 offset:36992
    ds_read_b64_tr_b16 v[86:87], v32 offset:39552
    s_waitcnt lgkmcnt(4)
    v_mfma_f32_16x16x32_bf16 v[96:99], v[68:71], v[52:55], v[96:99]
    v_mfma_f32_16x16x32_bf16 v[100:103], v[68:71], v[56:59], v[100:103]
    v_mfma_f32_16x16x32_bf16 v[104:107], v[68:71], v[60:63], v[104:107]
    v_mfma_f32_16x16x32_bf16 v[108:111], v[68:71], v[64:67], v[108:111]
    s_add_u32 m0, s38, 73728
    s_nop 0
    buffer_load_dwordx4 v2, s[4:7], s40 offen lds
    ds_read_b64_tr_b16 v[88:89], v33 offset:36992
    ds_read_b64_tr_b16 v[90:91], v33 offset:39552
    v_mfma_f32_16x16x32_bf16 v[112:115], v[72:75], v[52:55], v[112:115]
    v_mfma_f32_16x16x32_bf16 v[116:119], v[72:75], v[56:59], v[116:119]
    v_mfma_f32_16x16x32_bf16 v[120:123], v[72:75], v[60:63], v[120:123]
    v_mfma_f32_16x16x32_bf16 v[124:127], v[72:75], v[64:67], v[124:127]
    s_add_u32 m0, s38, 74752
    s_nop 0
    buffer_load_dwordx4 v3, s[4:7], s40 offen lds
    s_add_u32 s40, s40, 64
    ds_read_b64_tr_b16 v[68:69], v34 offset:36992
    ds_read_b64_tr_b16 v[70:71], v34 offset:39552
    v_mfma_f32_16x16x32_bf16 v[128:131], v[76:79], v[52:55], v[128:131]
    v_mfma_f32_16x16x32_bf16 v[132:135], v[76:79], v[56:59], v[132:135]
    v_mfma_f32_16x16x32_bf16 v[136:139], v[76:79], v[60:63], v[136:139]
    v_mfma_f32_16x16x32_bf16 v[140:143], v[76:79], v[64:67], v[140:143]
    s_add_u32 m0, s39, 90112
    s_nop 0
    global_load_lds_dwordx4 v[6:7], off
    v_add_co_u32 v6, vcc, v6, v16
    s_nop 1
    v_addc_co_u32 v7, vcc, 0, v7, vcc
    ds_read_b64_tr_b16 v[72:73], v35 offset:36992
    ds_read_b64_tr_b16 v[74:75], v35 offset:39552
    s_waitcnt lgkmcnt(8)
    v_mfma_f32_16x16x32_bf16 v[144:147], v[80:83], v[52:55], v[144:147]
    v_mfma_f32_16x16x32_bf16 v[148:151], v[80:83], v[56:59], v[148:151]
    v_mfma_f32_16x16x32_bf16 v[152:155], v[80:83], v[60:63], v[152:155]
    v_mfma_f32_16x16x32_bf16 v[156:159], v[80:83], v[64:67], v[156:159]
    s_add_u32 m0, s39, 98304
    s_nop 0
    global_load_lds_dwordx4 v[8:9], off
    v_add_co_u32 v8, vcc, v8, v17
    s_nop 1
    v_addc_co_u32 v9, vcc, 0, v9, vcc
    ds_read_b64_tr_b16 v[76:77], v32 offset:37120
    ds_read_b64_tr_b16 v[78:79], v32 offset:39680
    s_waitcnt lgkmcnt(8)
    v_mfma_f32_16x16x32_bf16 v[160:163], v[84:87], v[52:55], v[160:163]
    v_mfma_f32_16x16x32_bf16 v[164:167], v[84:87], v[56:59], v[164:167]
    v_mfma_f32_16x16x32_bf16 v[168:171], v[84:87], v[60:63], v[168:171]
    v_mfma_f32_16x16x32_bf16 v[172:175], v[84:87], v[64:67], v[172:175]
    s_cmp_ge_u32 s24, 4
    s_cbranch_scc1 G1_sk18
    s_add_u32 m0, s39, 106496
    s_nop 0
    global_load_lds_dwordx4 v[10:11], off
    v_add_co_u32 v10, vcc, v10, v18
    s_nop 1
    v_addc_co_u32 v11, vcc, 0, v11, vcc
G1_sk18:
    ds_read_b64_tr_b16 v[80:81], v33 offset:37120
    ds_read_b64_tr_b16 v[82:83], v33 offset:39680
    ds_read_b128 v[36:39], v21 offset:0
    s_waitcnt lgkmcnt(9)
    v_mfma_f32_16x16x32_bf16 v[176:179], v[88:91], v[52:55], v[176:179]
    v_mfma_f32_16x16x32_bf16 v[180:183], v[88:91], v[56:59], v[180:183]
    v_mfma_f32_16x16x32_bf16 v[184:187], v[88:91], v[60:63], v[184:187]
    v_mfma_f32_16x16x32_bf16 v[188:191], v[88:91], v[64:67], v[188:191]
    ds_read_b64_tr_b16 v[84:85], v28 offset:0
    ds_read_b64_tr_b16 v[86:87], v28 offset:2560
    ds_read_b128 v[40:43], v21 offset:1024
    s_waitcnt lgkmcnt(10)
    v_mfma_f32_16x16x32_bf16 v[192:195], v[68:71], v[52:55], v[192:195]
    v_mfma_f32_16x16x32_bf16 v[196:199], v[68:71], v[56:59], v[196:199]
    v_mfma_f32_16x16x32_bf16 v[200:203], v[68:71], v[60:63], v[200:203]
    v_mfma_f32_16x16x32_bf16 v[204:207], v[68:71], v[64:67], v[204:207]
    ds_read_b64_tr_b16 v[88:89], v29 offset:0
    ds_read_b64_tr_b16 v[90:91], v29 offset:2560
    ds_read_b128 v[44:47], v21 offset:2048
    s_waitcnt lgkmcnt(11)
    v_mfma_f32_16x16x32_bf16 v[208:211], v[72:75], v[52:55], v[208:211]
    v_mfma_f32_16x16x32_bf16 v[212:215], v[72:75], v[56:59], v[212:215]
    v_mfma_f32_16x16x32_bf16 v[216:219], v[72:75], v[60:63], v[216:219]
    v_mfma_f32_16x16x32_bf16 v[220:223], v[72:75], v[64:67], v[220:223]
    ds_read_b64_tr_b16 v[68:69], v30 offset:0
    ds_read_b64_tr_b16 v[70:71], v30 offset:2560
    ds_read_b128 v[48:51], v21 offset:3072
    s_waitcnt lgkmcnt(12)
    v_mfma_f32_16x16x32_bf16 v[224:227], v[76:79], v[52:55], v[224:227]
    v_mfma_f32_16x16x32_bf16 v[228:231], v[76:79], v[56:59], v[228:231]
    v_mfma_f32_16x16x32_bf16 v[232:235], v[76:79], v[60:63], v[232:235]
    v_mfma_f32_16x16x32_bf16 v[236:239], v[76:79], v[64:67], v[236:239]
    ds_read_b64_tr_b16 v[72:73], v31 offset:0
    ds_read_b64_tr_b16 v[74:75], v31 offset:2560
    s_waitcnt lgkmcnt(12)
    v_mfma_f32_16x16x32_bf16 v[240:243], v[80:83], v[52:55], v[240:243]
    v_mfma_f32_16x16x32_bf16 v[244:247], v[80:83], v[56:59], v[244:247]
    v_mfma_f32_16x16x32_bf16 v[248:251], v[80:83], v[60:63], v[248:251]
    v_mfma_f32_16x16x32_bf16 v[252:255], v[80:83], v[64:67], v[252:255]
    s_waitcnt vmcnt(4)
    s_barrier
    ds_read_b64_tr_b16 v[76:77], v28 offset:128
    ds_read_b64_tr_b16 v[78:79], v28 offset:2688
    s_waitcnt lgkmcnt(4)
    v_mfma_f32_16x16x32_bf16 v[96:99], v[84:87], v[36:39], v[96:99]
    v_mfma_f32_16x16x32_bf16 v[100:103], v[84:87], v[40:43], v[100:103]
    v_mfma_f32_16x16x32_bf16 v[104:107], v[84:87], v[44:47], v[104:107]
    v_mfma_f32_16x16x32_bf16 v[108:111], v[84:87], v[48:51], v[108:111]
    s_add_u32 m0, s38, 110592
    s_nop 0
    buffer_load_dwordx4 v2, s[4:7], s40 offen lds
    ds_read_b64_tr_b16 v[80:81], v29 offset:128
    ds_read_b64_tr_b16 v[82:83], v29 offset:2688
    v_mfma_f32_16x16x32_bf16 v[112:115], v[88:91], v[36:39], v[112:115]
    v_mfma_f32_16x16x32_bf16 v[116:119], v[88:91], v[40:43], v[116:119]
    v_mfma_f32_16x16x32_bf16 v[120:123], v[88:91], v[44:47], v[120:123]
    v_mfma_f32_16x16x32_bf16 v[124:127], v[88:91], v[48:51], v[124:127]
    s_add_u32 m0, s38, 111616
    s_nop 0
    buffer_load_dwordx4 v3, s[4:7], s40 offen lds
    s_add_u32 s40, s40, 64
    ds_read_b64_tr_b16 v[84:85], v30 offset:128
    ds_read_b64_tr_b16 v[86:87], v30 offset:2688
    v_mfma_f32_16x16x32_bf16 v[128:131], v[68:71], v[36:39], v[128:131]
    v_mfma_f32_16x16x32_bf16 v[132:135], v[68:71], v[40:43], v[132:135]
    v_mfma_f32_16x16x32_bf16 v[136:139], v[68:71], v[44:47], v[136:139]
    v_mfma_f32_16x16x32_bf16 v[140:143], v[68:71], v[48:51], v[140:143]
    s_add_u32 m0, s39, 126976
    s_nop 0
    global_load_lds_dwordx4 v[6:7], off
    v_add_co_u32 v6, vcc, v6, v16
    s_nop 1
    v_addc_co_u32 v7, vcc, 0, v7, vcc
    ds_read_b64_tr_b16 v[88:89], v31 offset:128
    ds_read_b64_tr_b16 v[90:91], v31 offset:2688
    s_waitcnt lgkmcnt(8)
    v_mfma_f32_16x16x32_bf16 v[144:147], v[72:75], v[36:39], v[144:147]
    v_mfma_f32_16x16x32_bf16 v[148:151], v[72:75], v[40:43], v[148:151]
    v_mfma_f32_16x16x32_bf16 v[152:155], v[72:75], v[44:47], v[152:155]
    v_mfma_f32_16x16x32_bf16 v[156:159], v[72:75], v[48:51], v[156:159]
    s_add_u32 m0, s39, 135168
    s_nop 0
    global_load_lds_dwordx4 v[8:9], off
    v_add_co_u32 v8, vcc, v8, v17
    s_nop 1
    v_addc_co_u32 v9, vcc, 0, v9, vcc
    ds_read_b64_tr_b16 v[68:69], v28 offset:256
    ds_read_b64_tr_b16 v[70:71], v28 offset:2816
    s_waitcnt lgkmcnt(8)
    v_mfma_f32_16x16x32_bf16 v[160:163], v[76:79], v[36:39], v[160:163]
    v_mfma_f32_16x16x32_bf16 v[164:167], v[76:79], v[40:43], v[164:167]
    v_mfma_f32_16x16x32_bf16 v[168:171], v[76:79], v[44:47], v[168:171]
    v_mfma_f32_16x16x32_bf16 v[172:175], v[76:79], v[48:51], v[172:175]
    s_cmp_ge_u32 s24, 4
    s_cbranch_scc1 G1_sk19
    s_add_u32 m0, s39, 143360
    s_nop 0
    global_load_lds_dwordx4 v[10:11], off
    v_add_co_u32 v10, vcc, v10, v18
    s_nop 1
    v_addc_co_u32 v11, vcc, 0, v11, vcc
G1_sk19:
    ds_read_b64_tr_b16 v[72:73], v29 offset:256
    ds_read_b64_tr_b16 v[74:75], v29 offset:2816
    ds_read_b128 v[52:55], v21 offset:36864
    s_waitcnt lgkmcnt(9)
    v_mfma_f32_16x16x32_bf16 v[176:179], v[80:83], v[36:39], v[176:179]
    v_mfma_f32_16x16x32_bf16 v[180:183], v[80:83], v[40:43], v[180:183]
    v_mfma_f32_16x16x32_bf16 v[184:187], v[80:83], v[44:47], v[184:187]
    v_mfma_f32_16x16x32_bf16 v[188:191], v[80:83], v[48:51], v[188:191]
    ds_read_b64_tr_b16 v[76:77], v28 offset:36864
    ds_read_b64_tr_b16 v[78:79], v28 offset:39424
    ds_read_b128 v[56:59], v21 offset:37888
    s_waitcnt lgkmcnt(10)
    v_mfma_f32_16x16x32_bf16 v[192:195], v[84:87], v[36:39], v[192:195]
    v_mfma_f32_16x16x32_bf16 v[196:199], v[84:87], v[40:43], v[196:199]
    v_mfma_f32_16x16x32_bf16 v[200:203], v[84:87], v[44:47], v[200:203]
    v_mfma_f32_16x16x32_bf16 v[204:207], v[84:87], v[48:51], v[204:207]
    ds_read_b64_tr_b16 v[80:81], v29 offset:36864
    ds_read_b64_tr_b16 v[82:83], v29 offset:39424
    ds_read_b128 v[60:63], v21 offset:38912
    s_waitcnt lgkmcnt(11)
    v_mfma_f32_16x16x32_bf16 v[208:211], v[88:91], v[36:39], v[208:211]
    v_mfma_f32_16x16x32_bf16 v[212:215], v[88:91], v[40:43], v[212:215]
    v_mfma_f32_16x16x32_bf16 v[216:219], v[88:91], v[44:47], v[216:219]
    v_mfma_f32_16x16x32_bf16 v[220:223], v[88:91], v[48:51], v[220:223]
    ds_read_b64_tr_b16 v[84:85], v30 offset:36864
    ds_read_b64_tr_b16 v[86:87], v30 offset:39424
    ds_read_b128 v[64:67], v21 offset:39936
    s_waitcnt lgkmcnt(12)
    v_mfma_f32_16x16x32_bf16 v[224:227], v[68:71], v[36:39], v[224:227]
    v_mfma_f32_16x16x32_bf16 v[228:231], v[68:71], v[40:43], v[228:231]
    v_mfma_f32_16x16x32_bf16 v[232:235], v[68:71], v[44:47], v[232:235]
    v_mfma_f32_16x16x32_bf16 v[236:239], v[68:71], v[48:51], v[236:239]
    ds_read_b64_tr_b16 v[88:89], v31 offset:36864
    ds_read_b64_tr_b16 v[90:91], v31 offset:39424
    s_waitcnt lgkmcnt(12)
    v_mfma_f32_16x16x32_bf16 v[240:243], v[72:75], v[36:39], v[240:243]
    v_mfma_f32_16x16x32_bf16 v[244:247], v[72:75], v[40:43], v[244:247]
    v_mfma_f32_16x16x32_bf16 v[248:251], v[72:75], v[44:47], v[248:251]
    v_mfma_f32_16x16x32_bf16 v[252:255], v[72:75], v[48:51], v[252:255]
    s_waitcnt vmcnt(4)
    s_barrier
    ds_read_b64_tr_b16 v[68:69], v28 offset:36992
    ds_read_b64_tr_b16 v[70:71], v28 offset:39552
    s_waitcnt lgkmcnt(4)
    v_mfma_f32_16x16x32_bf16 v[96:99], v[76:79], v[52:55], v[96:99]
    v_mfma_f32_16x16x32_bf16 v[100:103], v[76:79], v[56:59], v[100:103]
    v_mfma_f32_16x16x32_bf16 v[104:107], v[76:79], v[60:63], v[104:107]
    v_mfma_f32_16x16x32_bf16 v[108:111], v[76:79], v[64:67], v[108:111]
    s_add_u32 m0, s38, 0
    s_nop 0
    buffer_load_dwordx4 v2, s[4:7], s40 offen lds
    ds_read_b64_tr_b16 v[72:73], v29 offset:36992
    ds_read_b64_tr_b16 v[74:75], v29 offset:39552
    v_mfma_f32_16x16x32_bf16 v[112:115], v[80:83], v[52:55], v[112:115]
    v_mfma_f32_16x16x32_bf16 v[116:119], v[80:83], v[56:59], v[116:119]
    v_mfma_f32_16x16x32_bf16 v[120:123], v[80:83], v[60:63], v[120:123]
    v_mfma_f32_16x16x32_bf16 v[124:127], v[80:83], v[64:67], v[124:127]
    s_add_u32 m0, s38, 1024
    s_nop 0
    buffer_load_dwordx4 v3, s[4:7], s40 offen lds
    s_add_u32 s40, s40, 64
    ds_read_b64_tr_b16 v[76:77], v30 offset:36992
    ds_read_b64_tr_b16 v[78:79], v30 offset:39552
    v_mfma_f32_16x16x32_bf16 v[128:131], v[84:87], v[52:55], v[128:131]
    v_mfma_f32_16x16x32_bf16 v[132:135], v[84:87], v[56:59], v[132:135]
    v_mfma_f32_16x16x32_bf16 v[136:139], v[84:87], v[60:63], v[136:139]
    v_mfma_f32_16x16x32_bf16 v[140:143], v[84:87], v[64:67], v[140:143]
    s_add_u32 m0, s39, 16384
    s_nop 0
    global_load_lds_dwordx4 v[6:7], off
    v_add_co_u32 v6, vcc, v6, v16
    s_nop 1
    v_addc_co_u32 v7, vcc, 0, v7, vcc
    ds_read_b64_tr_b16 v[80:81], v31 offset:36992
    ds_read_b64_tr_b16 v[82:83], v31 offset:39552
    s_waitcnt lgkmcnt(8)
    v_mfma_f32_16x16x32_bf16 v[144:147], v[88:91], v[52:55], v[144:147]
    v_mfma_f32_16x16x32_bf16 v[148:151], v[88:91], v[56:59], v[148:151]
    v_mfma_f32_16x16x32_bf16 v[152:155], v[88:91], v[60:63], v[152:155]
    v_mfma_f32_16x16x32_bf16 v[156:159], v[88:91], v[64:67], v[156:159]
    s_add_u32 m0, s39, 24576
    s_nop 0
    global_load_lds_dwordx4 v[8:9], off
    v_add_co_u32 v8, vcc, v8, v17
    s_nop 1
    v_addc_co_u32 v9, vcc, 0, v9, vcc
    ds_read_b64_tr_b16 v[84:85], v28 offset:37120
    ds_read_b64_tr_b16 v[86:87], v28 offset:39680
    s_waitcnt lgkmcnt(8)
    v_mfma_f32_16x16x32_bf16 v[160:163], v[68:71], v[52:55], v[160:163]
    v_mfma_f32_16x16x32_bf16 v[164:167], v[68:71], v[56:59], v[164:167]
    v_mfma_f32_16x16x32_bf16 v[168:171], v[68:71], v[60:63], v[168:171]
    v_mfma_f32_16x16x32_bf16 v[172:175], v[68:71], v[64:67], v[172:175]
    s_cmp_ge_u32 s24, 4
    s_cbranch_scc1 G1_sk20
    s_add_u32 m0, s39, 32768
    s_nop 0
    global_load_lds_dwordx4 v[10:11], off
    v_add_co_u32 v10, vcc, v10, v18
    s_nop 1
    v_addc_co_u32 v11, vcc, 0, v11, vcc
G1_sk20:
    ds_read_b64_tr_b16 v[88:89], v29 offset:37120
    ds_read_b64_tr_b16 v[90:91], v29 offset:39680
    ds_read_b128 v[36:39], v22 offset:0
    s_waitcnt lgkmcnt(9)
    v_mfma_f32_16x16x32_bf16 v[176:179], v[72:75], v[52:55], v[176:179]
    v_mfma_f32_16x16x32_bf16 v[180:183], v[72:75], v[56:59], v[180:183]
    v_mfma_f32_16x16x32_bf16 v[184:187], v[72:75], v[60:63], v[184:187]
    v_mfma_f32_16x16x32_bf16 v[188:191], v[72:75], v[64:67], v[188:191]
    ds_read_b64_tr_b16 v[68:69], v32 offset:0
    ds_read_b64_tr_b16 v[70:71], v32 offset:2560
    ds_read_b128 v[40:43], v22 offset:1024
    s_waitcnt lgkmcnt(10)
    v_mfma_f32_16x16x32_bf16 v[192:195], v[76:79], v[52:55], v[192:195]
    v_mfma_f32_16x16x32_bf16 v[196:199], v[76:79], v[56:59], v[196:199]
    v_mfma_f32_16x16x32_bf16 v[200:203], v[76:79], v[60:63], v[200:203]
    v_mfma_f32_16x16x32_bf16 v[204:207], v[76:79], v[64:67], v[204:207]
    ds_read_b64_tr_b16 v[72:73], v33 offset:0
    ds_read_b64_tr_b16 v[74:75], v33 offset:2560
    ds_read_b128 v[44:47], v22 offset:2048
    s_waitcnt lgkmcnt(11)
    v_mfma_f32_16x16x32_bf16 v[208:211], v[80:83], v[52:55], v[208:211]
    v_mfma_f32_16x16x32_bf16 v[212:215], v[80:83], v[56:59], v[212:215]
    v_mfma_f32_16x16x32_bf16 v[216:219], v[80:83], v[60:63], v[216:219]
    v_mfma_f32_16x16x32_bf16 v[220:223], v[80:83], v[64:67], v[220:223]
    ds_read_b64_tr_b16 v[76:77], v34 offset:0
    ds_read_b64_tr_b16 v[78:79], v34 offset:2560
    ds_read_b128 v[48:51], v22 offset:3072
    s_waitcnt lgkmcnt(12)
    v_mfma_f32_16x16x32_bf16 v[224:227], v[84:87], v[52:55], v[224:227]
    v_mfma_f32_16x16x32_bf16 v[228:231], v[84:87], v[56:59], v[228:231]
    v_mfma_f32_16x16x32_bf16 v[232:235], v[84:87], v[60:63], v[232:235]
    v_mfma_f32_16x16x32_bf16 v[236:239], v[84:87], v[64:67], v[236:239]
    ds_read_b64_tr_b16 v[80:81], v35 offset:0
    ds_read_b64_tr_b16 v[82:83], v35 offset:2560
    s_waitcnt lgkmcnt(12)
    v_mfma_f32_16x16x32_bf16 v[240:243], v[88:91], v[52:55], v[240:243]
    v_mfma_f32_16x16x32_bf16 v[244:247], v[88:91], v[56:59], v[244:247]
    v_mfma_f32_16x16x32_bf16 v[248:251], v[88:91], v[60:63], v[248:251]
    v_mfma_f32_16x16x32_bf16 v[252:255], v[88:91], v[64:67], v[252:255]
    s_waitcnt vmcnt(4)
    s_barrier
    ds_read_b64_tr_b16 v[84:85], v32 offset:128
    ds_read_b64_tr_b16 v[86:87], v32 offset:2688
    s_waitcnt lgkmcnt(4)
    v_mfma_f32_16x16x32_bf16 v[96:99], v[68:71], v[36:39], v[96:99]
    v_mfma_f32_16x16x32_bf16 v[100:103], v[68:71], v[40:43], v[100:103]
    v_mfma_f32_16x16x32_bf16 v[104:107], v[68:71], v[44:47], v[104:107]
    v_mfma_f32_16x16x32_bf16 v[108:111], v[68:71], v[48:51], v[108:111]
    s_add_u32 m0, s38, 36864
    s_nop 0
    buffer_load_dwordx4 v2, s[4:7], s40 offen lds
    ds_read_b64_tr_b16 v[88:89], v33 offset:128
    ds_read_b64_tr_b16 v[90:91], v33 offset:2688
    v_mfma_f32_16x16x32_bf16 v[112:115], v[72:75], v[36:39], v[112:115]
    v_mfma_f32_16x16x32_bf16 v[116:119], v[72:75], v[40:43], v[116:119]
    v_mfma_f32_16x16x32_bf16 v[120:123], v[72:75], v[44:47], v[120:123]
    v_mfma_f32_16x16x32_bf16 v[124:127], v[72:75], v[48:51], v[124:127]
    s_add_u32 m0, s38, 37888
    s_nop 0
    buffer_load_dwordx4 v3, s[4:7], s40 offen lds
    s_add_u32 s40, s40, 64
    ds_read_b64_tr_b16 v[68:69], v34 offset:128
    ds_read_b64_tr_b16 v[70:71], v34 offset:2688
    v_mfma_f32_16x16x32_bf16 v[128:131], v[76:79], v[36:39], v[128:131]
    v_mfma_f32_16x16x32_bf16 v[132:135], v[76:79], v[40:43], v[132:135]
    v_mfma_f32_16x16x32_bf16 v[136:139], v[76:79], v[44:47], v[136:139]
    v_mfma_f32_16x16x32_bf16 v[140:143], v[76:79], v[48:51], v[140:143]
    s_add_u32 m0, s39, 53248
    s_nop 0
    global_load_lds_dwordx4 v[6:7], off
    v_add_co_u32 v6, vcc, v6, v16
    s_nop 1
    v_addc_co_u32 v7, vcc, 0, v7, vcc
    ds_read_b64_tr_b16 v[72:73], v35 offset:128
    ds_read_b64_tr_b16 v[74:75], v35 offset:2688
    s_waitcnt lgkmcnt(8)
    v_mfma_f32_16x16x32_bf16 v[144:147], v[80:83], v[36:39], v[144:147]
    v_mfma_f32_16x16x32_bf16 v[148:151], v[80:83], v[40:43], v[148:151]
    v_mfma_f32_16x16x32_bf16 v[152:155], v[80:83], v[44:47], v[152:155]
    v_mfma_f32_16x16x32_bf16 v[156:159], v[80:83], v[48:51], v[156:159]
    s_add_u32 m0, s39, 61440
    s_nop 0
    global_load_lds_dwordx4 v[8:9], off
    v_add_co_u32 v8, vcc, v8, v17
    s_nop 1
    v_addc_co_u32 v9, vcc, 0, v9, vcc
    ds_read_b64_tr_b16 v[76:77], v32 offset:256
    ds_read_b64_tr_b16 v[78:79], v32 offset:2816
    s_waitcnt lgkmcnt(8)
    v_mfma_f32_16x16x32_bf16 v[160:163], v[84:87], v[36:39], v[160:163]
    v_mfma_f32_16x16x32_bf16 v[164:167], v[84:87], v[40:43], v[164:167]
    v_mfma_f32_16x16x32_bf16 v[168:171], v[84:87], v[44:47], v[168:171]
    v_mfma_f32_16x16x32_bf16 v[172:175], v[84:87], v[48:51], v[172:175]
    s_cmp_ge_u32 s24, 4
    s_cbranch_scc1 G1_sk21
    s_add_u32 m0, s39, 69632
    s_nop 0
    global_load_lds_dwordx4 v[10:11], off
    v_add_co_u32 v10, vcc, v10, v18
    s_nop 1
    v_addc_co_u32 v11, vcc, 0, v11, vcc
G1_sk21:
    ds_read_b64_tr_b16 v[80:81], v33 offset:256
    ds_read_b64_tr_b16 v[82:83], v33 offset:2816
    ds_read_b128 v[52:55], v22 offset:36864
    s_waitcnt lgkmcnt(9)
    v_mfma_f32_16x16x32_bf16 v[176:179], v[88:91], v[36:39], v[176:179]
    v_mfma_f32_16x16x32_bf16 v[180:183], v[88:91], v[40:43], v[180:183]
    v_mfma_f32_16x16x32_bf16 v[184:187], v[88:91], v[44:47], v[184:187]
    v_mfma_f32_16x16x32_bf16 v[188:191], v[88:91], v[48:51], v[188:191]
    ds_read_b64_tr_b16 v[84:85], v32 offset:36864
    ds_read_b64_tr_b16 v[86:87], v32 offset:39424
    ds_read_b128 v[56:59], v22 offset:37888
    s_waitcnt lgkmcnt(10)
    v_mfma_f32_16x16x32_bf16 v[192:195], v[68:71], v[36:39], v[192:195]
    v_mfma_f32_16x16x32_bf16 v[196:199], v[68:71], v[40:43], v[196:199]
    v_mfma_f32_16x16x32_bf16 v[200:203], v[68:71], v[44:47], v[200:203]
    v_mfma_f32_16x16x32_bf16 v[204:207], v[68:71], v[48:51], v[204:207]
    ds_read_b64_tr_b16 v[88:89], v33 offset:36864
    ds_read_b64_tr_b16 v[90:91], v33 offset:39424
    ds_read_b128 v[60:63], v22 offset:38912
    s_waitcnt lgkmcnt(11)
    v_mfma_f32_16x16x32_bf16 v[208:211], v[72:75], v[36:39], v[208:211]
    v_mfma_f32_16x16x32_bf16 v[212:215], v[72:75], v[40:43], v[212:215]
    v_mfma_f32_16x16x32_bf16 v[216:219], v[72:75], v[44:47], v[216:219]
    v_mfma_f32_16x16x32_bf16 v[220:223], v[72:75], v[48:51], v[220:223]
    ds_read_b64_tr_b16 v[68:69], v34 offset:36864
    ds_read_b64_tr_b16 v[70:71], v34 offset:39424
    ds_read_b128 v[64:67], v22 offset:39936
    s_waitcnt lgkmcnt(12)
    v_mfma_f32_16x16x32_bf16 v[224:227], v[76:79], v[36:39], v[224:227]
    v_mfma_f32_16x16x32_bf16 v[228:231], v[76:79], v[40:43], v[228:231]
    v_mfma_f32_16x16x32_bf16 v[232:235], v[76:79], v[44:47], v[232:235]
    v_mfma_f32_16x16x32_bf16 v[236:239], v[76:79], v[48:51], v[236:239]
    ds_read_b64_tr_b16 v[72:73], v35 offset:36864
    ds_read_b64_tr_b16 v[74:75], v35 offset:39424
    s_waitcnt lgkmcnt(12)
    v_mfma_f32_16x16x32_bf16 v[240:243], v[80:83], v[36:39], v[240:243]
    v_mfma_f32_16x16x32_bf16 v[244:247], v[80:83], v[40:43], v[244:247]
    v_mfma_f32_16x16x32_bf16 v[248:251], v[80:83], v[44:47], v[248:251]
    v_mfma_f32_16x16x32_bf16 v[252:255], v[80:83], v[48:51], v[252:255]
    s_waitcnt vmcnt(4)
    s_barrier
    ds_read_b64_tr_b16 v[76:77], v32 offset:36992
    ds_read_b64_tr_b16 v[78:79], v32 offset:39552
    s_waitcnt lgkmcnt(4)
    v_mfma_f32_16x16x32_bf16 v[96:99], v[84:87], v[52:55], v[96:99]
    v_mfma_f32_16x16x32_bf16 v[100:103], v[84:87], v[56:59], v[100:103]
    v_mfma_f32_16x16x32_bf16 v[104:107], v[84:87], v[60:63], v[104:107]
    v_mfma_f32_16x16x32_bf16 v[108:111], v[84:87], v[64:67], v[108:111]
    s_add_u32 m0, s38, 73728
    s_nop 0
    buffer_load_dwordx4 v2, s[4:7], s40 offen lds
    ds_read_b64_tr_b16 v[80:81], v33 offset:36992
    ds_read_b64_tr_b16 v[82:83], v33 offset:39552
    v_mfma_f32_16x16x32_bf16 v[112:115], v[88:91], v[52:55], v[112:115]
    v_mfma_f32_16x16x32_bf16 v[116:119], v[88:91], v[56:59], v[116:119]
    v_mfma_f32_16x16x32_bf16 v[120:123], v[88:91], v[60:63], v[120:123]
    v_mfma_f32_16x16x32_bf16 v[124:127], v[88:91], v[64:67], v[124:127]
    s_add_u32 m0, s38, 74752
    s_nop 0
    buffer_load_dwordx4 v3, s[4:7], s40 offen lds
    s_add_u32 s40, s40, 64
    ds_read_b64_tr_b16 v[84:85], v34 offset:36992
    ds_read_b64_tr_b16 v[86:87], v34 offset:39552
    v_mfma_f32_16x16x32_bf16 v[128:131], v[68:71], v[52:55], v[128:131]
    v_mfma_f32_16x16x32_bf16 v[132:135], v[68:71], v[56:59], v[132:135]
    v_mfma_f32_16x16x32_bf16 v[136:139], v[68:71], v[60:63], v[136:139]
    v_mfma_f32_16x16x32_bf16 v[140:143], v[68:71], v[64:67], v[140:143]
    s_add_u32 m0, s39, 90112
    s_nop 0
    global_load_lds_dwordx4 v[6:7], off
    v_add_co_u32 v6, vcc, v6, v16
    s_nop 1
    v_addc_co_u32 v7, vcc, 0, v7, vcc
    ds_read_b64_tr_b16 v[88:89], v35 offset:36992
    ds_read_b64_tr_b16 v[90:91], v35 offset:39552
    s_waitcnt lgkmcnt(8)
    v_mfma_f32_16x16x32_bf16 v[144:147], v[72:75], v[52:55], v[144:147]
    v_mfma_f32_16x16x32_bf16 v[148:151], v[72:75], v[56:59], v[148:151]
    v_mfma_f32_16x16x32_bf16 v[152:155], v[72:75], v[60:63], v[152:155]
    v_mfma_f32_16x16x32_bf16 v[156:159], v[72:75], v[64:67], v[156:159]
    s_add_u32 m0, s39, 98304
    s_nop 0
    global_load_lds_dwordx4 v[8:9], off
    v_add_co_u32 v8, vcc, v8, v17
    s_nop 1
    v_addc_co_u32 v9, vcc, 0, v9, vcc
    ds_read_b64_tr_b16 v[68:69], v32 offset:37120
    ds_read_b64_tr_b16 v[70:71], v32 offset:39680
    s_waitcnt lgkmcnt(8)
    v_mfma_f32_16x16x32_bf16 v[160:163], v[76:79], v[52:55], v[160:163]
    v_mfma_f32_16x16x32_bf16 v[164:167], v[76:79], v[56:59], v[164:167]
    v_mfma_f32_16x16x32_bf16 v[168:171], v[76:79], v[60:63], v[168:171]
    v_mfma_f32_16x16x32_bf16 v[172:175], v[76:79], v[64:67], v[172:175]
    s_cmp_ge_u32 s24, 4
    s_cbranch_scc1 G1_sk22
    s_add_u32 m0, s39, 106496
    s_nop 0
    global_load_lds_dwordx4 v[10:11], off
    v_add_co_u32 v10, vcc, v10, v18
    s_nop 1
    v_addc_co_u32 v11, vcc, 0, v11, vcc
G1_sk22:
    ds_read_b64_tr_b16 v[72:73], v33 offset:37120
    ds_read_b64_tr_b16 v[74:75], v33 offset:39680
    ds_read_b128 v[36:39], v21 offset:0
    s_waitcnt lgkmcnt(9)
    v_mfma_f32_16x16x32_bf16 v[176:179], v[80:83], v[52:55], v[176:179]
    v_mfma_f32_16x16x32_bf16 v[180:183], v[80:83], v[56:59], v[180:183]
    v_mfma_f32_16x16x32_bf16 v[184:187], v[80:83], v[60:63], v[184:187]
    v_mfma_f32_16x16x32_bf16 v[188:191], v[80:83], v[64:67], v[188:191]
    ds_read_b64_tr_b16 v[76:77], v28 offset:0
    ds_read_b64_tr_b16 v[78:79], v28 offset:2560
    ds_read_b128 v[40:43], v21 offset:1024
    s_waitcnt lgkmcnt(10)
    v_mfma_f32_16x16x32_bf16 v[192:195], v[84:87], v[52:55], v[192:195]
    v_mfma_f32_16x16x32_bf16 v[196:199], v[84:87], v[56:59], v[196:199]
    v_mfma_f32_16x16x32_bf16 v[200:203], v[84:87], v[60:63], v[200:203]
    v_mfma_f32_16x16x32_bf16 v[204:207], v[84:87], v[64:67], v[204:207]
    ds_read_b64_tr_b16 v[80:81], v29 offset:0
    ds_read_b64_tr_b16 v[82:83], v29 offset:2560
    ds_read_b128 v[44:47], v21 offset:2048
    s_waitcnt lgkmcnt(11)
    v_mfma_f32_16x16x32_bf16 v[208:211], v[88:91], v[52:55], v[208:211]
    v_mfma_f32_16x16x32_bf16 v[212:215], v[88:91], v[56:59], v[212:215]
    v_mfma_f32_16x16x32_bf16 v[216:219], v[88:91], v[60:63], v[216:219]
    v_mfma_f32_16x16x32_bf16 v[220:223], v[88:91], v[64:67], v[220:223]
    ds_read_b64_tr_b16 v[84:85], v30 offset:0
    ds_read_b64_tr_b16 v[86:87], v30 offset:2560
    ds_read_b128 v[48:51], v21 offset:3072
    s_waitcnt lgkmcnt(12)
    v_mfma_f32_16x16x32_bf16 v[224:227], v[68:71], v[52:55], v[224:227]
    v_mfma_f32_16x16x32_bf16 v[228:231], v[68:71], v[56:59], v[228:231]
    v_mfma_f32_16x16x32_bf16 v[232:235], v[68:71], v[60:63], v[232:235]
    v_mfma_f32_16x16x32_bf16 v[236:239], v[68:71], v[64:67], v[236:239]
    ds_read_b64_tr_b16 v[88:89], v31 offset:0
    ds_read_b64_tr_b16 v[90:91], v31 offset:2560
    s_waitcnt lgkmcnt(12)
    v_mfma_f32_16x16x32_bf16 v[240:243], v[72:75], v[52:55], v[240:243]
    v_mfma_f32_16x16x32_bf16 v[244:247], v[72:75], v[56:59], v[244:247]
    v_mfma_f32_16x16x32_bf16 v[248:251], v[72:75], v[60:63], v[248:251]
    v_mfma_f32_16x16x32_bf16 v[252:255], v[72:75], v[64:67], v[252:255]
    s_waitcnt vmcnt(4)
    s_barrier
    ds_read_b64_tr_b16 v[68:69], v28 offset:128
    ds_read_b64_tr_b16 v[70:71], v28 offset:2688
    s_waitcnt lgkmcnt(4)
    v_mfma_f32_16x16x32_bf16 v[96:99], v[76:79], v[36:39], v[96:99]
    v_mfma_f32_16x16x32_bf16 v[100:103], v[76:79], v[40:43], v[100:103]
    v_mfma_f32_16x16x32_bf16 v[104:107], v[76:79], v[44:47], v[104:107]
    v_mfma_f32_16x16x32_bf16 v[108:111], v[76:79], v[48:51], v[108:111]
    s_add_u32 m0, s38, 110592
    s_nop 0
    buffer_load_dwordx4 v2, s[4:7], s40 offen lds
    ds_read_b64_tr_b16 v[72:73], v29 offset:128
    ds_read_b64_tr_b16 v[74:75], v29 offset:2688
    v_mfma_f32_16x16x32_bf16 v[112:115], v[80:83], v[36:39], v[112:115]
    v_mfma_f32_16x16x32_bf16 v[116:119], v[80:83], v[40:43], v[116:119]
    v_mfma_f32_16x16x32_bf16 v[120:123], v[80:83], v[44:47], v[120:123]
    v_mfma_f32_16x16x32_bf16 v[124:127], v[80:83], v[48:51], v[124:127]
    s_add_u32 m0, s38, 111616
    s_nop 0
    buffer_load_dwordx4 v3, s[4:7], s40 offen lds
    s_add_u32 s40, s40, 64
    ds_read_b64_tr_b16 v[76:77], v30 offset:128
    ds_read_b64_tr_b16 v[78:79], v30 offset:2688
    v_mfma_f32_16x16x32_bf16 v[128:131], v[84:87], v[36:39], v[128:131]
    v_mfma_f32_16x16x32_bf16 v[132:135], v[84:87], v[40:43], v[132:135]
    v_mfma_f32_16x16x32_bf16 v[136:139], v[84:87], v[44:47], v[136:139]
    v_mfma_f32_16x16x32_bf16 v[140:143], v[84:87], v[48:51], v[140:143]
    s_add_u32 m0, s39, 126976
    s_nop 0
    global_load_lds_dwordx4 v[6:7], off
    v_add_co_u32 v6, vcc, v6, v16
    s_nop 1
    v_addc_co_u32 v7, vcc, 0, v7, vcc
    ds_read_b64_tr_b16 v[80:81], v31 offset:128
    ds_read_b64_tr_b16 v[82:83], v31 offset:2688
    s_waitcnt lgkmcnt(8)
    v_mfma_f32_16x16x32_bf16 v[144:147], v[88:91], v[36:39], v[144:147]
    v_mfma_f32_16x16x32_bf16 v[148:151], v[88:91], v[40:43], v[148:151]
    v_mfma_f32_16x16x32_bf16 v[152:155], v[88:91], v[44:47], v[152:155]
    v_mfma_f32_16x16x32_bf16 v[156:159], v[88:91], v[48:51], v[156:159]
    s_add_u32 m0, s39, 135168
    s_nop 0
    global_load_lds_dwordx4 v[8:9], off
    v_add_co_u32 v8, vcc, v8, v17
    s_nop 1
    v_addc_co_u32 v9, vcc, 0, v9, vcc
    ds_read_b64_tr_b16 v[84:85], v28 offset:256
    ds_read_b64_tr_b16 v[86:87], v28 offset:2816
    s_waitcnt lgkmcnt(8)
    v_mfma_f32_16x16x32_bf16 v[160:163], v[68:71], v[36:39], v[160:163]
    v_mfma_f32_16x16x32_bf16 v[164:167], v[68:71], v[40:43], v[164:167]
    v_mfma_f32_16x16x32_bf16 v[168:171], v[68:71], v[44:47], v[168:171]
    v_mfma_f32_16x16x32_bf16 v[172:175], v[68:71], v[48:51], v[172:175]
    s_cmp_ge_u32 s24, 4
    s_cbranch_scc1 G1_sk23
    s_add_u32 m0, s39, 143360
    s_nop 0
    global_load_lds_dwordx4 v[10:11], off
    v_add_co_u32 v10, vcc, v10, v18
    s_nop 1
    v_addc_co_u32 v11, vcc, 0, v11, vcc
G1_sk23:
    ds_read_b64_tr_b16 v[88:89], v29 offset:256
    ds_read_b64_tr_b16 v[90:91], v29 offset:2816
    ds_read_b128 v[52:55], v21 offset:36864
    s_waitcnt lgkmcnt(9)
    v_mfma_f32_16x16x32_bf16 v[176:179], v[72:75], v[36:39], v[176:179]
    v_mfma_f32_16x16x32_bf16 v[180:183], v[72:75], v[40:43], v[180:183]
    v_mfma_f32_16x16x32_bf16 v[184:187], v[72:75], v[44:47], v[184:187]
    v_mfma_f32_16x16x32_bf16 v[188:191], v[72:75], v[48:51], v[188:191]
    ds_read_b64_tr_b16 v[68:69], v28 offset:36864
    ds_read_b64_tr_b16 v[70:71], v28 offset:39424
    ds_read_b128 v[56:59], v21 offset:37888
    s_waitcnt lgkmcnt(10)
    v_mfma_f32_16x16x32_bf16 v[192:195], v[76:79], v[36:39], v[192:195]
    v_mfma_f32_16x16x32_bf16 v[196:199], v[76:79], v[40:43], v[196:199]
    v_mfma_f32_16x16x32_bf16 v[200:203], v[76:79], v[44:47], v[200:203]
    v_mfma_f32_16x16x32_bf16 v[204:207], v[76:79], v[48:51], v[204:207]
    ds_read_b64_tr_b16 v[72:73], v29 offset:36864
    ds_read_b64_tr_b16 v[74:75], v29 offset:39424
    ds_read_b128 v[60:63], v21 offset:38912
    s_waitcnt lgkmcnt(11)
    v_mfma_f32_16x16x32_bf16 v[208:211], v[80:83], v[36:39], v[208:211]
    v_mfma_f32_16x16x32_bf16 v[212:215], v[80:83], v[40:43], v[212:215]
    v_mfma_f32_16x16x32_bf16 v[216:219], v[80:83], v[44:47], v[216:219]
    v_mfma_f32_16x16x32_bf16 v[220:223], v[80:83], v[48:51], v[220:223]
    ds_read_b64_tr_b16 v[76:77], v30 offset:36864
    ds_read_b64_tr_b16 v[78:79], v30 offset:39424
    ds_read_b128 v[64:67], v21 offset:39936
    s_waitcnt lgkmcnt(12)
    v_mfma_f32_16x16x32_bf16 v[224:227], v[84:87], v[36:39], v[224:227]
    v_mfma_f32_16x16x32_bf16 v[228:231], v[84:87], v[40:43], v[228:231]
    v_mfma_f32_16x16x32_bf16 v[232:235], v[84:87], v[44:47], v[232:235]
    v_mfma_f32_16x16x32_bf16 v[236:239], v[84:87], v[48:51], v[236:239]
    ds_read_b64_tr_b16 v[80:81], v31 offset:36864
    ds_read_b64_tr_b16 v[82:83], v31 offset:39424
    s_waitcnt lgkmcnt(12)
    v_mfma_f32_16x16x32_bf16 v[240:243], v[88:91], v[36:39], v[240:243]
    v_mfma_f32_16x16x32_bf16 v[244:247], v[88:91], v[40:43], v[244:247]
    v_mfma_f32_16x16x32_bf16 v[248:251], v[88:91], v[44:47], v[248:251]
    v_mfma_f32_16x16x32_bf16 v[252:255], v[88:91], v[48:51], v[252:255]
    s_waitcnt vmcnt(4)
    s_barrier
    ds_read_b64_tr_b16 v[84:85], v28 offset:36992
    ds_read_b64_tr_b16 v[86:87], v28 offset:39552
    s_waitcnt lgkmcnt(4)
    v_mfma_f32_16x16x32_bf16 v[96:99], v[68:71], v[52:55], v[96:99]
    v_mfma_f32_16x16x32_bf16 v[100:103], v[68:71], v[56:59], v[100:103]
    v_mfma_f32_16x16x32_bf16 v[104:107], v[68:71], v[60:63], v[104:107]
    v_mfma_f32_16x16x32_bf16 v[108:111], v[68:71], v[64:67], v[108:111]
    s_add_u32 m0, s38, 0
    s_nop 0
    buffer_load_dwordx4 v2, s[4:7], s40 offen lds
    ds_read_b64_tr_b16 v[88:89], v29 offset:36992
    ds_read_b64_tr_b16 v[90:91], v29 offset:39552
    v_mfma_f32_16x16x32_bf16 v[112:115], v[72:75], v[52:55], v[112:115]
    v_mfma_f32_16x16x32_bf16 v[116:119], v[72:75], v[56:59], v[116:119]
    v_mfma_f32_16x16x32_bf16 v[120:123], v[72:75], v[60:63], v[120:123]
    v_mfma_f32_16x16x32_bf16 v[124:127], v[72:75], v[64:67], v[124:127]
    s_add_u32 m0, s38, 1024
    s_nop 0
    buffer_load_dwordx4 v3, s[4:7], s40 offen lds
    s_add_u32 s40, s40, 64
    ds_read_b64_tr_b16 v[68:69], v30 offset:36992
    ds_read_b64_tr_b16 v[70:71], v30 offset:39552
    v_mfma_f32_16x16x32_bf16 v[128:131], v[76:79], v[52:55], v[128:131]
    v_mfma_f32_16x16x32_bf16 v[132:135], v[76:79], v[56:59], v[132:135]
    v_mfma_f32_16x16x32_bf16 v[136:139], v[76:79], v[60:63], v[136:139]
    v_mfma_f32_16x16x32_bf16 v[140:143], v[76:79], v[64:67], v[140:143]
    s_add_u32 m0, s39, 16384
    s_nop 0
    global_load_lds_dwordx4 v[6:7], off
    v_add_co_u32 v6, vcc, v6, v16
    s_nop 1
    v_addc_co_u32 v7, vcc, 0, v7, vcc
    ds_read_b64_tr_b16 v[72:73], v31 offset:36992
    ds_read_b64_tr_b16 v[74:75], v31 offset:39552
    s_waitcnt lgkmcnt(8)
    v_mfma_f32_16x16x32_bf16 v[144:147], v[80:83], v[52:55], v[144:147]
    v_mfma_f32_16x16x32_bf16 v[148:151], v[80:83], v[56:59], v[148:151]
    v_mfma_f32_16x16x32_bf16 v[152:155], v[80:83], v[60:63], v[152:155]
    v_mfma_f32_16x16x32_bf16 v[156:159], v[80:83], v[64:67], v[156:159]
    s_add_u32 m0, s39, 24576
    s_nop 0
    global_load_lds_dwordx4 v[8:9], off
    v_add_co_u32 v8, vcc, v8, v17
    s_nop 1
    v_addc_co_u32 v9, vcc, 0, v9, vcc
    ds_read_b64_tr_b16 v[76:77], v28 offset:37120
    ds_read_b64_tr_b16 v[78:79], v28 offset:39680
    s_waitcnt lgkmcnt(8)
    v_mfma_f32_16x16x32_bf16 v[160:163], v[84:87], v[52:55], v[160:163]
    v_mfma_f32_16x16x32_bf16 v[164:167], v[84:87], v[56:59], v[164:167]
    v_mfma_f32_16x16x32_bf16 v[168:171], v[84:87], v[60:63], v[168:171]
    v_mfma_f32_16x16x32_bf16 v[172:175], v[84:87], v[64:67], v[172:175]
    s_cmp_ge_u32 s24, 4
    s_cbranch_scc1 G1_sk24
    s_add_u32 m0, s39, 32768
    s_nop 0
    global_load_lds_dwordx4 v[10:11], off
    v_add_co_u32 v10, vcc, v10, v18
    s_nop 1
    v_addc_co_u32 v11, vcc, 0, v11, vcc
G1_sk24:
    ds_read_b64_tr_b16 v[80:81], v29 offset:37120
    ds_read_b64_tr_b16 v[82:83], v29 offset:39680
    ds_read_b128 v[36:39], v22 offset:0
    s_waitcnt lgkmcnt(9)
    v_mfma_f32_16x16x32_bf16 v[176:179], v[88:91], v[52:55], v[176:179]
    v_mfma_f32_16x16x32_bf16 v[180:183], v[88:91], v[56:59], v[180:183]
    v_mfma_f32_16x16x32_bf16 v[184:187], v[88:91], v[60:63], v[184:187]
    v_mfma_f32_16x16x32_bf16 v[188:191], v[88:91], v[64:67], v[188:191]
    ds_read_b64_tr_b16 v[84:85], v32 offset:0
    ds_read_b64_tr_b16 v[86:87], v32 offset:2560
    ds_read_b128 v[40:43], v22 offset:1024
    s_waitcnt lgkmcnt(10)
    v_mfma_f32_16x16x32_bf16 v[192:195], v[68:71], v[52:55], v[192:195]
    v_mfma_f32_16x16x32_bf16 v[196:199], v[68:71], v[56:59], v[196:199]
    v_mfma_f32_16x16x32_bf16 v[200:203], v[68:71], v[60:63], v[200:203]
    v_mfma_f32_16x16x32_bf16 v[204:207], v[68:71], v[64:67], v[204:207]
    ds_read_b64_tr_b16 v[88:89], v33 offset:0
    ds_read_b64_tr_b16 v[90:91], v33 offset:2560
    ds_read_b128 v[44:47], v22 offset:2048
    s_waitcnt lgkmcnt(11)
    v_mfma_f32_16x16x32_bf16 v[208:211], v[72:75], v[52:55], v[208:211]
    v_mfma_f32_16x16x32_bf16 v[212:215], v[72:75], v[56:59], v[212:215]
    v_mfma_f32_16x16x32_bf16 v[216:219], v[72:75], v[60:63], v[216:219]
    v_mfma_f32_16x16x32_bf16 v[220:223], v[72:75], v[64:67], v[220:223]
    ds_read_b64_tr_b16 v[68:69], v34 offset:0
    ds_read_b64_tr_b16 v[70:71], v34 offset:2560
    ds_read_b128 v[48:51], v22 offset:3072
    s_waitcnt lgkmcnt(12)
    v_mfma_f32_16x16x32_bf16 v[224:227], v[76:79], v[52:55], v[224:227]
    v_mfma_f32_16x16x32_bf16 v[228:231], v[76:79], v[56:59], v[228:231]
    v_mfma_f32_16x16x32_bf16 v[232:235], v[76:79], v[60:63], v[232:235]
    v_mfma_f32_16x16x32_bf16 v[236:239], v[76:79], v[64:67], v[236:239]
    ds_read_b64_tr_b16 v[72:73], v35 offset:0
    ds_read_b64_tr_b16 v[74:75], v35 offset:2560
    s_waitcnt lgkmcnt(12)
    v_mfma_f32_16x16x32_bf16 v[240:243], v[80:83], v[52:55], v[240:243]
    v_mfma_f32_16x16x32_bf16 v[244:247], v[80:83], v[56:59], v[244:247]
    v_mfma_f32_16x16x32_bf16 v[248:251], v[80:83], v[60:63], v[248:251]
    v_mfma_f32_16x16x32_bf16 v[252:255], v[80:83], v[64:67], v[252:255]
    s_waitcnt vmcnt(4)
    s_barrier
    ds_read_b64_tr_b16 v[76:77], v32 offset:128
    ds_read_b64_tr_b16 v[78:79], v32 offset:2688
    s_waitcnt lgkmcnt(4)
    v_mfma_f32_16x16x32_bf16 v[96:99], v[84:87], v[36:39], v[96:99]
    v_mfma_f32_16x16x32_bf16 v[100:103], v[84:87], v[40:43], v[100:103]
    v_mfma_f32_16x16x32_bf16 v[104:107], v[84:87], v[44:47], v[104:107]
    v_mfma_f32_16x16x32_bf16 v[108:111], v[84:87], v[48:51], v[108:111]
    s_add_u32 m0, s38, 36864
    s_nop 0
    buffer_load_dwordx4 v2, s[4:7], s40 offen lds
    ds_read_b64_tr_b16 v[80:81], v33 offset:128
    ds_read_b64_tr_b16 v[82:83], v33 offset:2688
    v_mfma_f32_16x16x32_bf16 v[112:115], v[88:91], v[36:39], v[112:115]
    v_mfma_f32_16x16x32_bf16 v[116:119], v[88:91], v[40:43], v[116:119]
    v_mfma_f32_16x16x32_bf16 v[120:123], v[88:91], v[44:47], v[120:123]
    v_mfma_f32_16x16x32_bf16 v[124:127], v[88:91], v[48:51], v[124:127]
    s_add_u32 m0, s38, 37888
    s_nop 0
    buffer_load_dwordx4 v3, s[4:7], s40 offen lds
    s_add_u32 s40, s40, 64
    ds_read_b64_tr_b16 v[84:85], v34 offset:128
    ds_read_b64_tr_b16 v[86:87], v34 offset:2688
    v_mfma_f32_16x16x32_bf16 v[128:131], v[68:71], v[36:39], v[128:131]
    v_mfma_f32_16x16x32_bf16 v[132:135], v[68:71], v[40:43], v[132:135]
    v_mfma_f32_16x16x32_bf16 v[136:139], v[68:71], v[44:47], v[136:139]
    v_mfma_f32_16x16x32_bf16 v[140:143], v[68:71], v[48:51], v[140:143]
    s_add_u32 m0, s39, 53248
    s_nop 0
    global_load_lds_dwordx4 v[6:7], off
    v_add_co_u32 v6, vcc, v6, v16
    s_nop 1
    v_addc_co_u32 v7, vcc, 0, v7, vcc
    ds_read_b64_tr_b16 v[88:89], v35 offset:128
    ds_read_b64_tr_b16 v[90:91], v35 offset:2688
    s_waitcnt lgkmcnt(8)
    v_mfma_f32_16x16x32_bf16 v[144:147], v[72:75], v[36:39], v[144:147]
    v_mfma_f32_16x16x32_bf16 v[148:151], v[72:75], v[40:43], v[148:151]
    v_mfma_f32_16x16x32_bf16 v[152:155], v[72:75], v[44:47], v[152:155]
    v_mfma_f32_16x16x32_bf16 v[156:159], v[72:75], v[48:51], v[156:159]
    s_add_u32 m0, s39, 61440
    s_nop 0
    global_load_lds_dwordx4 v[8:9], off
    v_add_co_u32 v8, vcc, v8, v17
    s_nop 1
    v_addc_co_u32 v9, vcc, 0, v9, vcc
    ds_read_b64_tr_b16 v[68:69], v32 offset:256
    ds_read_b64_tr_b16 v[70:71], v32 offset:2816
    s_waitcnt lgkmcnt(8)
    v_mfma_f32_16x16x32_bf16 v[160:163], v[76:79], v[36:39], v[160:163]
    v_mfma_f32_16x16x32_bf16 v[164:167], v[76:79], v[40:43], v[164:167]
    v_mfma_f32_16x16x32_bf16 v[168:171], v[76:79], v[44:47], v[168:171]
    v_mfma_f32_16x16x32_bf16 v[172:175], v[76:79], v[48:51], v[172:175]
    s_cmp_ge_u32 s24, 4
    s_cbranch_scc1 G1_sk25
    s_add_u32 m0, s39, 69632
    s_nop 0
    global_load_lds_dwordx4 v[10:11], off
    v_add_co_u32 v10, vcc, v10, v18
    s_nop 1
    v_addc_co_u32 v11, vcc, 0, v11, vcc
G1_sk25:
    ds_read_b64_tr_b16 v[72:73], v33 offset:256
    ds_read_b64_tr_b16 v[74:75], v33 offset:2816
    ds_read_b128 v[52:55], v22 offset:36864
    s_waitcnt lgkmcnt(9)
    v_mfma_f32_16x16x32_bf16 v[176:179], v[80:83], v[36:39], v[176:179]
    v_mfma_f32_16x16x32_bf16 v[180:183], v[80:83], v[40:43], v[180:183]
    v_mfma_f32_16x16x32_bf16 v[184:187], v[80:83], v[44:47], v[184:187]
    v_mfma_f32_16x16x32_bf16 v[188:191], v[80:83], v[48:51], v[188:191]
    ds_read_b64_tr_b16 v[76:77], v32 offset:36864
    ds_read_b64_tr_b16 v[78:79], v32 offset:39424
    ds_read_b128 v[56:59], v22 offset:37888
    s_waitcnt lgkmcnt(10)
    v_mfma_f32_16x16x32_bf16 v[192:195], v[84:87], v[36:39], v[192:195]
    v_mfma_f32_16x16x32_bf16 v[196:199], v[84:87], v[40:43], v[196:199]
    v_mfma_f32_16x16x32_bf16 v[200:203], v[84:87], v[44:47], v[200:203]
    v_mfma_f32_16x16x32_bf16 v[204:207], v[84:87], v[48:51], v[204:207]
    ds_read_b64_tr_b16 v[80:81], v33 offset:36864
    ds_read_b64_tr_b16 v[82:83], v33 offset:39424
    ds_read_b128 v[60:63], v22 offset:38912
    s_waitcnt lgkmcnt(11)
    v_mfma_f32_16x16x32_bf16 v[208:211], v[88:91], v[36:39], v[208:211]
    v_mfma_f32_16x16x32_bf16 v[212:215], v[88:91], v[40:43], v[212:215]
    v_mfma_f32_16x16x32_bf16 v[216:219], v[88:91], v[44:47], v[216:219]
    v_mfma_f32_16x16x32_bf16 v[220:223], v[88:91], v[48:51], v[220:223]
    ds_read_b64_tr_b16 v[84:85], v34 offset:36864
    ds_read_b64_tr_b16 v[86:87], v34 offset:39424
    ds_read_b128 v[64:67], v22 offset:39936
    s_waitcnt lgkmcnt(12)
    v_mfma_f32_16x16x32_bf16 v[224:227], v[68:71], v[36:39], v[224:227]
    v_mfma_f32_16x16x32_bf16 v[228:231], v[68:71], v[40:43], v[228:231]
    v_mfma_f32_16x16x32_bf16 v[232:235], v[68:71], v[44:47], v[232:235]
    v_mfma_f32_16x16x32_bf16 v[236:239], v[68:71], v[48:51], v[236:239]
    ds_read_b64_tr_b16 v[88:89], v35 offset:36864
    ds_read_b64_tr_b16 v[90:91], v35 offset:39424
    s_waitcnt lgkmcnt(12)
    v_mfma_f32_16x16x32_bf16 v[240:243], v[72:75], v[36:39], v[240:243]
    v_mfma_f32_16x16x32_bf16 v[244:247], v[72:75], v[40:43], v[244:247]
    v_mfma_f32_16x16x32_bf16 v[248:251], v[72:75], v[44:47], v[248:251]
    v_mfma_f32_16x16x32_bf16 v[252:255], v[72:75], v[48:51], v[252:255]
    s_waitcnt vmcnt(4)
    s_barrier
    ds_read_b64_tr_b16 v[68:69], v32 offset:36992
    ds_read_b64_tr_b16 v[70:71], v32 offset:39552
    s_waitcnt lgkmcnt(4)
    v_mfma_f32_16x16x32_bf16 v[96:99], v[76:79], v[52:55], v[96:99]
    v_mfma_f32_16x16x32_bf16 v[100:103], v[76:79], v[56:59], v[100:103]
    v_mfma_f32_16x16x32_bf16 v[104:107], v[76:79], v[60:63], v[104:107]
    v_mfma_f32_16x16x32_bf16 v[108:111], v[76:79], v[64:67], v[108:111]
    s_add_u32 m0, s38, 73728
    s_nop 0
    buffer_load_dwordx4 v2, s[4:7], s40 offen lds
    ds_read_b64_tr_b16 v[72:73], v33 offset:36992
    ds_read_b64_tr_b16 v[74:75], v33 offset:39552
    v_mfma_f32_16x16x32_bf16 v[112:115], v[80:83], v[52:55], v[112:115]
    v_mfma_f32_16x16x32_bf16 v[116:119], v[80:83], v[56:59], v[116:119]
    v_mfma_f32_16x16x32_bf16 v[120:123], v[80:83], v[60:63], v[120:123]
    v_mfma_f32_16x16x32_bf16 v[124:127], v[80:83], v[64:67], v[124:127]
    s_add_u32 m0, s38, 74752
    s_nop 0
    buffer_load_dwordx4 v3, s[4:7], s40 offen lds
    s_add_u32 s40, s40, 64
    ds_read_b64_tr_b16 v[76:77], v34 offset:36992
    ds_read_b64_tr_b16 v[78:79], v34 offset:39552
    v_mfma_f32_16x16x32_bf16 v[128:131], v[84:87], v[52:55], v[128:131]
    v_mfma_f32_16x16x32_bf16 v[132:135], v[84:87], v[56:59], v[132:135]
    v_mfma_f32_16x16x32_bf16 v[136:139], v[84:87], v[60:63], v[136:139]
    v_mfma_f32_16x16x32_bf16 v[140:143], v[84:87], v[64:67], v[140:143]
    s_add_u32 m0, s39, 90112
    s_nop 0
    global_load_lds_dwordx4 v[6:7], off
    v_add_co_u32 v6, vcc, v6, v16
    s_nop 1
    v_addc_co_u32 v7, vcc, 0, v7, vcc
    ds_read_b64_tr_b16 v[80:81], v35 offset:36992
    ds_read_b64_tr_b16 v[82:83], v35 offset:39552
    s_waitcnt lgkmcnt(8)
    v_mfma_f32_16x16x32_bf16 v[144:147], v[88:91], v[52:55], v[144:147]
    v_mfma_f32_16x16x32_bf16 v[148:151], v[88:91], v[56:59], v[148:151]
    v_mfma_f32_16x16x32_bf16 v[152:155], v[88:91], v[60:63], v[152:155]
    v_mfma_f32_16x16x32_bf16 v[156:159], v[88:91], v[64:67], v[156:159]
    s_add_u32 m0, s39, 98304
    s_nop 0
    global_load_lds_dwordx4 v[8:9], off
    v_add_co_u32 v8, vcc, v8, v17
    s_nop 1
    v_addc_co_u32 v9, vcc, 0, v9, vcc
    ds_read_b64_tr_b16 v[84:85], v32 offset:37120
    ds_read_b64_tr_b16 v[86:87], v32 offset:39680
    s_waitcnt lgkmcnt(8)
    v_mfma_f32_16x16x32_bf16 v[160:163], v[68:71], v[52:55], v[160:163]
    v_mfma_f32_16x16x32_bf16 v[164:167], v[68:71], v[56:59], v[164:167]
    v_mfma_f32_16x16x32_bf16 v[168:171], v[68:71], v[60:63], v[168:171]
    v_mfma_f32_16x16x32_bf16 v[172:175], v[68:71], v[64:67], v[172:175]
    s_cmp_ge_u32 s24, 4
    s_cbranch_scc1 G1_sk26
    s_add_u32 m0, s39, 106496
    s_nop 0
    global_load_lds_dwordx4 v[10:11], off
    v_add_co_u32 v10, vcc, v10, v18
    s_nop 1
    v_addc_co_u32 v11, vcc, 0, v11, vcc
G1_sk26:
    ds_read_b64_tr_b16 v[88:89], v33 offset:37120
    ds_read_b64_tr_b16 v[90:91], v33 offset:39680
    ds_read_b128 v[36:39], v21 offset:0
    s_waitcnt lgkmcnt(9)
    v_mfma_f32_16x16x32_bf16 v[176:179], v[72:75], v[52:55], v[176:179]
    v_mfma_f32_16x16x32_bf16 v[180:183], v[72:75], v[56:59], v[180:183]
    v_mfma_f32_16x16x32_bf16 v[184:187], v[72:75], v[60:63], v[184:187]
    v_mfma_f32_16x16x32_bf16 v[188:191], v[72:75], v[64:67], v[188:191]
    ds_read_b64_tr_b16 v[68:69], v28 offset:0
    ds_read_b64_tr_b16 v[70:71], v28 offset:2560
    ds_read_b128 v[40:43], v21 offset:1024
    s_waitcnt lgkmcnt(10)
    v_mfma_f32_16x16x32_bf16 v[192:195], v[76:79], v[52:55], v[192:195]
    v_mfma_f32_16x16x32_bf16 v[196:199], v[76:79], v[56:59], v[196:199]
    v_mfma_f32_16x16x32_bf16 v[200:203], v[76:79], v[60:63], v[200:203]
    v_mfma_f32_16x16x32_bf16 v[204:207], v[76:79], v[64:67], v[204:207]
    ds_read_b64_tr_b16 v[72:73], v29 offset:0
    ds_read_b64_tr_b16 v[74:75], v29 offset:2560
    ds_read_b128 v[44:47], v21 offset:2048
    s_waitcnt lgkmcnt(11)
    v_mfma_f32_16x16x32_bf16 v[208:211], v[80:83], v[52:55], v[208:211]
    v_mfma_f32_16x16x32_bf16 v[212:215], v[80:83], v[56:59], v[212:215]
    v_mfma_f32_16x16x32_bf16 v[216:219], v[80:83], v[60:63], v[216:219]
    v_mfma_f32_16x16x32_bf16 v[220:223], v[80:83], v[64:67], v[220:223]
    ds_read_b64_tr_b16 v[76:77], v30 offset:0
    ds_read_b64_tr_b16 v[78:79], v30 offset:2560
    ds_read_b128 v[48:51], v21 offset:3072
    s_waitcnt lgkmcnt(12)
    v_mfma_f32_16x16x32_bf16 v[224:227], v[84:87], v[52:55], v[224:227]
    v_mfma_f32_16x16x32_bf16 v[228:231], v[84:87], v[56:59], v[228:231]
    v_mfma_f32_16x16x32_bf16 v[232:235], v[84:87], v[60:63], v[232:235]
    v_mfma_f32_16x16x32_bf16 v[236:239], v[84:87], v[64:67], v[236:239]
    ds_read_b64_tr_b16 v[80:81], v31 offset:0
    ds_read_b64_tr_b16 v[82:83], v31 offset:2560
    s_waitcnt lgkmcnt(12)
    v_mfma_f32_16x16x32_bf16 v[240:243], v[88:91], v[52:55], v[240:243]
    v_mfma_f32_16x16x32_bf16 v[244:247], v[88:91], v[56:59], v[244:247]
    v_mfma_f32_16x16x32_bf16 v[248:251], v[88:91], v[60:63], v[248:251]
    v_mfma_f32_16x16x32_bf16 v[252:255], v[88:91], v[64:67], v[252:255]
    s_waitcnt vmcnt(4)
    s_barrier
    ds_read_b64_tr_b16 v[84:85], v28 offset:128
    ds_read_b64_tr_b16 v[86:87], v28 offset:2688
    s_waitcnt lgkmcnt(4)
    v_mfma_f32_16x16x32_bf16 v[96:99], v[68:71], v[36:39], v[96:99]
    v_mfma_f32_16x16x32_bf16 v[100:103], v[68:71], v[40:43], v[100:103]
    v_mfma_f32_16x16x32_bf16 v[104:107], v[68:71], v[44:47], v[104:107]
    v_mfma_f32_16x16x32_bf16 v[108:111], v[68:71], v[48:51], v[108:111]
    s_add_u32 m0, s38, 110592
    s_nop 0
    buffer_load_dwordx4 v2, s[4:7], s40 offen lds
    ds_read_b64_tr_b16 v[88:89], v29 offset:128
    ds_read_b64_tr_b16 v[90:91], v29 offset:2688
    v_mfma_f32_16x16x32_bf16 v[112:115], v[72:75], v[36:39], v[112:115]
    v_mfma_f32_16x16x32_bf16 v[116:119], v[72:75], v[40:43], v[116:119]
    v_mfma_f32_16x16x32_bf16 v[120:123], v[72:75], v[44:47], v[120:123]
    v_mfma_f32_16x16x32_bf16 v[124:127], v[72:75], v[48:51], v[124:127]
    s_add_u32 m0, s38, 111616
    s_nop 0
    buffer_load_dwordx4 v3, s[4:7], s40 offen lds
    s_add_u32 s40, s40, 64
    ds_read_b64_tr_b16 v[68:69], v30 offset:128
    ds_read_b64_tr_b16 v[70:71], v30 offset:2688
    v_mfma_f32_16x16x32_bf16 v[128:131], v[76:79], v[36:39], v[128:131]
    v_mfma_f32_16x16x32_bf16 v[132:135], v[76:79], v[40:43], v[132:135]
    v_mfma_f32_16x16x32_bf16 v[136:139], v[76:79], v[44:47], v[136:139]
    v_mfma_f32_16x16x32_bf16 v[140:143], v[76:79], v[48:51], v[140:143]
    s_add_u32 m0, s39, 126976
    s_nop 0
    global_load_lds_dwordx4 v[6:7], off
    v_add_co_u32 v6, vcc, v6, v16
    s_nop 1
    v_addc_co_u32 v7, vcc, 0, v7, vcc
    ds_read_b64_tr_b16 v[72:73], v31 offset:128
    ds_read_b64_tr_b16 v[74:75], v31 offset:2688
    s_waitcnt lgkmcnt(8)
    v_mfma_f32_16x16x32_bf16 v[144:147], v[80:83], v[36:39], v[144:147]
    v_mfma_f32_16x16x32_bf16 v[148:151], v[80:83], v[40:43], v[148:151]
    v_mfma_f32_16x16x32_bf16 v[152:155], v[80:83], v[44:47], v[152:155]
    v_mfma_f32_16x16x32_bf16 v[156:159], v[80:83], v[48:51], v[156:159]
    s_add_u32 m0, s39, 135168
    s_nop 0
    global_load_lds_dwordx4 v[8:9], off
    v_add_co_u32 v8, vcc, v8, v17
    s_nop 1
    v_addc_co_u32 v9, vcc, 0, v9, vcc
    ds_read_b64_tr_b16 v[76:77], v28 offset:256
    ds_read_b64_tr_b16 v[78:79], v28 offset:2816
    s_waitcnt lgkmcnt(8)
    v_mfma_f32_16x16x32_bf16 v[160:163], v[84:87], v[36:39], v[160:163]
    v_mfma_f32_16x16x32_bf16 v[164:167], v[84:87], v[40:43], v[164:167]
    v_mfma_f32_16x16x32_bf16 v[168:171], v[84:87], v[44:47], v[168:171]
    v_mfma_f32_16x16x32_bf16 v[172:175], v[84:87], v[48:51], v[172:175]
    s_cmp_ge_u32 s24, 4
    s_cbranch_scc1 G1_sk27
    s_add_u32 m0, s39, 143360
    s_nop 0
    global_load_lds_dwordx4 v[10:11], off
    v_add_co_u32 v10, vcc, v10, v18
    s_nop 1
    v_addc_co_u32 v11, vcc, 0, v11, vcc
G1_sk27:
    ds_read_b64_tr_b16 v[80:81], v29 offset:256
    ds_read_b64_tr_b16 v[82:83], v29 offset:2816
    ds_read_b128 v[52:55], v21 offset:36864
    s_waitcnt lgkmcnt(9)
    v_mfma_f32_16x16x32_bf16 v[176:179], v[88:91], v[36:39], v[176:179]
    v_mfma_f32_16x16x32_bf16 v[180:183], v[88:91], v[40:43], v[180:183]
    v_mfma_f32_16x16x32_bf16 v[184:187], v[88:91], v[44:47], v[184:187]
    v_mfma_f32_16x16x32_bf16 v[188:191], v[88:91], v[48:51], v[188:191]
    ds_read_b64_tr_b16 v[84:85], v28 offset:36864
    ds_read_b64_tr_b16 v[86:87], v28 offset:39424
    ds_read_b128 v[56:59], v21 offset:37888
    s_waitcnt lgkmcnt(10)
    v_mfma_f32_16x16x32_bf16 v[192:195], v[68:71], v[36:39], v[192:195]
    v_mfma_f32_16x16x32_bf16 v[196:199], v[68:71], v[40:43], v[196:199]
    v_mfma_f32_16x16x32_bf16 v[200:203], v[68:71], v[44:47], v[200:203]
    v_mfma_f32_16x16x32_bf16 v[204:207], v[68:71], v[48:51], v[204:207]
    ds_read_b64_tr_b16 v[88:89], v29 offset:36864
    ds_read_b64_tr_b16 v[90:91], v29 offset:39424
    ds_read_b128 v[60:63], v21 offset:38912
    s_waitcnt lgkmcnt(11)
    v_mfma_f32_16x16x32_bf16 v[208:211], v[72:75], v[36:39], v[208:211]
    v_mfma_f32_16x16x32_bf16 v[212:215], v[72:75], v[40:43], v[212:215]
    v_mfma_f32_16x16x32_bf16 v[216:219], v[72:75], v[44:47], v[216:219]
    v_mfma_f32_16x16x32_bf16 v[220:223], v[72:75], v[48:51], v[220:223]
    ds_read_b64_tr_b16 v[68:69], v30 offset:36864
    ds_read_b64_tr_b16 v[70:71], v30 offset:39424
    ds_read_b128 v[64:67], v21 offset:39936
    s_waitcnt lgkmcnt(12)
    v_mfma_f32_16x16x32_bf16 v[224:227], v[76:79], v[36:39], v[224:227]
    v_mfma_f32_16x16x32_bf16 v[228:231], v[76:79], v[40:43], v[228:231]
    v_mfma_f32_16x16x32_bf16 v[232:235], v[76:79], v[44:47], v[232:235]
    v_mfma_f32_16x16x32_bf16 v[236:239], v[76:79], v[48:51], v[236:239]
    ds_read_b64_tr_b16 v[72:73], v31 offset:36864
    ds_read_b64_tr_b16 v[74:75], v31 offset:39424
    s_waitcnt lgkmcnt(12)
    v_mfma_f32_16x16x32_bf16 v[240:243], v[80:83], v[36:39], v[240:243]
    v_mfma_f32_16x16x32_bf16 v[244:247], v[80:83], v[40:43], v[244:247]
    v_mfma_f32_16x16x32_bf16 v[248:251], v[80:83], v[44:47], v[248:251]
    v_mfma_f32_16x16x32_bf16 v[252:255], v[80:83], v[48:51], v[252:255]
    s_waitcnt vmcnt(4)
    s_barrier
    ds_read_b64_tr_b16 v[76:77], v28 offset:36992
    ds_read_b64_tr_b16 v[78:79], v28 offset:39552
    s_waitcnt lgkmcnt(4)
    v_mfma_f32_16x16x32_bf16 v[96:99], v[84:87], v[52:55], v[96:99]
    v_mfma_f32_16x16x32_bf16 v[100:103], v[84:87], v[56:59], v[100:103]
    v_mfma_f32_16x16x32_bf16 v[104:107], v[84:87], v[60:63], v[104:107]
    v_mfma_f32_16x16x32_bf16 v[108:111], v[84:87], v[64:67], v[108:111]
    s_add_u32 m0, s38, 0
    s_nop 0
    buffer_load_dwordx4 v2, s[4:7], s40 offen lds
    ds_read_b64_tr_b16 v[80:81], v29 offset:36992
    ds_read_b64_tr_b16 v[82:83], v29 offset:39552
    v_mfma_f32_16x16x32_bf16 v[112:115], v[88:91], v[52:55], v[112:115]
    v_mfma_f32_16x16x32_bf16 v[116:119], v[88:91], v[56:59], v[116:119]
    v_mfma_f32_16x16x32_bf16 v[120:123], v[88:91], v[60:63], v[120:123]
    v_mfma_f32_16x16x32_bf16 v[124:127], v[88:91], v[64:67], v[124:127]
    s_add_u32 m0, s38, 1024
    s_nop 0
    buffer_load_dwordx4 v3, s[4:7], s40 offen lds
    s_add_u32 s40, s40, 64
    ds_read_b64_tr_b16 v[84:85], v30 offset:36992
    ds_read_b64_tr_b16 v[86:87], v30 offset:39552
    v_mfma_f32_16x16x32_bf16 v[128:131], v[68:71], v[52:55], v[128:131]
    v_mfma_f32_16x16x32_bf16 v[132:135], v[68:71], v[56:59], v[132:135]
    v_mfma_f32_16x16x32_bf16 v[136:139], v[68:71], v[60:63], v[136:139]
    v_mfma_f32_16x16x32_bf16 v[140:143], v[68:71], v[64:67], v[140:143]
    s_add_u32 m0, s39, 16384
    s_nop 0
    global_load_lds_dwordx4 v[6:7], off
    v_add_co_u32 v6, vcc, v6, v16
    s_nop 1
    v_addc_co_u32 v7, vcc, 0, v7, vcc
    ds_read_b64_tr_b16 v[88:89], v31 offset:36992
    ds_read_b64_tr_b16 v[90:91], v31 offset:39552
    s_waitcnt lgkmcnt(8)
    v_mfma_f32_16x16x32_bf16 v[144:147], v[72:75], v[52:55], v[144:147]
    v_mfma_f32_16x16x32_bf16 v[148:151], v[72:75], v[56:59], v[148:151]
    v_mfma_f32_16x16x32_bf16 v[152:155], v[72:75], v[60:63], v[152:155]
    v_mfma_f32_16x16x32_bf16 v[156:159], v[72:75], v[64:67], v[156:159]
    s_add_u32 m0, s39, 24576
    s_nop 0
    global_load_lds_dwordx4 v[8:9], off
    v_add_co_u32 v8, vcc, v8, v17
    s_nop 1
    v_addc_co_u32 v9, vcc, 0, v9, vcc
    ds_read_b64_tr_b16 v[68:69], v28 offset:37120
    ds_read_b64_tr_b16 v[70:71], v28 offset:39680
    s_waitcnt lgkmcnt(8)
    v_mfma_f32_16x16x32_bf16 v[160:163], v[76:79], v[52:55], v[160:163]
    v_mfma_f32_16x16x32_bf16 v[164:167], v[76:79], v[56:59], v[164:167]
    v_mfma_f32_16x16x32_bf16 v[168:171], v[76:79], v[60:63], v[168:171]
    v_mfma_f32_16x16x32_bf16 v[172:175], v[76:79], v[64:67], v[172:175]
    s_cmp_ge_u32 s24, 4
    s_cbranch_scc1 G1_sk28
    s_add_u32 m0, s39, 32768
    s_nop 0
    global_load_lds_dwordx4 v[10:11], off
    v_add_co_u32 v10, vcc, v10, v18
    s_nop 1
    v_addc_co_u32 v11, vcc, 0, v11, vcc
G1_sk28:
    ds_read_b64_tr_b16 v[72:73], v29 offset:37120
    ds_read_b64_tr_b16 v[74:75], v29 offset:39680
    ds_read_b128 v[36:39], v22 offset:0
    s_waitcnt lgkmcnt(9)
    v_mfma_f32_16x16x32_bf16 v[176:179], v[80:83], v[52:55], v[176:179]
    v_mfma_f32_16x16x32_bf16 v[180:183], v[80:83], v[56:59], v[180:183]
    v_mfma_f32_16x16x32_bf16 v[184:187], v[80:83], v[60:63], v[184:187]
    v_mfma_f32_16x16x32_bf16 v[188:191], v[80:83], v[64:67], v[188:191]
    ds_read_b64_tr_b16 v[76:77], v32 offset:0
    ds_read_b64_tr_b16 v[78:79], v32 offset:2560
    ds_read_b128 v[40:43], v22 offset:1024
    s_waitcnt lgkmcnt(10)
    v_mfma_f32_16x16x32_bf16 v[192:195], v[84:87], v[52:55], v[192:195]
    v_mfma_f32_16x16x32_bf16 v[196:199], v[84:87], v[56:59], v[196:199]
    v_mfma_f32_16x16x32_bf16 v[200:203], v[84:87], v[60:63], v[200:203]
    v_mfma_f32_16x16x32_bf16 v[204:207], v[84:87], v[64:67], v[204:207]
    ds_read_b64_tr_b16 v[80:81], v33 offset:0
    ds_read_b64_tr_b16 v[82:83], v33 offset:2560
    ds_read_b128 v[44:47], v22 offset:2048
    s_waitcnt lgkmcnt(11)
    v_mfma_f32_16x16x32_bf16 v[208:211], v[88:91], v[52:55], v[208:211]
    v_mfma_f32_16x16x32_bf16 v[212:215], v[88:91], v[56:59], v[212:215]
    v_mfma_f32_16x16x32_bf16 v[216:219], v[88:91], v[60:63], v[216:219]
    v_mfma_f32_16x16x32_bf16 v[220:223], v[88:91], v[64:67], v[220:223]
    ds_read_b64_tr_b16 v[84:85], v34 offset:0
    ds_read_b64_tr_b16 v[86:87], v34 offset:2560
    ds_read_b128 v[48:51], v22 offset:3072
    s_waitcnt lgkmcnt(12)
    v_mfma_f32_16x16x32_bf16 v[224:227], v[68:71], v[52:55], v[224:227]
    v_mfma_f32_16x16x32_bf16 v[228:231], v[68:71], v[56:59], v[228:231]
    v_mfma_f32_16x16x32_bf16 v[232:235], v[68:71], v[60:63], v[232:235]
    v_mfma_f32_16x16x32_bf16 v[236:239], v[68:71], v[64:67], v[236:239]
    ds_read_b64_tr_b16 v[88:89], v35 offset:0
    ds_read_b64_tr_b16 v[90:91], v35 offset:2560
    s_waitcnt lgkmcnt(12)
    v_mfma_f32_16x16x32_bf16 v[240:243], v[72:75], v[52:55], v[240:243]
    v_mfma_f32_16x16x32_bf16 v[244:247], v[72:75], v[56:59], v[244:247]
    v_mfma_f32_16x16x32_bf16 v[248:251], v[72:75], v[60:63], v[248:251]
    v_mfma_f32_16x16x32_bf16 v[252:255], v[72:75], v[64:67], v[252:255]
    s_waitcnt vmcnt(4)
    s_barrier
    ds_read_b64_tr_b16 v[68:69], v32 offset:128
    ds_read_b64_tr_b16 v[70:71], v32 offset:2688
    s_waitcnt lgkmcnt(4)
    v_mfma_f32_16x16x32_bf16 v[96:99], v[76:79], v[36:39], v[96:99]
    v_mfma_f32_16x16x32_bf16 v[100:103], v[76:79], v[40:43], v[100:103]
    v_mfma_f32_16x16x32_bf16 v[104:107], v[76:79], v[44:47], v[104:107]
    v_mfma_f32_16x16x32_bf16 v[108:111], v[76:79], v[48:51], v[108:111]
    s_add_u32 m0, s38, 36864
    s_nop 0
    buffer_load_dwordx4 v2, s[4:7], s40 offen lds
    ds_read_b64_tr_b16 v[72:73], v33 offset:128
    ds_read_b64_tr_b16 v[74:75], v33 offset:2688
    v_mfma_f32_16x16x32_bf16 v[112:115], v[80:83], v[36:39], v[112:115]
    v_mfma_f32_16x16x32_bf16 v[116:119], v[80:83], v[40:43], v[116:119]
    v_mfma_f32_16x16x32_bf16 v[120:123], v[80:83], v[44:47], v[120:123]
    v_mfma_f32_16x16x32_bf16 v[124:127], v[80:83], v[48:51], v[124:127]
    s_add_u32 m0, s38, 37888
    s_nop 0
    buffer_load_dwordx4 v3, s[4:7], s40 offen lds
    s_add_u32 s40, s40, 64
    ds_read_b64_tr_b16 v[76:77], v34 offset:128
    ds_read_b64_tr_b16 v[78:79], v34 offset:2688
    v_mfma_f32_16x16x32_bf16 v[128:131], v[84:87], v[36:39], v[128:131]
    v_mfma_f32_16x16x32_bf16 v[132:135], v[84:87], v[40:43], v[132:135]
    v_mfma_f32_16x16x32_bf16 v[136:139], v[84:87], v[44:47], v[136:139]
    v_mfma_f32_16x16x32_bf16 v[140:143], v[84:87], v[48:51], v[140:143]
    s_add_u32 m0, s39, 53248
    s_nop 0
    global_load_lds_dwordx4 v[6:7], off
    v_add_co_u32 v6, vcc, v6, v16
    s_nop 1
    v_addc_co_u32 v7, vcc, 0, v7, vcc
    ds_read_b64_tr_b16 v[80:81], v35 offset:128
    ds_read_b64_tr_b16 v[82:83], v35 offset:2688
    s_waitcnt lgkmcnt(8)
    v_mfma_f32_16x16x32_bf16 v[144:147], v[88:91], v[36:39], v[144:147]
    v_mfma_f32_16x16x32_bf16 v[148:151], v[88:91], v[40:43], v[148:151]
    v_mfma_f32_16x16x32_bf16 v[152:155], v[88:91], v[44:47], v[152:155]
    v_mfma_f32_16x16x32_bf16 v[156:159], v[88:91], v[48:51], v[156:159]
    s_add_u32 m0, s39, 61440
    s_nop 0
    global_load_lds_dwordx4 v[8:9], off
    v_add_co_u32 v8, vcc, v8, v17
    s_nop 1
    v_addc_co_u32 v9, vcc, 0, v9, vcc
    ds_read_b64_tr_b16 v[84:85], v32 offset:256
    ds_read_b64_tr_b16 v[86:87], v32 offset:2816
    s_waitcnt lgkmcnt(8)
    v_mfma_f32_16x16x32_bf16 v[160:163], v[68:71], v[36:39], v[160:163]
    v_mfma_f32_16x16x32_bf16 v[164:167], v[68:71], v[40:43], v[164:167]
    v_mfma_f32_16x16x32_bf16 v[168:171], v[68:71], v[44:47], v[168:171]
    v_mfma_f32_16x16x32_bf16 v[172:175], v[68:71], v[48:51], v[172:175]
    s_cmp_ge_u32 s24, 4
    s_cbranch_scc1 G1_sk29
    s_add_u32 m0, s39, 69632
    s_nop 0
    global_load_lds_dwordx4 v[10:11], off
    v_add_co_u32 v10, vcc, v10, v18
    s_nop 1
    v_addc_co_u32 v11, vcc, 0, v11, vcc
G1_sk29:
    ds_read_b64_tr_b16 v[88:89], v33 offset:256
    ds_read_b64_tr_b16 v[90:91], v33 offset:2816
    ds_read_b128 v[52:55], v22 offset:36864
    s_waitcnt lgkmcnt(9)
    v_mfma_f32_16x16x32_bf16 v[176:179], v[72:75], v[36:39], v[176:179]
    v_mfma_f32_16x16x32_bf16 v[180:183], v[72:75], v[40:43], v[180:183]
    v_mfma_f32_16x16x32_bf16 v[184:187], v[72:75], v[44:47], v[184:187]
    v_mfma_f32_16x16x32_bf16 v[188:191], v[72:75], v[48:51], v[188:191]
    ds_read_b64_tr_b16 v[68:69], v32 offset:36864
    ds_read_b64_tr_b16 v[70:71], v32 offset:39424
    ds_read_b128 v[56:59], v22 offset:37888
    s_waitcnt lgkmcnt(10)
    v_mfma_f32_16x16x32_bf16 v[192:195], v[76:79], v[36:39], v[192:195]
    v_mfma_f32_16x16x32_bf16 v[196:199], v[76:79], v[40:43], v[196:199]
    v_mfma_f32_16x16x32_bf16 v[200:203], v[76:79], v[44:47], v[200:203]
    v_mfma_f32_16x16x32_bf16 v[204:207], v[76:79], v[48:51], v[204:207]
    ds_read_b64_tr_b16 v[72:73], v33 offset:36864
    ds_read_b64_tr_b16 v[74:75], v33 offset:39424
    ds_read_b128 v[60:63], v22 offset:38912
    s_waitcnt lgkmcnt(11)
    v_mfma_f32_16x16x32_bf16 v[208:211], v[80:83], v[36:39], v[208:211]
    v_mfma_f32_16x16x32_bf16 v[212:215], v[80:83], v[40:43], v[212:215]
    v_mfma_f32_16x16x32_bf16 v[216:219], v[80:83], v[44:47], v[216:219]
    v_mfma_f32_16x16x32_bf16 v[220:223], v[80:83], v[48:51], v[220:223]
    ds_read_b64_tr_b16 v[76:77], v34 offset:36864
    ds_read_b64_tr_b16 v[78:79], v34 offset:39424
    ds_read_b128 v[64:67], v22 offset:39936
    s_waitcnt lgkmcnt(12)
    v_mfma_f32_16x16x32_bf16 v[224:227], v[84:87], v[36:39], v[224:227]
    v_mfma_f32_16x16x32_bf16 v[228:231], v[84:87], v[40:43], v[228:231]
    v_mfma_f32_16x16x32_bf16 v[232:235], v[84:87], v[44:47], v[232:235]
    v_mfma_f32_16x16x32_bf16 v[236:239], v[84:87], v[48:51], v[236:239]
    ds_read_b64_tr_b16 v[80:81], v35 offset:36864
    ds_read_b64_tr_b16 v[82:83], v35 offset:39424
    s_waitcnt lgkmcnt(12)
    v_mfma_f32_16x16x32_bf16 v[240:243], v[88:91], v[36:39], v[240:243]
    v_mfma_f32_16x16x32_bf16 v[244:247], v[88:91], v[40:43], v[244:247]
    v_mfma_f32_16x16x32_bf16 v[248:251], v[88:91], v[44:47], v[248:251]
    v_mfma_f32_16x16x32_bf16 v[252:255], v[88:91], v[48:51], v[252:255]
    s_waitcnt vmcnt(4)
    s_barrier
    ds_read_b64_tr_b16 v[84:85], v32 offset:36992
    ds_read_b64_tr_b16 v[86:87], v32 offset:39552
    s_waitcnt lgkmcnt(4)
    v_mfma_f32_16x16x32_bf16 v[96:99], v[68:71], v[52:55], v[96:99]
    v_mfma_f32_16x16x32_bf16 v[100:103], v[68:71], v[56:59], v[100:103]
    v_mfma_f32_16x16x32_bf16 v[104:107], v[68:71], v[60:63], v[104:107]
    v_mfma_f32_16x16x32_bf16 v[108:111], v[68:71], v[64:67], v[108:111]
    s_add_u32 m0, s38, 73728
    s_nop 0
    buffer_load_dwordx4 v2, s[4:7], s40 offen lds
    ds_read_b64_tr_b16 v[88:89], v33 offset:36992
    ds_read_b64_tr_b16 v[90:91], v33 offset:39552
    v_mfma_f32_16x16x32_bf16 v[112:115], v[72:75], v[52:55], v[112:115]
    v_mfma_f32_16x16x32_bf16 v[116:119], v[72:75], v[56:59], v[116:119]
    v_mfma_f32_16x16x32_bf16 v[120:123], v[72:75], v[60:63], v[120:123]
    v_mfma_f32_16x16x32_bf16 v[124:127], v[72:75], v[64:67], v[124:127]
    s_add_u32 m0, s38, 74752
    s_nop 0
    buffer_load_dwordx4 v3, s[4:7], s40 offen lds
    s_add_u32 s40, s40, 64
    ds_read_b64_tr_b16 v[68:69], v34 offset:36992
    ds_read_b64_tr_b16 v[70:71], v34 offset:39552
    v_mfma_f32_16x16x32_bf16 v[128:131], v[76:79], v[52:55], v[128:131]
    v_mfma_f32_16x16x32_bf16 v[132:135], v[76:79], v[56:59], v[132:135]
    v_mfma_f32_16x16x32_bf16 v[136:139], v[76:79], v[60:63], v[136:139]
    v_mfma_f32_16x16x32_bf16 v[140:143], v[76:79], v[64:67], v[140:143]
    s_add_u32 m0, s39, 90112
    s_nop 0
    global_load_lds_dwordx4 v[6:7], off
    v_add_co_u32 v6, vcc, v6, v16
    s_nop 1
    v_addc_co_u32 v7, vcc, 0, v7, vcc
    ds_read_b64_tr_b16 v[72:73], v35 offset:36992
    ds_read_b64_tr_b16 v[74:75], v35 offset:39552
    s_waitcnt lgkmcnt(8)
    v_mfma_f32_16x16x32_bf16 v[144:147], v[80:83], v[52:55], v[144:147]
    v_mfma_f32_16x16x32_bf16 v[148:151], v[80:83], v[56:59], v[148:151]
    v_mfma_f32_16x16x32_bf16 v[152:155], v[80:83], v[60:63], v[152:155]
    v_mfma_f32_16x16x32_bf16 v[156:159], v[80:83], v[64:67], v[156:159]
    s_add_u32 m0, s39, 98304
    s_nop 0
    global_load_lds_dwordx4 v[8:9], off
    v_add_co_u32 v8, vcc, v8, v17
    s_nop 1
    v_addc_co_u32 v9, vcc, 0, v9, vcc
    ds_read_b64_tr_b16 v[76:77], v32 offset:37120
    ds_read_b64_tr_b16 v[78:79], v32 offset:39680
    s_waitcnt lgkmcnt(8)
    v_mfma_f32_16x16x32_bf16 v[160:163], v[84:87], v[52:55], v[160:163]
    v_mfma_f32_16x16x32_bf16 v[164:167], v[84:87], v[56:59], v[164:167]
    v_mfma_f32_16x16x32_bf16 v[168:171], v[84:87], v[60:63], v[168:171]
    v_mfma_f32_16x16x32_bf16 v[172:175], v[84:87], v[64:67], v[172:175]
    s_cmp_ge_u32 s24, 4
    s_cbranch_scc1 G1_sk30
    s_add_u32 m0, s39, 106496
    s_nop 0
    global_load_lds_dwordx4 v[10:11], off
    v_add_co_u32 v10, vcc, v10, v18
    s_nop 1
    v_addc_co_u32 v11, vcc, 0, v11, vcc
G1_sk30:
    ds_read_b64_tr_b16 v[80:81], v33 offset:37120
    ds_read_b64_tr_b16 v[82:83], v33 offset:39680
    ds_read_b128 v[36:39], v21 offset:0
    s_waitcnt lgkmcnt(9)
    v_mfma_f32_16x16x32_bf16 v[176:179], v[88:91], v[52:55], v[176:179]
    v_mfma_f32_16x16x32_bf16 v[180:183], v[88:91], v[56:59], v[180:183]
    v_mfma_f32_16x16x32_bf16 v[184:187], v[88:91], v[60:63], v[184:187]
    v_mfma_f32_16x16x32_bf16 v[188:191], v[88:91], v[64:67], v[188:191]
    ds_read_b64_tr_b16 v[84:85], v28 offset:0
    ds_read_b64_tr_b16 v[86:87], v28 offset:2560
    ds_read_b128 v[40:43], v21 offset:1024
    s_waitcnt lgkmcnt(10)
    v_mfma_f32_16x16x32_bf16 v[192:195], v[68:71], v[52:55], v[192:195]
    v_mfma_f32_16x16x32_bf16 v[196:199], v[68:71], v[56:59], v[196:199]
    v_mfma_f32_16x16x32_bf16 v[200:203], v[68:71], v[60:63], v[200:203]
    v_mfma_f32_16x16x32_bf16 v[204:207], v[68:71], v[64:67], v[204:207]
    ds_read_b64_tr_b16 v[88:89], v29 offset:0
    ds_read_b64_tr_b16 v[90:91], v29 offset:2560
    ds_read_b128 v[44:47], v21 offset:2048
    s_waitcnt lgkmcnt(11)
    v_mfma_f32_16x16x32_bf16 v[208:211], v[72:75], v[52:55], v[208:211]
    v_mfma_f32_16x16x32_bf16 v[212:215], v[72:75], v[56:59], v[212:215]
    v_mfma_f32_16x16x32_bf16 v[216:219], v[72:75], v[60:63], v[216:219]
    v_mfma_f32_16x16x32_bf16 v[220:223], v[72:75], v[64:67], v[220:223]
    ds_read_b64_tr_b16 v[68:69], v30 offset:0
    ds_read_b64_tr_b16 v[70:71], v30 offset:2560
    ds_read_b128 v[48:51], v21 offset:3072
    s_waitcnt lgkmcnt(12)
    v_mfma_f32_16x16x32_bf16 v[224:227], v[76:79], v[52:55], v[224:227]
    v_mfma_f32_16x16x32_bf16 v[228:231], v[76:79], v[56:59], v[228:231]
    v_mfma_f32_16x16x32_bf16 v[232:235], v[76:79], v[60:63], v[232:235]
    v_mfma_f32_16x16x32_bf16 v[236:239], v[76:79], v[64:67], v[236:239]
    ds_read_b64_tr_b16 v[72:73], v31 offset:0
    ds_read_b64_tr_b16 v[74:75], v31 offset:2560
    s_waitcnt lgkmcnt(12)
    v_mfma_f32_16x16x32_bf16 v[240:243], v[80:83], v[52:55], v[240:243]
    v_mfma_f32_16x16x32_bf16 v[244:247], v[80:83], v[56:59], v[244:247]
    v_mfma_f32_16x16x32_bf16 v[248:251], v[80:83], v[60:63], v[248:251]
    v_mfma_f32_16x16x32_bf16 v[252:255], v[80:83], v[64:67], v[252:255]
    s_waitcnt vmcnt(4)
    s_barrier
    ds_read_b64_tr_b16 v[76:77], v28 offset:128
    ds_read_b64_tr_b16 v[78:79], v28 offset:2688
    s_waitcnt lgkmcnt(4)
    v_mfma_f32_16x16x32_bf16 v[96:99], v[84:87], v[36:39], v[96:99]
    v_mfma_f32_16x16x32_bf16 v[100:103], v[84:87], v[40:43], v[100:103]
    v_mfma_f32_16x16x32_bf16 v[104:107], v[84:87], v[44:47], v[104:107]
    v_mfma_f32_16x16x32_bf16 v[108:111], v[84:87], v[48:51], v[108:111]
    s_add_u32 m0, s38, 110592
    s_nop 0
    buffer_load_dwordx4 v2, s[4:7], s40 offen lds
    ds_read_b64_tr_b16 v[80:81], v29 offset:128
    ds_read_b64_tr_b16 v[82:83], v29 offset:2688
    v_mfma_f32_16x16x32_bf16 v[112:115], v[88:91], v[36:39], v[112:115]
    v_mfma_f32_16x16x32_bf16 v[116:119], v[88:91], v[40:43], v[116:119]
    v_mfma_f32_16x16x32_bf16 v[120:123], v[88:91], v[44:47], v[120:123]
    v_mfma_f32_16x16x32_bf16 v[124:127], v[88:91], v[48:51], v[124:127]
    s_add_u32 m0, s38, 111616
    s_nop 0
    buffer_load_dwordx4 v3, s[4:7], s40 offen lds
    s_add_u32 s40, s40, 64
    ds_read_b64_tr_b16 v[84:85], v30 offset:128
    ds_read_b64_tr_b16 v[86:87], v30 offset:2688
    v_mfma_f32_16x16x32_bf16 v[128:131], v[68:71], v[36:39], v[128:131]
    v_mfma_f32_16x16x32_bf16 v[132:135], v[68:71], v[40:43], v[132:135]
    v_mfma_f32_16x16x32_bf16 v[136:139], v[68:71], v[44:47], v[136:139]
    v_mfma_f32_16x16x32_bf16 v[140:143], v[68:71], v[48:51], v[140:143]
    s_add_u32 m0, s39, 126976
    s_nop 0
    global_load_lds_dwordx4 v[6:7], off
    v_add_co_u32 v6, vcc, v6, v16
    s_nop 1
    v_addc_co_u32 v7, vcc, 0, v7, vcc
    ds_read_b64_tr_b16 v[88:89], v31 offset:128
    ds_read_b64_tr_b16 v[90:91], v31 offset:2688
    s_waitcnt lgkmcnt(8)
    v_mfma_f32_16x16x32_bf16 v[144:147], v[72:75], v[36:39], v[144:147]
    v_mfma_f32_16x16x32_bf16 v[148:151], v[72:75], v[40:43], v[148:151]
    v_mfma_f32_16x16x32_bf16 v[152:155], v[72:75], v[44:47], v[152:155]
    v_mfma_f32_16x16x32_bf16 v[156:159], v[72:75], v[48:51], v[156:159]
    s_add_u32 m0, s39, 135168
    s_nop 0
    global_load_lds_dwordx4 v[8:9], off
    v_add_co_u32 v8, vcc, v8, v17
    s_nop 1
    v_addc_co_u32 v9, vcc, 0, v9, vcc
    ds_read_b64_tr_b16 v[68:69], v28 offset:256
    ds_read_b64_tr_b16 v[70:71], v28 offset:2816
    s_waitcnt lgkmcnt(8)
    v_mfma_f32_16x16x32_bf16 v[160:163], v[76:79], v[36:39], v[160:163]
    v_mfma_f32_16x16x32_bf16 v[164:167], v[76:79], v[40:43], v[164:167]
    v_mfma_f32_16x16x32_bf16 v[168:171], v[76:79], v[44:47], v[168:171]
    v_mfma_f32_16x16x32_bf16 v[172:175], v[76:79], v[48:51], v[172:175]
    s_cmp_ge_u32 s24, 4
    s_cbranch_scc1 G1_sk31
    s_add_u32 m0, s39, 143360
    s_nop 0
    global_load_lds_dwordx4 v[10:11], off
    v_add_co_u32 v10, vcc, v10, v18
    s_nop 1
    v_addc_co_u32 v11, vcc, 0, v11, vcc
G1_sk31:
    ds_read_b64_tr_b16 v[72:73], v29 offset:256
    ds_read_b64_tr_b16 v[74:75], v29 offset:2816
    ds_read_b128 v[52:55], v21 offset:36864
    s_waitcnt lgkmcnt(9)
    v_mfma_f32_16x16x32_bf16 v[176:179], v[80:83], v[36:39], v[176:179]
    v_mfma_f32_16x16x32_bf16 v[180:183], v[80:83], v[40:43], v[180:183]
    v_mfma_f32_16x16x32_bf16 v[184:187], v[80:83], v[44:47], v[184:187]
    v_mfma_f32_16x16x32_bf16 v[188:191], v[80:83], v[48:51], v[188:191]
    ds_read_b64_tr_b16 v[76:77], v28 offset:36864
    ds_read_b64_tr_b16 v[78:79], v28 offset:39424
    ds_read_b128 v[56:59], v21 offset:37888
    s_waitcnt lgkmcnt(10)
    v_mfma_f32_16x16x32_bf16 v[192:195], v[84:87], v[36:39], v[192:195]
    v_mfma_f32_16x16x32_bf16 v[196:199], v[84:87], v[40:43], v[196:199]
    v_mfma_f32_16x16x32_bf16 v[200:203], v[84:87], v[44:47], v[200:203]
    v_mfma_f32_16x16x32_bf16 v[204:207], v[84:87], v[48:51], v[204:207]
    ds_read_b64_tr_b16 v[80:81], v29 offset:36864
    ds_read_b64_tr_b16 v[82:83], v29 offset:39424
    ds_read_b128 v[60:63], v21 offset:38912
    s_waitcnt lgkmcnt(11)
    v_mfma_f32_16x16x32_bf16 v[208:211], v[88:91], v[36:39], v[208:211]
    v_mfma_f32_16x16x32_bf16 v[212:215], v[88:91], v[40:43], v[212:215]
    v_mfma_f32_16x16x32_bf16 v[216:219], v[88:91], v[44:47], v[216:219]
    v_mfma_f32_16x16x32_bf16 v[220:223], v[88:91], v[48:51], v[220:223]
    ds_read_b64_tr_b16 v[84:85], v30 offset:36864
    ds_read_b64_tr_b16 v[86:87], v30 offset:39424
    ds_read_b128 v[64:67], v21 offset:39936
    s_waitcnt lgkmcnt(12)
    v_mfma_f32_16x16x32_bf16 v[224:227], v[68:71], v[36:39], v[224:227]
    v_mfma_f32_16x16x32_bf16 v[228:231], v[68:71], v[40:43], v[228:231]
    v_mfma_f32_16x16x32_bf16 v[232:235], v[68:71], v[44:47], v[232:235]
    v_mfma_f32_16x16x32_bf16 v[236:239], v[68:71], v[48:51], v[236:239]
    ds_read_b64_tr_b16 v[88:89], v31 offset:36864
    ds_read_b64_tr_b16 v[90:91], v31 offset:39424
    s_waitcnt lgkmcnt(12)
    v_mfma_f32_16x16x32_bf16 v[240:243], v[72:75], v[36:39], v[240:243]
    v_mfma_f32_16x16x32_bf16 v[244:247], v[72:75], v[40:43], v[244:247]
    v_mfma_f32_16x16x32_bf16 v[248:251], v[72:75], v[44:47], v[248:251]
    v_mfma_f32_16x16x32_bf16 v[252:255], v[72:75], v[48:51], v[252:255]
    s_waitcnt vmcnt(4)
    s_barrier
    ds_read_b64_tr_b16 v[68:69], v28 offset:36992
    ds_read_b64_tr_b16 v[70:71], v28 offset:39552
    s_waitcnt lgkmcnt(4)
    v_mfma_f32_16x16x32_bf16 v[96:99], v[76:79], v[52:55], v[96:99]
    v_mfma_f32_16x16x32_bf16 v[100:103], v[76:79], v[56:59], v[100:103]
    v_mfma_f32_16x16x32_bf16 v[104:107], v[76:79], v[60:63], v[104:107]
    v_mfma_f32_16x16x32_bf16 v[108:111], v[76:79], v[64:67], v[108:111]
    ds_read_b64_tr_b16 v[72:73], v29 offset:36992
    ds_read_b64_tr_b16 v[74:75], v29 offset:39552
    v_mfma_f32_16x16x32_bf16 v[112:115], v[80:83], v[52:55], v[112:115]
    v_mfma_f32_16x16x32_bf16 v[116:119], v[80:83], v[56:59], v[116:119]
    v_mfma_f32_16x16x32_bf16 v[120:123], v[80:83], v[60:63], v[120:123]
    v_mfma_f32_16x16x32_bf16 v[124:127], v[80:83], v[64:67], v[124:127]
    ds_read_b64_tr_b16 v[76:77], v30 offset:36992
    ds_read_b64_tr_b16 v[78:79], v30 offset:39552
    v_mfma_f32_16x16x32_bf16 v[128:131], v[84:87], v[52:55], v[128:131]
    v_mfma_f32_16x16x32_bf16 v[132:135], v[84:87], v[56:59], v[132:135]
    v_mfma_f32_16x16x32_bf16 v[136:139], v[84:87], v[60:63], v[136:139]
    v_mfma_f32_16x16x32_bf16 v[140:143], v[84:87], v[64:67], v[140:143]
    ds_read_b64_tr_b16 v[80:81], v31 offset:36992
    ds_read_b64_tr_b16 v[82:83], v31 offset:39552
    s_waitcnt lgkmcnt(8)
    v_mfma_f32_16x16x32_bf16 v[144:147], v[88:91], v[52:55], v[144:147]
    v_mfma_f32_16x16x32_bf16 v[148:151], v[88:91], v[56:59], v[148:151]
    v_mfma_f32_16x16x32_bf16 v[152:155], v[88:91], v[60:63], v[152:155]
    v_mfma_f32_16x16x32_bf16 v[156:159], v[88:91], v[64:67], v[156:159]
    ds_read_b64_tr_b16 v[84:85], v28 offset:37120
    ds_read_b64_tr_b16 v[86:87], v28 offset:39680
    s_waitcnt lgkmcnt(8)
    v_mfma_f32_16x16x32_bf16 v[160:163], v[68:71], v[52:55], v[160:163]
    v_mfma_f32_16x16x32_bf16 v[164:167], v[68:71], v[56:59], v[164:167]
    v_mfma_f32_16x16x32_bf16 v[168:171], v[68:71], v[60:63], v[168:171]
    v_mfma_f32_16x16x32_bf16 v[172:175], v[68:71], v[64:67], v[172:175]
    ds_read_b64_tr_b16 v[88:89], v29 offset:37120
    ds_read_b64_tr_b16 v[90:91], v29 offset:39680
    ds_read_b128 v[36:39], v22 offset:0
    s_waitcnt lgkmcnt(9)
    v_mfma_f32_16x16x32_bf16 v[176:179], v[72:75], v[52:55], v[176:179]
    v_mfma_f32_16x16x32_bf16 v[180:183], v[72:75], v[56:59], v[180:183]
    v_mfma_f32_16x16x32_bf16 v[184:187], v[72:75], v[60:63], v[184:187]
    v_mfma_f32_16x16x32_bf16 v[188:191], v[72:75], v[64:67], v[188:191]
    ds_read_b64_tr_b16 v[68:69], v32 offset:0
    ds_read_b64_tr_b16 v[70:71], v32 offset:2560
    ds_read_b128 v[40:43], v22 offset:1024
    s_waitcnt lgkmcnt(10)
    v_mfma_f32_16x16x32_bf16 v[192:195], v[76:79], v[52:55], v[192:195]
    v_mfma_f32_16x16x32_bf16 v[196:199], v[76:79], v[56:59], v[196:199]
    v_mfma_f32_16x16x32_bf16 v[200:203], v[76:79], v[60:63], v[200:203]
    v_mfma_f32_16x16x32_bf16 v[204:207], v[76:79], v[64:67], v[204:207]
    ds_read_b64_tr_b16 v[72:73], v33 offset:0
    ds_read_b64_tr_b16 v[74:75], v33 offset:2560
    ds_read_b128 v[44:47], v22 offset:2048
    s_waitcnt lgkmcnt(11)
    v_mfma_f32_16x16x32_bf16 v[208:211], v[80:83], v[52:55], v[208:211]
    v_mfma_f32_16x16x32_bf16 v[212:215], v[80:83], v[56:59], v[212:215]
    v_mfma_f32_16x16x32_bf16 v[216:219], v[80:83], v[60:63], v[216:219]
    v_mfma_f32_16x16x32_bf16 v[220:223], v[80:83], v[64:67], v[220:223]
    ds_read_b64_tr_b16 v[76:77], v34 offset:0
    ds_read_b64_tr_b16 v[78:79], v34 offset:2560
    ds_read_b128 v[48:51], v22 offset:3072
    s_waitcnt lgkmcnt(12)
    v_mfma_f32_16x16x32_bf16 v[224:227], v[84:87], v[52:55], v[224:227]
    v_mfma_f32_16x16x32_bf16 v[228:231], v[84:87], v[56:59], v[228:231]
    v_mfma_f32_16x16x32_bf16 v[232:235], v[84:87], v[60:63], v[232:235]
    v_mfma_f32_16x16x32_bf16 v[236:239], v[84:87], v[64:67], v[236:239]
    ds_read_b64_tr_b16 v[80:81], v35 offset:0
    ds_read_b64_tr_b16 v[82:83], v35 offset:2560
    s_waitcnt lgkmcnt(12)
    v_mfma_f32_16x16x32_bf16 v[240:243], v[88:91], v[52:55], v[240:243]
    v_mfma_f32_16x16x32_bf16 v[244:247], v[88:91], v[56:59], v[244:247]
    v_mfma_f32_16x16x32_bf16 v[248:251], v[88:91], v[60:63], v[248:251]
    v_mfma_f32_16x16x32_bf16 v[252:255], v[88:91], v[64:67], v[252:255]
    s_waitcnt vmcnt(0)
    s_barrier
    ds_read_b64_tr_b16 v[84:85], v32 offset:128
    ds_read_b64_tr_b16 v[86:87], v32 offset:2688
    s_waitcnt lgkmcnt(4)
    v_mfma_f32_16x16x32_bf16 v[96:99], v[68:71], v[36:39], v[96:99]
    v_mfma_f32_16x16x32_bf16 v[100:103], v[68:71], v[40:43], v[100:103]
    v_mfma_f32_16x16x32_bf16 v[104:107], v[68:71], v[44:47], v[104:107]
    v_mfma_f32_16x16x32_bf16 v[108:111], v[68:71], v[48:51], v[108:111]
    ds_read_b64_tr_b16 v[88:89], v33 offset:128
    ds_read_b64_tr_b16 v[90:91], v33 offset:2688
    v_mfma_f32_16x16x32_bf16 v[112:115], v[72:75], v[36:39], v[112:115]
    v_mfma_f32_16x16x32_bf16 v[116:119], v[72:75], v[40:43], v[116:119]
    v_mfma_f32_16x16x32_bf16 v[120:123], v[72:75], v[44:47], v[120:123]
    v_mfma_f32_16x16x32_bf16 v[124:127], v[72:75], v[48:51], v[124:127]
    ds_read_b64_tr_b16 v[68:69], v34 offset:128
    ds_read_b64_tr_b16 v[70:71], v34 offset:2688
    v_mfma_f32_16x16x32_bf16 v[128:131], v[76:79], v[36:39], v[128:131]
    v_mfma_f32_16x16x32_bf16 v[132:135], v[76:79], v[40:43], v[132:135]
    v_mfma_f32_16x16x32_bf16 v[136:139], v[76:79], v[44:47], v[136:139]
    v_mfma_f32_16x16x32_bf16 v[140:143], v[76:79], v[48:51], v[140:143]
    ds_read_b64_tr_b16 v[72:73], v35 offset:128
    ds_read_b64_tr_b16 v[74:75], v35 offset:2688
    s_waitcnt lgkmcnt(8)
    v_mfma_f32_16x16x32_bf16 v[144:147], v[80:83], v[36:39], v[144:147]
    v_mfma_f32_16x16x32_bf16 v[148:151], v[80:83], v[40:43], v[148:151]
    v_mfma_f32_16x16x32_bf16 v[152:155], v[80:83], v[44:47], v[152:155]
    v_mfma_f32_16x16x32_bf16 v[156:159], v[80:83], v[48:51], v[156:159]
    ds_read_b64_tr_b16 v[76:77], v32 offset:256
    ds_read_b64_tr_b16 v[78:79], v32 offset:2816
    s_waitcnt lgkmcnt(8)
    v_mfma_f32_16x16x32_bf16 v[160:163], v[84:87], v[36:39], v[160:163]
    v_mfma_f32_16x16x32_bf16 v[164:167], v[84:87], v[40:43], v[164:167]
    v_mfma_f32_16x16x32_bf16 v[168:171], v[84:87], v[44:47], v[168:171]
    v_mfma_f32_16x16x32_bf16 v[172:175], v[84:87], v[48:51], v[172:175]
    ds_read_b64_tr_b16 v[80:81], v33 offset:256
    ds_read_b64_tr_b16 v[82:83], v33 offset:2816
    ds_read_b128 v[52:55], v22 offset:36864
    s_waitcnt lgkmcnt(9)
    v_mfma_f32_16x16x32_bf16 v[176:179], v[88:91], v[36:39], v[176:179]
    v_mfma_f32_16x16x32_bf16 v[180:183], v[88:91], v[40:43], v[180:183]
    v_mfma_f32_16x16x32_bf16 v[184:187], v[88:91], v[44:47], v[184:187]
    v_mfma_f32_16x16x32_bf16 v[188:191], v[88:91], v[48:51], v[188:191]
    ds_read_b64_tr_b16 v[84:85], v32 offset:36864
    ds_read_b64_tr_b16 v[86:87], v32 offset:39424
    ds_read_b128 v[56:59], v22 offset:37888
    s_waitcnt lgkmcnt(10)
    v_mfma_f32_16x16x32_bf16 v[192:195], v[68:71], v[36:39], v[192:195]
    v_mfma_f32_16x16x32_bf16 v[196:199], v[68:71], v[40:43], v[196:199]
    v_mfma_f32_16x16x32_bf16 v[200:203], v[68:71], v[44:47], v[200:203]
    v_mfma_f32_16x16x32_bf16 v[204:207], v[68:71], v[48:51], v[204:207]
    ds_read_b64_tr_b16 v[88:89], v33 offset:36864
    ds_read_b64_tr_b16 v[90:91], v33 offset:39424
    ds_read_b128 v[60:63], v22 offset:38912
    s_waitcnt lgkmcnt(11)
    v_mfma_f32_16x16x32_bf16 v[208:211], v[72:75], v[36:39], v[208:211]
    v_mfma_f32_16x16x32_bf16 v[212:215], v[72:75], v[40:43], v[212:215]
    v_mfma_f32_16x16x32_bf16 v[216:219], v[72:75], v[44:47], v[216:219]
    v_mfma_f32_16x16x32_bf16 v[220:223], v[72:75], v[48:51], v[220:223]
    ds_read_b64_tr_b16 v[68:69], v34 offset:36864
    ds_read_b64_tr_b16 v[70:71], v34 offset:39424
    ds_read_b128 v[64:67], v22 offset:39936
    s_waitcnt lgkmcnt(12)
    v_mfma_f32_16x16x32_bf16 v[224:227], v[76:79], v[36:39], v[224:227]
    v_mfma_f32_16x16x32_bf16 v[228:231], v[76:79], v[40:43], v[228:231]
    v_mfma_f32_16x16x32_bf16 v[232:235], v[76:79], v[44:47], v[232:235]
    v_mfma_f32_16x16x32_bf16 v[236:239], v[76:79], v[48:51], v[236:239]
    ds_read_b64_tr_b16 v[72:73], v35 offset:36864
    ds_read_b64_tr_b16 v[74:75], v35 offset:39424
    s_waitcnt lgkmcnt(12)
    v_mfma_f32_16x16x32_bf16 v[240:243], v[80:83], v[36:39], v[240:243]
    v_mfma_f32_16x16x32_bf16 v[244:247], v[80:83], v[40:43], v[244:247]
    v_mfma_f32_16x16x32_bf16 v[248:251], v[80:83], v[44:47], v[248:251]
    v_mfma_f32_16x16x32_bf16 v[252:255], v[80:83], v[48:51], v[252:255]
    ds_read_b64_tr_b16 v[76:77], v32 offset:36992
    ds_read_b64_tr_b16 v[78:79], v32 offset:39552
    s_waitcnt lgkmcnt(4)
    v_mfma_f32_16x16x32_bf16 v[96:99], v[84:87], v[52:55], v[96:99]
    v_mfma_f32_16x16x32_bf16 v[100:103], v[84:87], v[56:59], v[100:103]
    v_mfma_f32_16x16x32_bf16 v[104:107], v[84:87], v[60:63], v[104:107]
    v_mfma_f32_16x16x32_bf16 v[108:111], v[84:87], v[64:67], v[108:111]
    ds_read_b64_tr_b16 v[80:81], v33 offset:36992
    ds_read_b64_tr_b16 v[82:83], v33 offset:39552
    v_mfma_f32_16x16x32_bf16 v[112:115], v[88:91], v[52:55], v[112:115]
    v_mfma_f32_16x16x32_bf16 v[116:119], v[88:91], v[56:59], v[116:119]
    v_mfma_f32_16x16x32_bf16 v[120:123], v[88:91], v[60:63], v[120:123]
    v_mfma_f32_16x16x32_bf16 v[124:127], v[88:91], v[64:67], v[124:127]
    ds_read_b64_tr_b16 v[84:85], v34 offset:36992
    ds_read_b64_tr_b16 v[86:87], v34 offset:39552
    v_mfma_f32_16x16x32_bf16 v[128:131], v[68:71], v[52:55], v[128:131]
    v_mfma_f32_16x16x32_bf16 v[132:135], v[68:71], v[56:59], v[132:135]
    v_mfma_f32_16x16x32_bf16 v[136:139], v[68:71], v[60:63], v[136:139]
    v_mfma_f32_16x16x32_bf16 v[140:143], v[68:71], v[64:67], v[140:143]
    ds_read_b64_tr_b16 v[88:89], v35 offset:36992
    ds_read_b64_tr_b16 v[90:91], v35 offset:39552
    s_waitcnt lgkmcnt(8)
    v_mfma_f32_16x16x32_bf16 v[144:147], v[72:75], v[52:55], v[144:147]
    v_mfma_f32_16x16x32_bf16 v[148:151], v[72:75], v[56:59], v[148:151]
    v_mfma_f32_16x16x32_bf16 v[152:155], v[72:75], v[60:63], v[152:155]
    v_mfma_f32_16x16x32_bf16 v[156:159], v[72:75], v[64:67], v[156:159]
    ds_read_b64_tr_b16 v[68:69], v32 offset:37120
    ds_read_b64_tr_b16 v[70:71], v32 offset:39680
    s_waitcnt lgkmcnt(8)
    v_mfma_f32_16x16x32_bf16 v[160:163], v[76:79], v[52:55], v[160:163]
    v_mfma_f32_16x16x32_bf16 v[164:167], v[76:79], v[56:59], v[164:167]
    v_mfma_f32_16x16x32_bf16 v[168:171], v[76:79], v[60:63], v[168:171]
    v_mfma_f32_16x16x32_bf16 v[172:175], v[76:79], v[64:67], v[172:175]
    ds_read_b64_tr_b16 v[72:73], v33 offset:37120
    ds_read_b64_tr_b16 v[74:75], v33 offset:39680
    s_waitcnt lgkmcnt(8)
    v_mfma_f32_16x16x32_bf16 v[176:179], v[80:83], v[52:55], v[176:179]
    v_mfma_f32_16x16x32_bf16 v[180:183], v[80:83], v[56:59], v[180:183]
    v_mfma_f32_16x16x32_bf16 v[184:187], v[80:83], v[60:63], v[184:187]
    v_mfma_f32_16x16x32_bf16 v[188:191], v[80:83], v[64:67], v[188:191]
    s_waitcnt lgkmcnt(6)
    v_mfma_f32_16x16x32_bf16 v[192:195], v[84:87], v[52:55], v[192:195]
    v_mfma_f32_16x16x32_bf16 v[196:199], v[84:87], v[56:59], v[196:199]
    v_mfma_f32_16x16x32_bf16 v[200:203], v[84:87], v[60:63], v[200:203]
    v_mfma_f32_16x16x32_bf16 v[204:207], v[84:87], v[64:67], v[204:207]
    s_waitcnt lgkmcnt(4)
    v_mfma_f32_16x16x32_bf16 v[208:211], v[88:91], v[52:55], v[208:211]
    v_mfma_f32_16x16x32_bf16 v[212:215], v[88:91], v[56:59], v[212:215]
    v_mfma_f32_16x16x32_bf16 v[216:219], v[88:91], v[60:63], v[216:219]
    v_mfma_f32_16x16x32_bf16 v[220:223], v[88:91], v[64:67], v[220:223]
    s_waitcnt lgkmcnt(2)
    v_mfma_f32_16x16x32_bf16 v[224:227], v[68:71], v[52:55], v[224:227]
    v_mfma_f32_16x16x32_bf16 v[228:231], v[68:71], v[56:59], v[228:231]
    v_mfma_f32_16x16x32_bf16 v[232:235], v[68:71], v[60:63], v[232:235]
    v_mfma_f32_16x16x32_bf16 v[236:239], v[68:71], v[64:67], v[236:239]
    s_waitcnt lgkmcnt(0)
    v_mfma_f32_16x16x32_bf16 v[240:243], v[72:75], v[52:55], v[240:243]
    v_mfma_f32_16x16x32_bf16 v[244:247], v[72:75], v[56:59], v[244:247]
    v_mfma_f32_16x16x32_bf16 v[248:251], v[72:75], v[60:63], v[248:251]
    v_mfma_f32_16x16x32_bf16 v[252:255], v[72:75], v[64:67], v[252:255]
    s_nop 15
    s_barrier
    v_and_b32 v10, 15, v0
    v_lshrrev_b32 v11, 4, v0
    s_lshl_b32 s35, s30, 6
    v_add_u32 v10, s35, v10
    v_mul_u32_u24 v12, 432, v10
    v_lshlrev_b32 v11, 3, v11
    v_add_u32 v12, v12, v11
    s_cmp_eq_u32 s31, 0
    s_cbranch_scc0 G1_epi1
    v_cvt_pk_bf16_f32 v20, v96, v97
    v_cvt_pk_bf16_f32 v21, v98, v99
    ds_write_b64 v12, v[20:21] offset:0
    v_cvt_pk_bf16_f32 v20, v100, v101
    v_cvt_pk_bf16_f32 v21, v102, v103
    ds_write_b64 v12, v[20:21] offset:6912
    v_cvt_pk_bf16_f32 v20, v104, v105
    v_cvt_pk_bf16_f32 v21, v106, v107
    ds_write_b64 v12, v[20:21] offset:13824
    v_cvt_pk_bf16_f32 v20, v108, v109
    v_cvt_pk_bf16_f32 v21, v110, v111
    ds_write_b64 v12, v[20:21] offset:20736
    v_cvt_pk_bf16_f32 v20, v112, v113
    v_cvt_pk_bf16_f32 v21, v114, v115
    ds_write_b64 v12, v[20:21] offset:32
    v_cvt_pk_bf16_f32 v20, v116, v117
    v_cvt_pk_bf16_f32 v21, v118, v119
    ds_write_b64 v12, v[20:21] offset:6944
    v_cvt_pk_bf16_f32 v20, v120, v121
    v_cvt_pk_bf16_f32 v21, v122, v123
    ds_write_b64 v12, v[20:21] offset:13856
    v_cvt_pk_bf16_f32 v20, v124, v125
    v_cvt_pk_bf16_f32 v21, v126, v127
    ds_write_b64 v12, v[20:21] offset:20768
    v_cvt_pk_bf16_f32 v20, v128, v129
    v_cvt_pk_bf16_f32 v21, v130, v131
    ds_write_b64 v12, v[20:21] offset:64
    v_cvt_pk_bf16_f32 v20, v132, v133
    v_cvt_pk_bf16_f32 v21, v134, v135
    ds_write_b64 v12, v[20:21] offset:6976
    v_cvt_pk_bf16_f32 v20, v136, v137
    v_cvt_pk_bf16_f32 v21, v138, v139
    ds_write_b64 v12, v[20:21] offset:13888
    v_cvt_pk_bf16_f32 v20, v140, v141
    v_cvt_pk_bf16_f32 v21, v142, v143
    ds_write_b64 v12, v[20:21] offset:20800
    v_cvt_pk_bf16_f32 v20, v144, v145
    v_cvt_pk_bf16_f32 v21, v146, v147
    ds_write_b64 v12, v[20:21] offset:96
    v_cvt_pk_bf16_f32 v20, v148, v149
    v_cvt_pk_bf16_f32 v21, v150, v151
    ds_write_b64 v12, v[20:21] offset:7008
    v_cvt_pk_bf16_f32 v20, v152, v153
    v_cvt_pk_bf16_f32 v21, v154, v155
    ds_write_b64 v12, v[20:21] offset:13920
    v_cvt_pk_bf16_f32 v20, v156, v157
    v_cvt_pk_bf16_f32 v21, v158, v159
    ds_write_b64 v12, v[20:21] offset:20832
    v_cvt_pk_bf16_f32 v20, v160, v161
    v_cvt_pk_bf16_f32 v21, v162, v163
    ds_write_b64 v12, v[20:21] offset:128
    v_cvt_pk_bf16_f32 v20, v164, v165
    v_cvt_pk_bf16_f32 v21, v166, v167
    ds_write_b64 v12, v[20:21] offset:7040
    v_cvt_pk_bf16_f32 v20, v168, v169
    v_cvt_pk_bf16_f32 v21, v170, v171
    ds_write_b64 v12, v[20:21] offset:13952
    v_cvt_pk_bf16_f32 v20, v172, v173
    v_cvt_pk_bf16_f32 v21, v174, v175
    ds_write_b64 v12, v[20:21] offset:20864
    v_cvt_pk_bf16_f32 v20, v176, v177
    v_cvt_pk_bf16_f32 v21, v178, v179
    ds_write_b64 v12, v[20:21] offset:160
    v_cvt_pk_bf16_f32 v20, v180, v181
    v_cvt_pk_bf16_f32 v21, v182, v183
    ds_write_b64 v12, v[20:21] offset:7072
    v_cvt_pk_bf16_f32 v20, v184, v185
    v_cvt_pk_bf16_f32 v21, v186, v187
    ds_write_b64 v12, v[20:21] offset:13984
    v_cvt_pk_bf16_f32 v20, v188, v189
    v_cvt_pk_bf16_f32 v21, v190, v191
    ds_write_b64 v12, v[20:21] offset:20896
    v_cvt_pk_bf16_f32 v14, v192, v193
    v_cvt_pk_bf16_f32 v15, v224, v225
    v_lshlrev_b32 v16, 16, v14
    v_and_b32 v17, 0xffff0000, v14
    v_lshlrev_b32 v18, 16, v15
    v_and_b32 v19, 0xffff0000, v15
    v_max_f32 v16, 0, v16
    v_max_f32 v17, 0, v17
    v_mul_f32 v16, v16, v18
    v_mul_f32 v17, v17, v19
    v_cvt_pk_bf16_f32 v20, v16, v17
    v_cvt_pk_bf16_f32 v14, v194, v195
    v_cvt_pk_bf16_f32 v15, v226, v227
    v_lshlrev_b32 v16, 16, v14
    v_and_b32 v17, 0xffff0000, v14
    v_lshlrev_b32 v18, 16, v15
    v_and_b32 v19, 0xffff0000, v15
    v_max_f32 v16, 0, v16
    v_max_f32 v17, 0, v17
    v_mul_f32 v16, v16, v18
    v_mul_f32 v17, v17, v19
    v_cvt_pk_bf16_f32 v21, v16, v17
    ds_write_b64 v12, v[20:21] offset:192
    v_cvt_pk_bf16_f32 v14, v196, v197
    v_cvt_pk_bf16_f32 v15, v228, v229
    v_lshlrev_b32 v16, 16, v14
    v_and_b32 v17, 0xffff0000, v14
    v_lshlrev_b32 v18, 16, v15
    v_and_b32 v19, 0xffff0000, v15
    v_max_f32 v16, 0, v16
    v_max_f32 v17, 0, v17
    v_mul_f32 v16, v16, v18
    v_mul_f32 v17, v17, v19
    v_cvt_pk_bf16_f32 v20, v16, v17
    v_cvt_pk_bf16_f32 v14, v198, v199
    v_cvt_pk_bf16_f32 v15, v230, v231
    v_lshlrev_b32 v16, 16, v14
    v_and_b32 v17, 0xffff0000, v14
    v_lshlrev_b32 v18, 16, v15
    v_and_b32 v19, 0xffff0000, v15
    v_max_f32 v16, 0, v16
    v_max_f32 v17, 0, v17
    v_mul_f32 v16, v16, v18
    v_mul_f32 v17, v17, v19
    v_cvt_pk_bf16_f32 v21, v16, v17
    ds_write_b64 v12, v[20:21] offset:7104
    v_cvt_pk_bf16_f32 v14, v200, v201
    v_cvt_pk_bf16_f32 v15, v232, v233
    v_lshlrev_b32 v16, 16, v14
    v_and_b32 v17, 0xffff0000, v14
    v_lshlrev_b32 v18, 16, v15
    v_and_b32 v19, 0xffff0000, v15
    v_max_f32 v16, 0, v16
    v_max_f32 v17, 0, v17
    v_mul_f32 v16, v16, v18
    v_mul_f32 v17, v17, v19
    v_cvt_pk_bf16_f32 v20, v16, v17
    v_cvt_pk_bf16_f32 v14, v202, v203
    v_cvt_pk_bf16_f32 v15, v234, v235
    v_lshlrev_b32 v16, 16, v14
    v_and_b32 v17, 0xffff0000, v14
    v_lshlrev_b32 v18, 16, v15
    v_and_b32 v19, 0xffff0000, v15
    v_max_f32 v16, 0, v16
    v_max_f32 v17, 0, v17
    v_mul_f32 v16, v16, v18
    v_mul_f32 v17, v17, v19
    v_cvt_pk_bf16_f32 v21, v16, v17
    ds_write_b64 v12, v[20:21] offset:14016
    v_cvt_pk_bf16_f32 v14, v204, v205
    v_cvt_pk_bf16_f32 v15, v236, v237
    v_lshlrev_b32 v16, 16, v14
    v_and_b32 v17, 0xffff0000, v14
    v_lshlrev_b32 v18, 16, v15
    v_and_b32 v19, 0xffff0000, v15
    v_max_f32 v16, 0, v16
    v_max_f32 v17, 0, v17
    v_mul_f32 v16, v16, v18
    v_mul_f32 v17, v17, v19
    v_cvt_pk_bf16_f32 v20, v16, v17
    v_cvt_pk_bf16_f32 v14, v206, v207
    v_cvt_pk_bf16_f32 v15, v238, v239
    v_lshlrev_b32 v16, 16, v14
    v_and_b32 v17, 0xffff0000, v14
    v_lshlrev_b32 v18, 16, v15
    v_and_b32 v19, 0xffff0000, v15
    v_max_f32 v16, 0, v16
    v_max_f32 v17, 0, v17
    v_mul_f32 v16, v16, v18
    v_mul_f32 v17, v17, v19
    v_cvt_pk_bf16_f32 v21, v16, v17
    ds_write_b64 v12, v[20:21] offset:20928
    v_cvt_pk_bf16_f32 v14, v208, v209
    v_cvt_pk_bf16_f32 v15, v240, v241
    v_lshlrev_b32 v16, 16, v14
    v_and_b32 v17, 0xffff0000, v14
    v_lshlrev_b32 v18, 16, v15
    v_and_b32 v19, 0xffff0000, v15
    v_max_f32 v16, 0, v16
    v_max_f32 v17, 0, v17
    v_mul_f32 v16, v16, v18
    v_mul_f32 v17, v17, v19
    v_cvt_pk_bf16_f32 v20, v16, v17
    v_cvt_pk_bf16_f32 v14, v210, v211
    v_cvt_pk_bf16_f32 v15, v242, v243
    v_lshlrev_b32 v16, 16, v14
    v_and_b32 v17, 0xffff0000, v14
    v_lshlrev_b32 v18, 16, v15
    v_and_b32 v19, 0xffff0000, v15
    v_max_f32 v16, 0, v16
    v_max_f32 v17, 0, v17
    v_mul_f32 v16, v16, v18
    v_mul_f32 v17, v17, v19
    v_cvt_pk_bf16_f32 v21, v16, v17
    ds_write_b64 v12, v[20:21] offset:224
    v_cvt_pk_bf16_f32 v14, v212, v213
    v_cvt_pk_bf16_f32 v15, v244, v245
    v_lshlrev_b32 v16, 16, v14
    v_and_b32 v17, 0xffff0000, v14
    v_lshlrev_b32 v18, 16, v15
    v_and_b32 v19, 0xffff0000, v15
    v_max_f32 v16, 0, v16
    v_max_f32 v17, 0, v17
    v_mul_f32 v16, v16, v18
    v_mul_f32 v17, v17, v19
    v_cvt_pk_bf16_f32 v20, v16, v17
    v_cvt_pk_bf16_f32 v14, v214, v215
    v_cvt_pk_bf16_f32 v15, v246, v247
    v_lshlrev_b32 v16, 16, v14
    v_and_b32 v17, 0xffff0000, v14
    v_lshlrev_b32 v18, 16, v15
    v_and_b32 v19, 0xffff0000, v15
    v_max_f32 v16, 0, v16
    v_max_f32 v17, 0, v17
    v_mul_f32 v16, v16, v18
    v_mul_f32 v17, v17, v19
    v_cvt_pk_bf16_f32 v21, v16, v17
    ds_write_b64 v12, v[20:21] offset:7136
    v_cvt_pk_bf16_f32 v14, v216, v217
    v_cvt_pk_bf16_f32 v15, v248, v249
    v_lshlrev_b32 v16, 16, v14
    v_and_b32 v17, 0xffff0000, v14
    v_lshlrev_b32 v18, 16, v15
    v_and_b32 v19, 0xffff0000, v15
    v_max_f32 v16, 0, v16
    v_max_f32 v17, 0, v17
    v_mul_f32 v16, v16, v18
    v_mul_f32 v17, v17, v19
    v_cvt_pk_bf16_f32 v20, v16, v17
    v_cvt_pk_bf16_f32 v14, v218, v219
    v_cvt_pk_bf16_f32 v15, v250, v251
    v_lshlrev_b32 v16, 16, v14
    v_and_b32 v17, 0xffff0000, v14
    v_lshlrev_b32 v18, 16, v15
    v_and_b32 v19, 0xffff0000, v15
    v_max_f32 v16, 0, v16
    v_max_f32 v17, 0, v17
    v_mul_f32 v16, v16, v18
    v_mul_f32 v17, v17, v19
    v_cvt_pk_bf16_f32 v21, v16, v17
    ds_write_b64 v12, v[20:21] offset:14048
    v_cvt_pk_bf16_f32 v14, v220, v221
    v_cvt_pk_bf16_f32 v15, v252, v253
    v_lshlrev_b32 v16, 16, v14
    v_and_b32 v17, 0xffff0000, v14
    v_lshlrev_b32 v18, 16, v15
    v_and_b32 v19, 0xffff0000, v15
    v_max_f32 v16, 0, v16
    v_max_f32 v17, 0, v17
    v_mul_f32 v16, v16, v18
    v_mul_f32 v17, v17, v19
    v_cvt_pk_bf16_f32 v20, v16, v17
    v_cvt_pk_bf16_f32 v14, v222, v223
    v_cvt_pk_bf16_f32 v15, v254, v255
    v_lshlrev_b32 v16, 16, v14
    v_and_b32 v17, 0xffff0000, v14
    v_lshlrev_b32 v18, 16, v15
    v_and_b32 v19, 0xffff0000, v15
    v_max_f32 v16, 0, v16
    v_max_f32 v17, 0, v17
    v_mul_f32 v16, v16, v18
    v_mul_f32 v17, v17, v19
    v_cvt_pk_bf16_f32 v21, v16, v17
    ds_write_b64 v12, v[20:21] offset:20960
    s_branch G1_epi2
G1_epi1:
    v_cvt_pk_bf16_f32 v14, v96, v97
    v_cvt_pk_bf16_f32 v15, v176, v177
    v_lshlrev_b32 v16, 16, v14
    v_and_b32 v17, 0xffff0000, v14
    v_lshlrev_b32 v18, 16, v15
    v_and_b32 v19, 0xffff0000, v15
    v_max_f32 v16, 0, v16
    v_max_f32 v17, 0, v17
    v_mul_f32 v16, v16, v18
    v_mul_f32 v17, v17, v19
    v_cvt_pk_bf16_f32 v20, v16, v17
    v_cvt_pk_bf16_f32 v14, v98, v99
    v_cvt_pk_bf16_f32 v15, v178, v179
    v_lshlrev_b32 v16, 16, v14
    v_and_b32 v17, 0xffff0000, v14
    v_lshlrev_b32 v18, 16, v15
    v_and_b32 v19, 0xffff0000, v15
    v_max_f32 v16, 0, v16
    v_max_f32 v17, 0, v17
    v_mul_f32 v16, v16, v18
    v_mul_f32 v17, v17, v19
    v_cvt_pk_bf16_f32 v21, v16, v17
    ds_write_b64 v12, v[20:21] offset:256
    v_cvt_pk_bf16_f32 v14, v100, v101
    v_cvt_pk_bf16_f32 v15, v180, v181
    v_lshlrev_b32 v16, 16, v14
    v_and_b32 v17, 0xffff0000, v14
    v_lshlrev_b32 v18, 16, v15
    v_and_b32 v19, 0xffff0000, v15
    v_max_f32 v16, 0, v16
    v_max_f32 v17, 0, v17
    v_mul_f32 v16, v16, v18
    v_mul_f32 v17, v17, v19
    v_cvt_pk_bf16_f32 v20, v16, v17
    v_cvt_pk_bf16_f32 v14, v102, v103
    v_cvt_pk_bf16_f32 v15, v182, v183
    v_lshlrev_b32 v16, 16, v14
    v_and_b32 v17, 0xffff0000, v14
    v_lshlrev_b32 v18, 16, v15
    v_and_b32 v19, 0xffff0000, v15
    v_max_f32 v16, 0, v16
    v_max_f32 v17, 0, v17
    v_mul_f32 v16, v16, v18
    v_mul_f32 v17, v17, v19
    v_cvt_pk_bf16_f32 v21, v16, v17
    ds_write_b64 v12, v[20:21] offset:7168
    v_cvt_pk_bf16_f32 v14, v104, v105
    v_cvt_pk_bf16_f32 v15, v184, v185
    v_lshlrev_b32 v16, 16, v14
    v_and_b32 v17, 0xffff0000, v14
    v_lshlrev_b32 v18, 16, v15
    v_and_b32 v19, 0xffff0000, v15
    v_max_f32 v16, 0, v16
    v_max_f32 v17, 0, v17
    v_mul_f32 v16, v16, v18
    v_mul_f32 v17, v17, v19
    v_cvt_pk_bf16_f32 v20, v16, v17
    v_cvt_pk_bf16_f32 v14, v106, v107
    v_cvt_pk_bf16_f32 v15, v186, v187
    v_lshlrev_b32 v16, 16, v14
    v_and_b32 v17, 0xffff0000, v14
    v_lshlrev_b32 v18, 16, v15
    v_and_b32 v19, 0xffff0000, v15
    v_max_f32 v16, 0, v16
    v_max_f32 v17, 0, v17
    v_mul_f32 v16, v16, v18
    v_mul_f32 v17, v17, v19
    v_cvt_pk_bf16_f32 v21, v16, v17
    ds_write_b64 v12, v[20:21] offset:14080
    v_cvt_pk_bf16_f32 v14, v108, v109
    v_cvt_pk_bf16_f32 v15, v188, v189
    v_lshlrev_b32 v16, 16, v14
    v_and_b32 v17, 0xffff0000, v14
    v_lshlrev_b32 v18, 16, v15
    v_and_b32 v19, 0xffff0000, v15
    v_max_f32 v16, 0, v16
    v_max_f32 v17, 0, v17
    v_mul_f32 v16, v16, v18
    v_mul_f32 v17, v17, v19
    v_cvt_pk_bf16_f32 v20, v16, v17
    v_cvt_pk_bf16_f32 v14, v110, v111
    v_cvt_pk_bf16_f32 v15, v190, v191
    v_lshlrev_b32 v16, 16, v14
    v_and_b32 v17, 0xffff0000, v14
    v_lshlrev_b32 v18, 16, v15
    v_and_b32 v19, 0xffff0000, v15
    v_max_f32 v16, 0, v16
    v_max_f32 v17, 0, v17
    v_mul_f32 v16, v16, v18
    v_mul_f32 v17, v17, v19
    v_cvt_pk_bf16_f32 v21, v16, v17
    ds_write_b64 v12, v[20:21] offset:20992
    v_cvt_pk_bf16_f32 v14, v112, v113
    v_cvt_pk_bf16_f32 v15, v192, v193
    v_lshlrev_b32 v16, 16, v14
    v_and_b32 v17, 0xffff0000, v14
    v_lshlrev_b32 v18, 16, v15
    v_and_b32 v19, 0xffff0000, v15
    v_max_f32 v16, 0, v16
    v_max_f32 v17, 0, v17
    v_mul_f32 v16, v16, v18
    v_mul_f32 v17, v17, v19
    v_cvt_pk_bf16_f32 v20, v16, v17
    v_cvt_pk_bf16_f32 v14, v114, v115
    v_cvt_pk_bf16_f32 v15, v194, v195
    v_lshlrev_b32 v16, 16, v14
    v_and_b32 v17, 0xffff0000, v14
    v_lshlrev_b32 v18, 16, v15
    v_and_b32 v19, 0xffff0000, v15
    v_max_f32 v16, 0, v16
    v_max_f32 v17, 0, v17
    v_mul_f32 v16, v16, v18
    v_mul_f32 v17, v17, v19
    v_cvt_pk_bf16_f32 v21, v16, v17
    ds_write_b64 v12, v[20:21] offset:288
    v_cvt_pk_bf16_f32 v14, v116, v117
    v_cvt_pk_bf16_f32 v15, v196, v197
    v_lshlrev_b32 v16, 16, v14
    v_and_b32 v17, 0xffff0000, v14
    v_lshlrev_b32 v18, 16, v15
    v_and_b32 v19, 0xffff0000, v15
    v_max_f32 v16, 0, v16
    v_max_f32 v17, 0, v17
    v_mul_f32 v16, v16, v18
    v_mul_f32 v17, v17, v19
    v_cvt_pk_bf16_f32 v20, v16, v17
    v_cvt_pk_bf16_f32 v14, v118, v119
    v_cvt_pk_bf16_f32 v15, v198, v199
    v_lshlrev_b32 v16, 16, v14
    v_and_b32 v17, 0xffff0000, v14
    v_lshlrev_b32 v18, 16, v15
    v_and_b32 v19, 0xffff0000, v15
    v_max_f32 v16, 0, v16
    v_max_f32 v17, 0, v17
    v_mul_f32 v16, v16, v18
    v_mul_f32 v17, v17, v19
    v_cvt_pk_bf16_f32 v21, v16, v17
    ds_write_b64 v12, v[20:21] offset:7200
    v_cvt_pk_bf16_f32 v14, v120, v121
    v_cvt_pk_bf16_f32 v15, v200, v201
    v_lshlrev_b32 v16, 16, v14
    v_and_b32 v17, 0xffff0000, v14
    v_lshlrev_b32 v18, 16, v15
    v_and_b32 v19, 0xffff0000, v15
    v_max_f32 v16, 0, v16
    v_max_f32 v17, 0, v17
    v_mul_f32 v16, v16, v18
    v_mul_f32 v17, v17, v19
    v_cvt_pk_bf16_f32 v20, v16, v17
    v_cvt_pk_bf16_f32 v14, v122, v123
    v_cvt_pk_bf16_f32 v15, v202, v203
    v_lshlrev_b32 v16, 16, v14
    v_and_b32 v17, 0xffff0000, v14
    v_lshlrev_b32 v18, 16, v15
    v_and_b32 v19, 0xffff0000, v15
    v_max_f32 v16, 0, v16
    v_max_f32 v17, 0, v17
    v_mul_f32 v16, v16, v18
    v_mul_f32 v17, v17, v19
    v_cvt_pk_bf16_f32 v21, v16, v17
    ds_write_b64 v12, v[20:21] offset:14112
    v_cvt_pk_bf16_f32 v14, v124, v125
    v_cvt_pk_bf16_f32 v15, v204, v205
    v_lshlrev_b32 v16, 16, v14
    v_and_b32 v17, 0xffff0000, v14
    v_lshlrev_b32 v18, 16, v15
    v_and_b32 v19, 0xffff0000, v15
    v_max_f32 v16, 0, v16
    v_max_f32 v17, 0, v17
    v_mul_f32 v16, v16, v18
    v_mul_f32 v17, v17, v19
    v_cvt_pk_bf16_f32 v20, v16, v17
    v_cvt_pk_bf16_f32 v14, v126, v127
    v_cvt_pk_bf16_f32 v15, v206, v207
    v_lshlrev_b32 v16, 16, v14
    v_and_b32 v17, 0xffff0000, v14
    v_lshlrev_b32 v18, 16, v15
    v_and_b32 v19, 0xffff0000, v15
    v_max_f32 v16, 0, v16
    v_max_f32 v17, 0, v17
    v_mul_f32 v16, v16, v18
    v_mul_f32 v17, v17, v19
    v_cvt_pk_bf16_f32 v21, v16, v17
    ds_write_b64 v12, v[20:21] offset:21024
    v_cvt_pk_bf16_f32 v14, v128, v129
    v_cvt_pk_bf16_f32 v15, v208, v209
    v_lshlrev_b32 v16, 16, v14
    v_and_b32 v17, 0xffff0000, v14
    v_lshlrev_b32 v18, 16, v15
    v_and_b32 v19, 0xffff0000, v15
    v_max_f32 v16, 0, v16
    v_max_f32 v17, 0, v17
    v_mul_f32 v16, v16, v18
    v_mul_f32 v17, v17, v19
    v_cvt_pk_bf16_f32 v20, v16, v17
    v_cvt_pk_bf16_f32 v14, v130, v131
    v_cvt_pk_bf16_f32 v15, v210, v211
    v_lshlrev_b32 v16, 16, v14
    v_and_b32 v17, 0xffff0000, v14
    v_lshlrev_b32 v18, 16, v15
    v_and_b32 v19, 0xffff0000, v15
    v_max_f32 v16, 0, v16
    v_max_f32 v17, 0, v17
    v_mul_f32 v16, v16, v18
    v_mul_f32 v17, v17, v19
    v_cvt_pk_bf16_f32 v21, v16, v17
    ds_write_b64 v12, v[20:21] offset:320
    v_cvt_pk_bf16_f32 v14, v132, v133
    v_cvt_pk_bf16_f32 v15, v212, v213
    v_lshlrev_b32 v16, 16, v14
    v_and_b32 v17, 0xffff0000, v14
    v_lshlrev_b32 v18, 16, v15
    v_and_b32 v19, 0xffff0000, v15
    v_max_f32 v16, 0, v16
    v_max_f32 v17, 0, v17
    v_mul_f32 v16, v16, v18
    v_mul_f32 v17, v17, v19
    v_cvt_pk_bf16_f32 v20, v16, v17
    v_cvt_pk_bf16_f32 v14, v134, v135
    v_cvt_pk_bf16_f32 v15, v214, v215
    v_lshlrev_b32 v16, 16, v14
    v_and_b32 v17, 0xffff0000, v14
    v_lshlrev_b32 v18, 16, v15
    v_and_b32 v19, 0xffff0000, v15
    v_max_f32 v16, 0, v16
    v_max_f32 v17, 0, v17
    v_mul_f32 v16, v16, v18
    v_mul_f32 v17, v17, v19
    v_cvt_pk_bf16_f32 v21, v16, v17
    ds_write_b64 v12, v[20:21] offset:7232
    v_cvt_pk_bf16_f32 v14, v136, v137
    v_cvt_pk_bf16_f32 v15, v216, v217
    v_lshlrev_b32 v16, 16, v14
    v_and_b32 v17, 0xffff0000, v14
    v_lshlrev_b32 v18, 16, v15
    v_and_b32 v19, 0xffff0000, v15
    v_max_f32 v16, 0, v16
    v_max_f32 v17, 0, v17
    v_mul_f32 v16, v16, v18
    v_mul_f32 v17, v17, v19
    v_cvt_pk_bf16_f32 v20, v16, v17
    v_cvt_pk_bf16_f32 v14, v138, v139
    v_cvt_pk_bf16_f32 v15, v218, v219
    v_lshlrev_b32 v16, 16, v14
    v_and_b32 v17, 0xffff0000, v14
    v_lshlrev_b32 v18, 16, v15
    v_and_b32 v19, 0xffff0000, v15
    v_max_f32 v16, 0, v16
    v_max_f32 v17, 0, v17
    v_mul_f32 v16, v16, v18
    v_mul_f32 v17, v17, v19
    v_cvt_pk_bf16_f32 v21, v16, v17
    ds_write_b64 v12, v[20:21] offset:14144
    v_cvt_pk_bf16_f32 v14, v140, v141
    v_cvt_pk_bf16_f32 v15, v220, v221
    v_lshlrev_b32 v16, 16, v14
    v_and_b32 v17, 0xffff0000, v14
    v_lshlrev_b32 v18, 16, v15
    v_and_b32 v19, 0xffff0000, v15
    v_max_f32 v16, 0, v16
    v_max_f32 v17, 0, v17
    v_mul_f32 v16, v16, v18
    v_mul_f32 v17, v17, v19
    v_cvt_pk_bf16_f32 v20, v16, v17
    v_cvt_pk_bf16_f32 v14, v142, v143
    v_cvt_pk_bf16_f32 v15, v222, v223
    v_lshlrev_b32 v16, 16, v14
    v_and_b32 v17, 0xffff0000, v14
    v_lshlrev_b32 v18, 16, v15
    v_and_b32 v19, 0xffff0000, v15
    v_max_f32 v16, 0, v16
    v_max_f32 v17, 0, v17
    v_mul_f32 v16, v16, v18
    v_mul_f32 v17, v17, v19
    v_cvt_pk_bf16_f32 v21, v16, v17
    ds_write_b64 v12, v[20:21] offset:21056
    v_cvt_pk_bf16_f32 v14, v144, v145
    v_cvt_pk_bf16_f32 v15, v224, v225
    v_lshlrev_b32 v16, 16, v14
    v_and_b32 v17, 0xffff0000, v14
    v_lshlrev_b32 v18, 16, v15
    v_and_b32 v19, 0xffff0000, v15
    v_max_f32 v16, 0, v16
    v_max_f32 v17, 0, v17
    v_mul_f32 v16, v16, v18
    v_mul_f32 v17, v17, v19
    v_cvt_pk_bf16_f32 v20, v16, v17
    v_cvt_pk_bf16_f32 v14, v146, v147
    v_cvt_pk_bf16_f32 v15, v226, v227
    v_lshlrev_b32 v16, 16, v14
    v_and_b32 v17, 0xffff0000, v14
    v_lshlrev_b32 v18, 16, v15
    v_and_b32 v19, 0xffff0000, v15
    v_max_f32 v16, 0, v16
    v_max_f32 v17, 0, v17
    v_mul_f32 v16, v16, v18
    v_mul_f32 v17, v17, v19
    v_cvt_pk_bf16_f32 v21, v16, v17
    ds_write_b64 v12, v[20:21] offset:352
    v_cvt_pk_bf16_f32 v14, v148, v149
    v_cvt_pk_bf16_f32 v15, v228, v229
    v_lshlrev_b32 v16, 16, v14
    v_and_b32 v17, 0xffff0000, v14
    v_lshlrev_b32 v18, 16, v15
    v_and_b32 v19, 0xffff0000, v15
    v_max_f32 v16, 0, v16
    v_max_f32 v17, 0, v17
    v_mul_f32 v16, v16, v18
    v_mul_f32 v17, v17, v19
    v_cvt_pk_bf16_f32 v20, v16, v17
    v_cvt_pk_bf16_f32 v14, v150, v151
    v_cvt_pk_bf16_f32 v15, v230, v231
    v_lshlrev_b32 v16, 16, v14
    v_and_b32 v17, 0xffff0000, v14
    v_lshlrev_b32 v18, 16, v15
    v_and_b32 v19, 0xffff0000, v15
    v_max_f32 v16, 0, v16
    v_max_f32 v17, 0, v17
    v_mul_f32 v16, v16, v18
    v_mul_f32 v17, v17, v19
    v_cvt_pk_bf16_f32 v21, v16, v17
    ds_write_b64 v12, v[20:21] offset:7264
    v_cvt_pk_bf16_f32 v14, v152, v153
    v_cvt_pk_bf16_f32 v15, v232, v233
    v_lshlrev_b32 v16, 16, v14
    v_and_b32 v17, 0xffff0000, v14
    v_lshlrev_b32 v18, 16, v15
    v_and_b32 v19, 0xffff0000, v15
    v_max_f32 v16, 0, v16
    v_max_f32 v17, 0, v17
    v_mul_f32 v16, v16, v18
    v_mul_f32 v17, v17, v19
    v_cvt_pk_bf16_f32 v20, v16, v17
    v_cvt_pk_bf16_f32 v14, v154, v155
    v_cvt_pk_bf16_f32 v15, v234, v235
    v_lshlrev_b32 v16, 16, v14
    v_and_b32 v17, 0xffff0000, v14
    v_lshlrev_b32 v18, 16, v15
    v_and_b32 v19, 0xffff0000, v15
    v_max_f32 v16, 0, v16
    v_max_f32 v17, 0, v17
    v_mul_f32 v16, v16, v18
    v_mul_f32 v17, v17, v19
    v_cvt_pk_bf16_f32 v21, v16, v17
    ds_write_b64 v12, v[20:21] offset:14176
    v_cvt_pk_bf16_f32 v14, v156, v157
    v_cvt_pk_bf16_f32 v15, v236, v237
    v_lshlrev_b32 v16, 16, v14
    v_and_b32 v17, 0xffff0000, v14
    v_lshlrev_b32 v18, 16, v15
    v_and_b32 v19, 0xffff0000, v15
    v_max_f32 v16, 0, v16
    v_max_f32 v17, 0, v17
    v_mul_f32 v16, v16, v18
    v_mul_f32 v17, v17, v19
    v_cvt_pk_bf16_f32 v20, v16, v17
    v_cvt_pk_bf16_f32 v14, v158, v159
    v_cvt_pk_bf16_f32 v15, v238, v239
    v_lshlrev_b32 v16, 16, v14
    v_and_b32 v17, 0xffff0000, v14
    v_lshlrev_b32 v18, 16, v15
    v_and_b32 v19, 0xffff0000, v15
    v_max_f32 v16, 0, v16
    v_max_f32 v17, 0, v17
    v_mul_f32 v16, v16, v18
    v_mul_f32 v17, v17, v19
    v_cvt_pk_bf16_f32 v21, v16, v17
    ds_write_b64 v12, v[20:21] offset:21088
    v_cvt_pk_bf16_f32 v14, v160, v161
    v_cvt_pk_bf16_f32 v15, v240, v241
    v_lshlrev_b32 v16, 16, v14
    v_and_b32 v17, 0xffff0000, v14
    v_lshlrev_b32 v18, 16, v15
    v_and_b32 v19, 0xffff0000, v15
    v_max_f32 v16, 0, v16
    v_max_f32 v17, 0, v17
    v_mul_f32 v16, v16, v18
    v_mul_f32 v17, v17, v19
    v_cvt_pk_bf16_f32 v20, v16, v17
    v_cvt_pk_bf16_f32 v14, v162, v163
    v_cvt_pk_bf16_f32 v15, v242, v243
    v_lshlrev_b32 v16, 16, v14
    v_and_b32 v17, 0xffff0000, v14
    v_lshlrev_b32 v18, 16, v15
    v_and_b32 v19, 0xffff0000, v15
    v_max_f32 v16, 0, v16
    v_max_f32 v17, 0, v17
    v_mul_f32 v16, v16, v18
    v_mul_f32 v17, v17, v19
    v_cvt_pk_bf16_f32 v21, v16, v17
    ds_write_b64 v12, v[20:21] offset:384
    v_cvt_pk_bf16_f32 v14, v164, v165
    v_cvt_pk_bf16_f32 v15, v244, v245
    v_lshlrev_b32 v16, 16, v14
    v_and_b32 v17, 0xffff0000, v14
    v_lshlrev_b32 v18, 16, v15
    v_and_b32 v19, 0xffff0000, v15
    v_max_f32 v16, 0, v16
    v_max_f32 v17, 0, v17
    v_mul_f32 v16, v16, v18
    v_mul_f32 v17, v17, v19
    v_cvt_pk_bf16_f32 v20, v16, v17
    v_cvt_pk_bf16_f32 v14, v166, v167
    v_cvt_pk_bf16_f32 v15, v246, v247
    v_lshlrev_b32 v16, 16, v14
    v_and_b32 v17, 0xffff0000, v14
    v_lshlrev_b32 v18, 16, v15
    v_and_b32 v19, 0xffff0000, v15
    v_max_f32 v16, 0, v16
    v_max_f32 v17, 0, v17
    v_mul_f32 v16, v16, v18
    v_mul_f32 v17, v17, v19
    v_cvt_pk_bf16_f32 v21, v16, v17
    ds_write_b64 v12, v[20:21] offset:7296
    v_cvt_pk_bf16_f32 v14, v168, v169
    v_cvt_pk_bf16_f32 v15, v248, v249
    v_lshlrev_b32 v16, 16, v14
    v_and_b32 v17, 0xffff0000, v14
    v_lshlrev_b32 v18, 16, v15
    v_and_b32 v19, 0xffff0000, v15
    v_max_f32 v16, 0, v16
    v_max_f32 v17, 0, v17
    v_mul_f32 v16, v16, v18
    v_mul_f32 v17, v17, v19
    v_cvt_pk_bf16_f32 v20, v16, v17
    v_cvt_pk_bf16_f32 v14, v170, v171
    v_cvt_pk_bf16_f32 v15, v250, v251
    v_lshlrev_b32 v16, 16, v14
    v_and_b32 v17, 0xffff0000, v14
    v_lshlrev_b32 v18, 16, v15
    v_and_b32 v19, 0xffff0000, v15
    v_max_f32 v16, 0, v16
    v_max_f32 v17, 0, v17
    v_mul_f32 v16, v16, v18
    v_mul_f32 v17, v17, v19
    v_cvt_pk_bf16_f32 v21, v16, v17
    ds_write_b64 v12, v[20:21] offset:14208
    v_cvt_pk_bf16_f32 v14, v172, v173
    v_cvt_pk_bf16_f32 v15, v252, v253
    v_lshlrev_b32 v16, 16, v14
    v_and_b32 v17, 0xffff0000, v14
    v_lshlrev_b32 v18, 16, v15
    v_and_b32 v19, 0xffff0000, v15
    v_max_f32 v16, 0, v16
    v_max_f32 v17, 0, v17
    v_mul_f32 v16, v16, v18
    v_mul_f32 v17, v17, v19
    v_cvt_pk_bf16_f32 v20, v16, v17
    v_cvt_pk_bf16_f32 v14, v174, v175
    v_cvt_pk_bf16_f32 v15, v254, v255
    v_lshlrev_b32 v16, 16, v14
    v_and_b32 v17, 0xffff0000, v14
    v_lshlrev_b32 v18, 16, v15
    v_and_b32 v19, 0xffff0000, v15
    v_max_f32 v16, 0, v16
    v_max_f32 v17, 0, v17
    v_mul_f32 v16, v16, v18
    v_mul_f32 v17, v17, v19
    v_cvt_pk_bf16_f32 v21, v16, v17
    ds_write_b64 v12, v[20:21] offset:21120
G1_epi2:
    s_waitcnt lgkmcnt(0)
    s_barrier
    s_mov_b32 s12, s22
    s_mov_b32 s13, s23
    s_mov_b32 s14, 67108864
    s_mov_b32 s15, 0x00020000
    s_lshl_b32 s34, s27, 8
    s_lshl_b32 s35, s24, 5
    s_add_u32 s34, s34, s35
    s_mul_i32 s36, s28, 192
    s_add_u32 s36, s36, 4194304
    s_mul_i32 s37, s28, 224
    s_add_u32 s37, s37, 16779264
    v_add_u32 v21, 0, v0
    v_mul_u32_u24 v22, 0x9d8a, v21
    v_lshrrev_b32 v22, 20, v22
    v_mul_u32_u24 v23, 26, v22
    v_sub_u32 v23, v21, v23
    v_add_u32 v24, s35, v22
    v_mul_u32_u24 v24, 432, v24
    v_lshlrev_b32 v25, 4, v23
    v_add_u32 v24, v24, v25
    ds_read_b128 v[96:99], v24
    v_add_u32 v22, s34, v22
    v_mul_u32_u24 v26, 6144, v22
    v_add_u32 v26, s36, v26
    v_mul_u32_u24 v27, 9216, v22
    v_add_u32 v27, s37, v27
    v_subrev_u32 v27, 192, v27
    v_cmp_gt_u32 vcc, 12, v23
    s_nop 1
    v_cndmask_b32 v26, v27, v26, vcc
    v_add_u32 v40, v26, v25
    v_add_u32 v21, 64, v0
    v_mul_u32_u24 v22, 0x9d8a, v21
    v_lshrrev_b32 v22, 20, v22
    v_mul_u32_u24 v23, 26, v22
    v_sub_u32 v23, v21, v23
    v_add_u32 v24, s35, v22
    v_mul_u32_u24 v24, 432, v24
    v_lshlrev_b32 v25, 4, v23
    v_add_u32 v24, v24, v25
    ds_read_b128 v[100:103], v24
    v_add_u32 v22, s34, v22
    v_mul_u32_u24 v26, 6144, v22
    v_add_u32 v26, s36, v26
    v_mul_u32_u24 v27, 9216, v22
    v_add_u32 v27, s37, v27
    v_subrev_u32 v27, 192, v27
    v_cmp_gt_u32 vcc, 12, v23
    s_nop 1
    v_cndmask_b32 v26, v27, v26, vcc
    v_add_u32 v41, v26, v25
    v_add_u32 v21, 128, v0
    v_mul_u32_u24 v22, 0x9d8a, v21
    v_lshrrev_b32 v22, 20, v22
    v_mul_u32_u24 v23, 26, v22
    v_sub_u32 v23, v21, v23
    v_add_u32 v24, s35, v22
    v_mul_u32_u24 v24, 432, v24
    v_lshlrev_b32 v25, 4, v23
    v_add_u32 v24, v24, v25
    ds_read_b128 v[104:107], v24
    v_add_u32 v22, s34, v22
    v_mul_u32_u24 v26, 6144, v22
    v_add_u32 v26, s36, v26
    v_mul_u32_u24 v27, 9216, v22
    v_add_u32 v27, s37, v27
    v_subrev_u32 v27, 192, v27
    v_cmp_gt_u32 vcc, 12, v23
    s_nop 1
    v_cndmask_b32 v26, v27, v26, vcc
    v_add_u32 v42, v26, v25
    v_add_u32 v21, 192, v0
    v_mul_u32_u24 v22, 0x9d8a, v21
    v_lshrrev_b32 v22, 20, v22
    v_mul_u32_u24 v23, 26, v22
    v_sub_u32 v23, v21, v23
    v_add_u32 v24, s35, v22
    v_mul_u32_u24 v24, 432, v24
    v_lshlrev_b32 v25, 4, v23
    v_add_u32 v24, v24, v25
    ds_read_b128 v[108:111], v24
    v_add_u32 v22, s34, v22
    v_mul_u32_u24 v26, 6144, v22
    v_add_u32 v26, s36, v26
    v_mul_u32_u24 v27, 9216, v22
    v_add_u32 v27, s37, v27
    v_subrev_u32 v27, 192, v27
    v_cmp_gt_u32 vcc, 12, v23
    s_nop 1
    v_cndmask_b32 v26, v27, v26, vcc
    v_add_u32 v43, v26, v25
    s_waitcnt lgkmcnt(0)
    buffer_store_dwordx4 v[96:99], v40, s[12:15], 0 offen
    buffer_store_dwordx4 v[100:103], v41, s[12:15], 0 offen
    buffer_store_dwordx4 v[104:107], v42, s[12:15], 0 offen
    buffer_store_dwordx4 v[108:111], v43, s[12:15], 0 offen
    s_nop 1
    v_add_u32 v21, 256, v0
    v_mul_u32_u24 v22, 0x9d8a, v21
    v_lshrrev_b32 v22, 20, v22
    v_mul_u32_u24 v23, 26, v22
    v_sub_u32 v23, v21, v23
    v_add_u32 v24, s35, v22
    v_mul_u32_u24 v24, 432, v24
    v_lshlrev_b32 v25, 4, v23
    v_add_u32 v24, v24, v25
    ds_read_b128 v[96:99], v24
    v_add_u32 v22, s34, v22
    v_mul_u32_u24 v26, 6144, v22
    v_add_u32 v26, s36, v26
    v_mul_u32_u24 v27, 9216, v22
    v_add_u32 v27, s37, v27
    v_subrev_u32 v27, 192, v27
    v_cmp_gt_u32 vcc, 12, v23
    s_nop 1
    v_cndmask_b32 v26, v27, v26, vcc
    v_add_u32 v44, v26, v25
    v_add_u32 v21, 320, v0
    v_mul_u32_u24 v22, 0x9d8a, v21
    v_lshrrev_b32 v22, 20, v22
    v_mul_u32_u24 v23, 26, v22
    v_sub_u32 v23, v21, v23
    v_add_u32 v24, s35, v22
    v_mul_u32_u24 v24, 432, v24
    v_lshlrev_b32 v25, 4, v23
    v_add_u32 v24, v24, v25
    ds_read_b128 v[100:103], v24
    v_add_u32 v22, s34, v22
    v_mul_u32_u24 v26, 6144, v22
    v_add_u32 v26, s36, v26
    v_mul_u32_u24 v27, 9216, v22
    v_add_u32 v27, s37, v27
    v_subrev_u32 v27, 192, v27
    v_cmp_gt_u32 vcc, 12, v23
    s_nop 1
    v_cndmask_b32 v26, v27, v26, vcc
    v_add_u32 v45, v26, v25
    v_add_u32 v21, 384, v0
    v_mul_u32_u24 v22, 0x9d8a, v21
    v_lshrrev_b32 v22, 20, v22
    v_mul_u32_u24 v23, 26, v22
    v_sub_u32 v23, v21, v23
    v_add_u32 v24, s35, v22
    v_mul_u32_u24 v24, 432, v24
    v_lshlrev_b32 v25, 4, v23
    v_add_u32 v24, v24, v25
    ds_read_b128 v[104:107], v24
    v_add_u32 v22, s34, v22
    v_mul_u32_u24 v26, 6144, v22
    v_add_u32 v26, s36, v26
    v_mul_u32_u24 v27, 9216, v22
    v_add_u32 v27, s37, v27
    v_subrev_u32 v27, 192, v27
    v_cmp_gt_u32 vcc, 12, v23
    s_nop 1
    v_cndmask_b32 v26, v27, v26, vcc
    v_add_u32 v46, v26, v25
    v_add_u32 v21, 448, v0
    v_mul_u32_u24 v22, 0x9d8a, v21
    v_lshrrev_b32 v22, 20, v22
    v_mul_u32_u24 v23, 26, v22
    v_sub_u32 v23, v21, v23
    v_add_u32 v24, s35, v22
    v_mul_u32_u24 v24, 432, v24
    v_lshlrev_b32 v25, 4, v23
    v_add_u32 v24, v24, v25
    ds_read_b128 v[108:111], v24
    v_add_u32 v22, s34, v22
    v_mul_u32_u24 v26, 6144, v22
    v_add_u32 v26, s36, v26
    v_mul_u32_u24 v27, 9216, v22
    v_add_u32 v27, s37, v27
    v_subrev_u32 v27, 192, v27
    v_cmp_gt_u32 vcc, 12, v23
    s_nop 1
    v_cndmask_b32 v26, v27, v26, vcc
    v_add_u32 v47, v26, v25
    s_waitcnt lgkmcnt(0)
    buffer_store_dwordx4 v[96:99], v44, s[12:15], 0 offen
    buffer_store_dwordx4 v[100:103], v45, s[12:15], 0 offen
    buffer_store_dwordx4 v[104:107], v46, s[12:15], 0 offen
    buffer_store_dwordx4 v[108:111], v47, s[12:15], 0 offen
    s_nop 1
    v_add_u32 v21, 512, v0
    v_mul_u32_u24 v22, 0x9d8a, v21
    v_lshrrev_b32 v22, 20, v22
    v_mul_u32_u24 v23, 26, v22
    v_sub_u32 v23, v21, v23
    v_add_u32 v24, s35, v22
    v_mul_u32_u24 v24, 432, v24
    v_lshlrev_b32 v25, 4, v23
    v_add_u32 v24, v24, v25
    ds_read_b128 v[96:99], v24
    v_add_u32 v22, s34, v22
    v_mul_u32_u24 v26, 6144, v22
    v_add_u32 v26, s36, v26
    v_mul_u32_u24 v27, 9216, v22
    v_add_u32 v27, s37, v27
    v_subrev_u32 v27, 192, v27
    v_cmp_gt_u32 vcc, 12, v23
    s_nop 1
    v_cndmask_b32 v26, v27, v26, vcc
    v_add_u32 v48, v26, v25
    v_add_u32 v21, 576, v0
    v_mul_u32_u24 v22, 0x9d8a, v21
    v_lshrrev_b32 v22, 20, v22
    v_mul_u32_u24 v23, 26, v22
    v_sub_u32 v23, v21, v23
    v_add_u32 v24, s35, v22
    v_mul_u32_u24 v24, 432, v24
    v_lshlrev_b32 v25, 4, v23
    v_add_u32 v24, v24, v25
    ds_read_b128 v[100:103], v24
    v_add_u32 v22, s34, v22
    v_mul_u32_u24 v26, 6144, v22
    v_add_u32 v26, s36, v26
    v_mul_u32_u24 v27, 9216, v22
    v_add_u32 v27, s37, v27
    v_subrev_u32 v27, 192, v27
    v_cmp_gt_u32 vcc, 12, v23
    s_nop 1
    v_cndmask_b32 v26, v27, v26, vcc
    v_add_u32 v49, v26, v25
    v_add_u32 v21, 640, v0
    v_mul_u32_u24 v22, 0x9d8a, v21
    v_lshrrev_b32 v22, 20, v22
    v_mul_u32_u24 v23, 26, v22
    v_sub_u32 v23, v21, v23
    v_add_u32 v24, s35, v22
    v_mul_u32_u24 v24, 432, v24
    v_lshlrev_b32 v25, 4, v23
    v_add_u32 v24, v24, v25
    ds_read_b128 v[104:107], v24
    v_add_u32 v22, s34, v22
    v_mul_u32_u24 v26, 6144, v22
    v_add_u32 v26, s36, v26
    v_mul_u32_u24 v27, 9216, v22
    v_add_u32 v27, s37, v27
    v_subrev_u32 v27, 192, v27
    v_cmp_gt_u32 vcc, 12, v23
    s_nop 1
    v_cndmask_b32 v26, v27, v26, vcc
    v_add_u32 v50, v26, v25
    v_add_u32 v21, 704, v0
    v_mul_u32_u24 v22, 0x9d8a, v21
    v_lshrrev_b32 v22, 20, v22
    v_mul_u32_u24 v23, 26, v22
    v_sub_u32 v23, v21, v23
    v_add_u32 v24, s35, v22
    v_mul_u32_u24 v24, 432, v24
    v_lshlrev_b32 v25, 4, v23
    v_add_u32 v24, v24, v25
    ds_read_b128 v[108:111], v24
    v_add_u32 v22, s34, v22
    v_mul_u32_u24 v26, 6144, v22
    v_add_u32 v26, s36, v26
    v_mul_u32_u24 v27, 9216, v22
    v_add_u32 v27, s37, v27
    v_subrev_u32 v27, 192, v27
    v_cmp_gt_u32 vcc, 12, v23
    s_nop 1
    v_cndmask_b32 v26, v27, v26, vcc
    v_add_u32 v51, v26, v25
    s_waitcnt lgkmcnt(0)
    buffer_store_dwordx4 v[96:99], v48, s[12:15], 0 offen
    buffer_store_dwordx4 v[100:103], v49, s[12:15], 0 offen
    buffer_store_dwordx4 v[104:107], v50, s[12:15], 0 offen
    buffer_store_dwordx4 v[108:111], v51, s[12:15], 0 offen
    s_nop 1
    v_add_u32 v21, 768, v0
    v_mul_u32_u24 v22, 0x9d8a, v21
    v_lshrrev_b32 v22, 20, v22
    v_mul_u32_u24 v23, 26, v22
    v_sub_u32 v23, v21, v23
    v_add_u32 v24, s35, v22
    v_mul_u32_u24 v24, 432, v24
    v_lshlrev_b32 v25, 4, v23
    v_add_u32 v24, v24, v25
    ds_read_b128 v[96:99], v24
    v_add_u32 v22, s34, v22
    v_mul_u32_u24 v26, 6144, v22
    v_add_u32 v26, s36, v26
    v_mul_u32_u24 v27, 9216, v22
    v_add_u32 v27, s37, v27
    v_subrev_u32 v27, 192, v27
    v_cmp_gt_u32 vcc, 12, v23
    s_nop 1
    v_cndmask_b32 v26, v27, v26, vcc
    v_add_u32 v52, v26, v25
    s_waitcnt lgkmcnt(0)
    buffer_store_dwordx4 v[96:99], v52, s[12:15], 0 offen
    s_nop 1
G1_done:
    s_endpgm
.globl attn_kernel
.p2align 8
.type attn_kernel,@function
attn_kernel:
    s_cmp_ge_u32 s2, 1024
    s_cbranch_scc1 AT_pf
    s_load_dwordx2 s[16:17], s[0:1], 72
    v_lshrrev_b32 v1, 6, v0
    v_and_b32 v0, 63, v0
    s_nop 0
    v_readfirstlane_b32 s24, v1
    s_and_b32 s25, s2, 31
    s_lshr_b32 s26, s2, 5
    s_lshl_b32 s27, s26, 6
    s_waitcnt lgkmcnt(0)
    s_add_u32 s4, s16, 4194304
    s_addc_u32 s5, s17, 0
    s_mov_b32 s6, 12582912
    s_mov_b32 s7, 0x00020000
    s_add_u32 s8, s16, 16777216
    s_addc_u32 s9, s17, 0
    s_mov_b32 s10, 18874368
    s_mov_b32 s11, 0x00020000
    v_lshrrev_b32 v10, 2, v0
    v_and_b32 v11, 3, v0
    s_lshl_b32 s28, s24, 4
    s_add_u32 s28, s28, s27
    s_sub_u32 s28, s28, 256
    v_add_u32 v10, s28, v10
    s_mov_b32 s29, 6144
    v_mul_lo_u32 v10, v10, s29
    v_lshlrev_b32 v11, 4, v11
    v_add_u32 v10, v10, v11
    s_lshl_b32 s30, s25, 6
    v_add_u32 v10, s30, v10
    v_add_u32 v12, 2048, v10
    v_add_u32 v13, 4096, v10
    s_lshl_b32 s31, s24, 10
    s_mov_b32 s33, 0
    s_add_u32 m0, s31, 0
    s_nop 0
    buffer_load_dwordx4 v12, s[4:7], s33 offen lds
    s_add_u32 m0, s31, 20480
    s_nop 0
    buffer_load_dwordx4 v13, s[4:7], s33 offen lds
    v_add_u32 v12, 393216, v12
    v_add_u32 v13, 393216, v13
    s_add_u32 m0, s31, 4096
    s_nop 0
    buffer_load_dwordx4 v12, s[4:7], s33 offen lds
    s_add_u32 m0, s31, 24576
    s_nop 0
    buffer_load_dwordx4 v13, s[4:7], s33 offen lds
    v_add_u32 v12, 393216, v12
    v_add_u32 v13, 393216, v13
    s_add_u32 m0, s31, 8192
    s_nop 0
    buffer_load_dwordx4 v12, s[4:7], s33 offen lds
    s_add_u32 m0, s31, 28672
    s_nop 0
    buffer_load_dwordx4 v13, s[4:7], s33 offen lds
    v_add_u32 v12, 393216, v12
    v_add_u32 v13, 393216, v13
    s_add_u32 m0, s31, 12288
    s_nop 0
    buffer_load_dwordx4 v12, s[4:7], s33 offen lds
    s_add_u32 m0, s31, 32768
    s_nop 0
    buffer_load_dwordx4 v13, s[4:7], s33 offen lds
    v_add_u32 v12, 393216, v12
    v_add_u32 v13, 393216, v13
    s_add_u32 m0, s31, 16384
    s_nop 0
    buffer_load_dwordx4 v12, s[4:7], s33 offen lds
    s_add_u32 m0, s31, 36864
    s_nop 0
    buffer_load_dwordx4 v13, s[4:7], s33 offen lds
    v_and_b32 v14, 15, v0
    s_lshl_b32 s28, s24, 4
    s_add_u32 s28, s28, s27
    v_add_u32 v15, s28, v14
    v_mul_lo_u32 v16, v15, s29
    v_lshrrev_b32 v17, 4, v0
    v_lshlrev_b32 v18, 4, v17
    v_add_u32 v16, v16, v18
    v_add_u32 v16, s30, v16
    buffer_load_dwordx4 v[4:7], v16, s[4:7], 0 offen
    v_lshlrev_b32 v20, 6, v14
    v_add_u32 v20, v20, v18
    v_add_u32 v20, s31, v20
    v_lshlrev_b32 v21, 2, v17
    v_lshrrev_b32 v22, 2, v14
    v_add_u32 v21, v21, v22
    v_lshlrev_b32 v21, 6, v21
    v_and_b32 v22, 3, v14
    v_lshlrev_b32 v22, 3, v22
    v_add_u32 v21, v21, v22
    v_add_u32 v21, s31, v21
    v_add_u32 v21, 20480, v21
    s_waitcnt vmcnt(0)
    s_barrier
    ds_read_b128 v[24:27], v20 offset:0
    ds_read_b128 v[28:31], v20 offset:1024
    ds_read_b128 v[32:35], v20 offset:2048
    ds_read_b128 v[36:39], v20 offset:3072
    s_waitcnt lgkmcnt(3)
    v_mfma_f32_16x16x32_bf16 v[56:59], v[24:27], v[4:7], 0
    ds_read_b128 v[24:27], v20 offset:4096
    s_waitcnt lgkmcnt(3)
    v_mfma_f32_16x16x32_bf16 v[60:63], v[28:31], v[4:7], 0
    ds_read_b128 v[28:31], v20 offset:5120
    s_waitcnt lgkmcnt(3)
    v_mfma_f32_16x16x32_bf16 v[64:67], v[32:35], v[4:7], 0
    ds_read_b128 v[32:35], v20 offset:6144
    s_waitcnt lgkmcnt(3)
    v_mfma_f32_16x16x32_bf16 v[68:71], v[36:39], v[4:7], 0
    ds_read_b128 v[36:39], v20 offset:7168
    s_waitcnt lgkmcnt(3)
    v_mfma_f32_16x16x32_bf16 v[72:75], v[24:27], v[4:7], 0
    ds_read_b128 v[24:27], v20 offset:8192
    s_waitcnt lgkmcnt(3)
    v_mfma_f32_16x16x32_bf16 v[76:79], v[28:31], v[4:7], 0
    ds_read_b128 v[28:31], v20 offset:9216
    s_waitcnt lgkmcnt(3)
    v_mfma_f32_16x16x32_bf16 v[80:83], v[32:35], v[4:7], 0
    ds_read_b128 v[32:35], v20 offset:10240
    s_waitcnt lgkmcnt(3)
    v_mfma_f32_16x16x32_bf16 v[84:87], v[36:39], v[4:7], 0
    ds_read_b128 v[36:39], v20 offset:11264
    s_waitcnt lgkmcnt(3)
    v_mfma_f32_16x16x32_bf16 v[88:91], v[24:27], v[4:7], 0
    ds_read_b128 v[24:27], v20 offset:12288
    s_waitcnt lgkmcnt(3)
    v_mfma_f32_16x16x32_bf16 v[92:95], v[28:31], v[4:7], 0
    ds_read_b128 v[28:31], v20 offset:13312
    s_waitcnt lgkmcnt(3)
    v_mfma_f32_16x16x32_bf16 v[96:99], v[32:35], v[4:7], 0
    ds_read_b128 v[32:35], v20 offset:14336
    s_waitcnt lgkmcnt(3)
    v_mfma_f32_16x16x32_bf16 v[100:103], v[36:39], v[4:7], 0
    ds_read_b128 v[36:39], v20 offset:15360
    s_waitcnt lgkmcnt(3)
    v_mfma_f32_16x16x32_bf16 v[104:107], v[24:27], v[4:7], 0
    ds_read_b128 v[24:27], v20 offset:16384
    s_waitcnt lgkmcnt(3)
    v_mfma_f32_16x16x32_bf16 v[108:111], v[28:31], v[4:7], 0
    s_waitcnt lgkmcnt(2)
    v_mfma_f32_16x16x32_bf16 v[112:115], v[32:35], v[4:7], 0
    s_waitcnt lgkmcnt(1)
    v_mfma_f32_16x16x32_bf16 v[116:119], v[36:39], v[4:7], 0
    s_waitcnt lgkmcnt(0)
    v_mfma_f32_16x16x32_bf16 v[120:123], v[24:27], v[4:7], 0
    v_add_u32 v22, 1, v14
    s_sub_u32 s34, 256, s28
    v_max_i32 v22, s34, v22
    v_add_u32 v23, 256, v14
    v_sub_u32 v23, v23, v22
    v_lshlrev_b32 v40, 2, v17
    v_sub_u32 v22, v40, v22
    s_nop 7
    v_mov_b32 v41, 0xf149f2ca
    v_mov_b32 v42, 0xf149f2ca
    s_mov_b32 s35, 0x3e3504f3
    s_cmp_lt_u32 s28, 256
    s_cbranch_scc1 AT_slow
    v_cvt_pk_bf16_f32 v43, v56, v57
    v_lshlrev_b32 v56, 16, v43
    v_and_b32 v57, 0xffff0000, v43
    v_mul_f32 v56, s35, v56
    v_mul_f32 v57, s35, v57
    v_cvt_pk_bf16_f32 v43, v56, v57
    v_lshlrev_b32 v56, 16, v43
    v_and_b32 v57, 0xffff0000, v43
    v_add_u32 v44, 0, v22
    v_cmp_le_u32 vcc, v44, v23
    s_nop 1
    v_cndmask_b32 v56, v41, v56, vcc
    v_add_u32 v44, 1, v22
    v_cmp_le_u32 vcc, v44, v23
    s_nop 1
    v_cndmask_b32 v57, v41, v57, vcc
    v_max3_f32 v42, v42, v56, v57
    v_cvt_pk_bf16_f32 v43, v58, v59
    v_lshlrev_b32 v58, 16, v43
    v_and_b32 v59, 0xffff0000, v43
    v_mul_f32 v58, s35, v58
    v_mul_f32 v59, s35, v59
    v_cvt_pk_bf16_f32 v43, v58, v59
    v_lshlrev_b32 v58, 16, v43
    v_and_b32 v59, 0xffff0000, v43
    v_add_u32 v44, 2, v22
    v_cmp_le_u32 vcc, v44, v23
    s_nop 1
    v_cndmask_b32 v58, v41, v58, vcc
    v_add_u32 v44, 3, v22
    v_cmp_le_u32 vcc, v44, v23
    s_nop 1
    v_cndmask_b32 v59, v41, v59, vcc
    v_max3_f32 v42, v42, v58, v59
    v_cvt_pk_bf16_f32 v43, v60, v61
    v_lshlrev_b32 v60, 16, v43
    v_and_b32 v61, 0xffff0000, v43
    v_mul_f32 v60, s35, v60
    v_mul_f32 v61, s35, v61
    v_cvt_pk_bf16_f32 v43, v60, v61
    v_lshlrev_b32 v60, 16, v43
    v_and_b32 v61, 0xffff0000, v43
    v_max3_f32 v42, v42, v60, v61
    v_cvt_pk_bf16_f32 v43, v62, v63
    v_lshlrev_b32 v62, 16, v43
    v_and_b32 v63, 0xffff0000, v43
    v_mul_f32 v62, s35, v62
    v_mul_f32 v63, s35, v63
    v_cvt_pk_bf16_f32 v43, v62, v63
    v_lshlrev_b32 v62, 16, v43
    v_and_b32 v63, 0xffff0000, v43
    v_max3_f32 v42, v42, v62, v63
    v_cvt_pk_bf16_f32 v43, v64, v65
    v_lshlrev_b32 v64, 16, v43
    v_and_b32 v65, 0xffff0000, v43
    v_mul_f32 v64, s35, v64
    v_mul_f32 v65, s35, v65
    v_cvt_pk_bf16_f32 v43, v64, v65
    v_lshlrev_b32 v64, 16, v43
    v_and_b32 v65, 0xffff0000, v43
    v_max3_f32 v42, v42, v64, v65
    v_cvt_pk_bf16_f32 v43, v66, v67
    v_lshlrev_b32 v66, 16, v43
    v_and_b32 v67, 0xffff0000, v43
    v_mul_f32 v66, s35, v66
    v_mul_f32 v67, s35, v67
    v_cvt_pk_bf16_f32 v43, v66, v67
    v_lshlrev_b32 v66, 16, v43
    v_and_b32 v67, 0xffff0000, v43
    v_max3_f32 v42, v42, v66, v67
    v_cvt_pk_bf16_f32 v43, v68, v69
    v_lshlrev_b32 v68, 16, v43
    v_and_b32 v69, 0xffff0000, v43
    v_mul_f32 v68, s35, v68
    v_mul_f32 v69, s35, v69
    v_cvt_pk_bf16_f32 v43, v68, v69
    v_lshlrev_b32 v68, 16, v43
    v_and_b32 v69, 0xffff0000, v43
    v_max3_f32 v42, v42, v68, v69
    v_cvt_pk_bf16_f32 v43, v70, v71
    v_lshlrev_b32 v70, 16, v43
    v_and_b32 v71, 0xffff0000, v43
    v_mul_f32 v70, s35, v70
    v_mul_f32 v71, s35, v71
    v_cvt_pk_bf16_f32 v43, v70, v71
    v_lshlrev_b32 v70, 16, v43
    v_and_b32 v71, 0xffff0000, v43
    v_max3_f32 v42, v42, v70, v71
    v_cvt_pk_bf16_f32 v43, v72, v73
    v_lshlrev_b32 v72, 16, v43
    v_and_b32 v73, 0xffff0000, v43
    v_mul_f32 v72, s35, v72
    v_mul_f32 v73, s35, v73
    v_cvt_pk_bf16_f32 v43, v72, v73
    v_lshlrev_b32 v72, 16, v43
    v_and_b32 v73, 0xffff0000, v43
    v_max3_f32 v42, v42, v72, v73
    v_cvt_pk_bf16_f32 v43, v74, v75
    v_lshlrev_b32 v74, 16, v43
    v_and_b32 v75, 0xffff0000, v43
    v_mul_f32 v74, s35, v74
    v_mul_f32 v75, s35, v75
    v_cvt_pk_bf16_f32 v43, v74, v75
    v_lshlrev_b32 v74, 16, v43
    v_and_b32 v75, 0xffff0000, v43
    v_max3_f32 v42, v42, v74, v75
    v_cvt_pk_bf16_f32 v43, v76, v77
    v_lshlrev_b32 v76, 16, v43
    v_and_b32 v77, 0xffff0000, v43
    v_mul_f32 v76, s35, v76
    v_mul_f32 v77, s35, v77
    v_cvt_pk_bf16_f32 v43, v76, v77
    v_lshlrev_b32 v76, 16, v43
    v_and_b32 v77, 0xffff0000, v43
    v_max3_f32 v42, v42, v76, v77
    v_cvt_pk_bf16_f32 v43, v78, v79
    v_lshlrev_b32 v78, 16, v43
    v_and_b32 v79, 0xffff0000, v43
    v_mul_f32 v78, s35, v78
    v_mul_f32 v79, s35, v79
    v_cvt_pk_bf16_f32 v43, v78, v79
    v_lshlrev_b32 v78, 16, v43
    v_and_b32 v79, 0xffff0000, v43
    v_max3_f32 v42, v42, v78, v79
    v_cvt_pk_bf16_f32 v43, v80, v81
    v_lshlrev_b32 v80, 16, v43
    v_and_b32 v81, 0xffff0000, v43
    v_mul_f32 v80, s35, v80
    v_mul_f32 v81, s35, v81
    v_cvt_pk_bf16_f32 v43, v80, v81
    v_lshlrev_b32 v80, 16, v43
    v_and_b32 v81, 0xffff0000, v43
    v_max3_f32 v42, v42, v80, v81
    v_cvt_pk_bf16_f32 v43, v82, v83
    v_lshlrev_b32 v82, 16, v43
    v_and_b32 v83, 0xffff0000, v43
    v_mul_f32 v82, s35, v82
    v_mul_f32 v83, s35, v83
    v_cvt_pk_bf16_f32 v43, v82, v83
    v_lshlrev_b32 v82, 16, v43
    v_and_b32 v83, 0xffff0000, v43
    v_max3_f32 v42, v42, v82, v83
    v_cvt_pk_bf16_f32 v43, v84, v85
    v_lshlrev_b32 v84, 16, v43
    v_and_b32 v85, 0xffff0000, v43
    v_mul_f32 v84, s35, v84
    v_mul_f32 v85, s35, v85
    v_cvt_pk_bf16_f32 v43, v84, v85
    v_lshlrev_b32 v84, 16, v43
    v_and_b32 v85, 0xffff0000, v43
    v_max3_f32 v42, v42, v84, v85
    v_cvt_pk_bf16_f32 v43, v86, v87
    v_lshlrev_b32 v86, 16, v43
    v_and_b32 v87, 0xffff0000, v43
    v_mul_f32 v86, s35, v86
    v_mul_f32 v87, s35, v87
    v_cvt_pk_bf16_f32 v43, v86, v87
    v_lshlrev_b32 v86, 16, v43
    v_and_b32 v87, 0xffff0000, v43
    v_max3_f32 v42, v42, v86, v87
    v_cvt_pk_bf16_f32 v43, v88, v89
    v_lshlrev_b32 v88, 16, v43
    v_and_b32 v89, 0xffff0000, v43
    v_mul_f32 v88, s35, v88
    v_mul_f32 v89, s35, v89
    v_cvt_pk_bf16_f32 v43, v88, v89
    v_lshlrev_b32 v88, 16, v43
    v_and_b32 v89, 0xffff0000, v43
    v_max3_f32 v42, v42, v88, v89
    v_cvt_pk_bf16_f32 v43, v90, v91
    v_lshlrev_b32 v90, 16, v43
    v_and_b32 v91, 0xffff0000, v43
    v_mul_f32 v90, s35, v90
    v_mul_f32 v91, s35, v91
    v_cvt_pk_bf16_f32 v43, v90, v91
    v_lshlrev_b32 v90, 16, v43
    v_and_b32 v91, 0xffff0000, v43
    v_max3_f32 v42, v42, v90, v91
    v_cvt_pk_bf16_f32 v43, v92, v93
    v_lshlrev_b32 v92, 16, v43
    v_and_b32 v93, 0xffff0000, v43
    v_mul_f32 v92, s35, v92
    v_mul_f32 v93, s35, v93
    v_cvt_pk_bf16_f32 v43, v92, v93
    v_lshlrev_b32 v92, 16, v43
    v_and_b32 v93, 0xffff0000, v43
    v_max3_f32 v42, v42, v92, v93
    v_cvt_pk_bf16_f32 v43, v94, v95
    v_lshlrev_b32 v94, 16, v43
    v_and_b32 v95, 0xffff0000, v43
    v_mul_f32 v94, s35, v94
    v_mul_f32 v95, s35, v95
    v_cvt_pk_bf16_f32 v43, v94, v95
    v_lshlrev_b32 v94, 16, v43
    v_and_b32 v95, 0xffff0000, v43
    v_max3_f32 v42, v42, v94, v95
    v_cvt_pk_bf16_f32 v43, v96, v97
    v_lshlrev_b32 v96, 16, v43
    v_and_b32 v97, 0xffff0000, v43
    v_mul_f32 v96, s35, v96
    v_mul_f32 v97, s35, v97
    v_cvt_pk_bf16_f32 v43, v96, v97
    v_lshlrev_b32 v96, 16, v43
    v_and_b32 v97, 0xffff0000, v43
    v_max3_f32 v42, v42, v96, v97
    v_cvt_pk_bf16_f32 v43, v98, v99
    v_lshlrev_b32 v98, 16, v43
    v_and_b32 v99, 0xffff0000, v43
    v_mul_f32 v98, s35, v98
    v_mul_f32 v99, s35, v99
    v_cvt_pk_bf16_f32 v43, v98, v99
    v_lshlrev_b32 v98, 16, v43
    v_and_b32 v99, 0xffff0000, v43
    v_max3_f32 v42, v42, v98, v99
    v_cvt_pk_bf16_f32 v43, v100, v101
    v_lshlrev_b32 v100, 16, v43
    v_and_b32 v101, 0xffff0000, v43
    v_mul_f32 v100, s35, v100
    v_mul_f32 v101, s35, v101
    v_cvt_pk_bf16_f32 v43, v100, v101
    v_lshlrev_b32 v100, 16, v43
    v_and_b32 v101, 0xffff0000, v43
    v_max3_f32 v42, v42, v100, v101
    v_cvt_pk_bf16_f32 v43, v102, v103
    v_lshlrev_b32 v102, 16, v43
    v_and_b32 v103, 0xffff0000, v43
    v_mul_f32 v102, s35, v102
    v_mul_f32 v103, s35, v103
    v_cvt_pk_bf16_f32 v43, v102, v103
    v_lshlrev_b32 v102, 16, v43
    v_and_b32 v103, 0xffff0000, v43
    v_max3_f32 v42, v42, v102, v103
    v_cvt_pk_bf16_f32 v43, v104, v105
    v_lshlrev_b32 v104, 16, v43
    v_and_b32 v105, 0xffff0000, v43
    v_mul_f32 v104, s35, v104
    v_mul_f32 v105, s35, v105
    v_cvt_pk_bf16_f32 v43, v104, v105
    v_lshlrev_b32 v104, 16, v43
    v_and_b32 v105, 0xffff0000, v43
    v_max3_f32 v42, v42, v104, v105
    v_cvt_pk_bf16_f32 v43, v106, v107
    v_lshlrev_b32 v106, 16, v43
    v_and_b32 v107, 0xffff0000, v43
    v_mul_f32 v106, s35, v106
    v_mul_f32 v107, s35, v107
    v_cvt_pk_bf16_f32 v43, v106, v107
    v_lshlrev_b32 v106, 16, v43
    v_and_b32 v107, 0xffff0000, v43
    v_max3_f32 v42, v42, v106, v107
    v_cvt_pk_bf16_f32 v43, v108, v109
    v_lshlrev_b32 v108, 16, v43
    v_and_b32 v109, 0xffff0000, v43
    v_mul_f32 v108, s35, v108
    v_mul_f32 v109, s35, v109
    v_cvt_pk_bf16_f32 v43, v108, v109
    v_lshlrev_b32 v108, 16, v43
    v_and_b32 v109, 0xffff0000, v43
    v_max3_f32 v42, v42, v108, v109
    v_cvt_pk_bf16_f32 v43, v110, v111
    v_lshlrev_b32 v110, 16, v43
    v_and_b32 v111, 0xffff0000, v43
    v_mul_f32 v110, s35, v110
    v_mul_f32 v111, s35, v111
    v_cvt_pk_bf16_f32 v43, v110, v111
    v_lshlrev_b32 v110, 16, v43
    v_and_b32 v111, 0xffff0000, v43
    v_max3_f32 v42, v42, v110, v111
    v_cvt_pk_bf16_f32 v43, v112, v113
    v_lshlrev_b32 v112, 16, v43
    v_and_b32 v113, 0xffff0000, v43
    v_mul_f32 v112, s35, v112
    v_mul_f32 v113, s35, v113
    v_cvt_pk_bf16_f32 v43, v112, v113
    v_lshlrev_b32 v112, 16, v43
    v_and_b32 v113, 0xffff0000, v43
    v_max3_f32 v42, v42, v112, v113
    v_cvt_pk_bf16_f32 v43, v114, v115
    v_lshlrev_b32 v114, 16, v43
    v_and_b32 v115, 0xffff0000, v43
    v_mul_f32 v114, s35, v114
    v_mul_f32 v115, s35, v115
    v_cvt_pk_bf16_f32 v43, v114, v115
    v_lshlrev_b32 v114, 16, v43
    v_and_b32 v115, 0xffff0000, v43
    v_max3_f32 v42, v42, v114, v115
    v_cvt_pk_bf16_f32 v43, v116, v117
    v_lshlrev_b32 v116, 16, v43
    v_and_b32 v117, 0xffff0000, v43
    v_mul_f32 v116, s35, v116
    v_mul_f32 v117, s35, v117
    v_cvt_pk_bf16_f32 v43, v116, v117
    v_lshlrev_b32 v116, 16, v43
    v_and_b32 v117, 0xffff0000, v43
    v_max3_f32 v42, v42, v116, v117
    v_cvt_pk_bf16_f32 v43, v118, v119
    v_lshlrev_b32 v118, 16, v43
    v_and_b32 v119, 0xffff0000, v43
    v_mul_f32 v118, s35, v118
    v_mul_f32 v119, s35, v119
    v_cvt_pk_bf16_f32 v43, v118, v119
    v_lshlrev_b32 v118, 16, v43
    v_and_b32 v119, 0xffff0000, v43
    v_max3_f32 v42, v42, v118, v119
    v_cvt_pk_bf16_f32 v43, v120, v121
    v_lshlrev_b32 v120, 16, v43
    v_and_b32 v121, 0xffff0000, v43
    v_mul_f32 v120, s35, v120
    v_mul_f32 v121, s35, v121
    v_cvt_pk_bf16_f32 v43, v120, v121
    v_lshlrev_b32 v120, 16, v43
    v_and_b32 v121, 0xffff0000, v43
    v_add_u32 v44, 256, v22
    v_cmp_le_u32 vcc, v44, v23
    s_nop 1
    v_cndmask_b32 v120, v41, v120, vcc
    v_add_u32 v44, 257, v22
    v_cmp_le_u32 vcc, v44, v23
    s_nop 1
    v_cndmask_b32 v121, v41, v121, vcc
    v_max3_f32 v42, v42, v120, v121
    v_cvt_pk_bf16_f32 v43, v122, v123
    v_lshlrev_b32 v122, 16, v43
    v_and_b32 v123, 0xffff0000, v43
    v_mul_f32 v122, s35, v122
    v_mul_f32 v123, s35, v123
    v_cvt_pk_bf16_f32 v43, v122, v123
    v_lshlrev_b32 v122, 16, v43
    v_and_b32 v123, 0xffff0000, v43
    v_add_u32 v44, 258, v22
    v_cmp_le_u32 vcc, v44, v23
    s_nop 1
    v_cndmask_b32 v122, v41, v122, vcc
    v_add_u32 v44, 259, v22
    v_cmp_le_u32 vcc, v44, v23
    s_nop 1
    v_cndmask_b32 v123, v41, v123, vcc
    v_max3_f32 v42, v42, v122, v123
    s_branch AT_join
AT_slow:
    v_cvt_pk_bf16_f32 v43, v56, v57
    v_lshlrev_b32 v56, 16, v43
    v_and_b32 v57, 0xffff0000, v43
    v_mul_f32 v56, s35, v56
    v_mul_f32 v57, s35, v57
    v_cvt_pk_bf16_f32 v43, v56, v57
    v_lshlrev_b32 v56, 16, v43
    v_and_b32 v57, 0xffff0000, v43
    v_add_u32 v44, 0, v22
    v_cmp_le_u32 vcc, v44, v23
    s_nop 1
    v_cndmask_b32 v56, v41, v56, vcc
    v_add_u32 v44, 1, v22
    v_cmp_le_u32 vcc, v44, v23
    s_nop 1
    v_cndmask_b32 v57, v41, v57, vcc
    v_max3_f32 v42, v42, v56, v57
    v_cvt_pk_bf16_f32 v43, v58, v59
    v_lshlrev_b32 v58, 16, v43
    v_and_b32 v59, 0xffff0000, v43
    v_mul_f32 v58, s35, v58
    v_mul_f32 v59, s35, v59
    v_cvt_pk_bf16_f32 v43, v58, v59
    v_lshlrev_b32 v58, 16, v43
    v_and_b32 v59, 0xffff0000, v43
    v_add_u32 v44, 2, v22
    v_cmp_le_u32 vcc, v44, v23
    s_nop 1
    v_cndmask_b32 v58, v41, v58, vcc
    v_add_u32 v44, 3, v22
    v_cmp_le_u32 vcc, v44, v23
    s_nop 1
    v_cndmask_b32 v59, v41, v59, vcc
    v_max3_f32 v42, v42, v58, v59
    v_cvt_pk_bf16_f32 v43, v60, v61
    v_lshlrev_b32 v60, 16, v43
    v_and_b32 v61, 0xffff0000, v43
    v_mul_f32 v60, s35, v60
    v_mul_f32 v61, s35, v61
    v_cvt_pk_bf16_f32 v43, v60, v61
    v_lshlrev_b32 v60, 16, v43
    v_and_b32 v61, 0xffff0000, v43
    v_add_u32 v44, 16, v22
    v_cmp_le_u32 vcc, v44, v23
    s_nop 1
    v_cndmask_b32 v60, v41, v60, vcc
    v_add_u32 v44, 17, v22
    v_cmp_le_u32 vcc, v44, v23
    s_nop 1
    v_cndmask_b32 v61, v41, v61, vcc
    v_max3_f32 v42, v42, v60, v61
    v_cvt_pk_bf16_f32 v43, v62, v63
    v_lshlrev_b32 v62, 16, v43
    v_and_b32 v63, 0xffff0000, v43
    v_mul_f32 v62, s35, v62
    v_mul_f32 v63, s35, v63
    v_cvt_pk_bf16_f32 v43, v62, v63
    v_lshlrev_b32 v62, 16, v43
    v_and_b32 v63, 0xffff0000, v43
    v_add_u32 v44, 18, v22
    v_cmp_le_u32 vcc, v44, v23
    s_nop 1
    v_cndmask_b32 v62, v41, v62, vcc
    v_add_u32 v44, 19, v22
    v_cmp_le_u32 vcc, v44, v23
    s_nop 1
    v_cndmask_b32 v63, v41, v63, vcc
    v_max3_f32 v42, v42, v62, v63
    v_cvt_pk_bf16_f32 v43, v64, v65
    v_lshlrev_b32 v64, 16, v43
    v_and_b32 v65, 0xffff0000, v43
    v_mul_f32 v64, s35, v64
    v_mul_f32 v65, s35, v65
    v_cvt_pk_bf16_f32 v43, v64, v65
    v_lshlrev_b32 v64, 16, v43
    v_and_b32 v65, 0xffff0000, v43
    v_add_u32 v44, 32, v22
    v_cmp_le_u32 vcc, v44, v23
    s_nop 1
    v_cndmask_b32 v64, v41, v64, vcc
    v_add_u32 v44, 33, v22
    v_cmp_le_u32 vcc, v44, v23
    s_nop 1
    v_cndmask_b32 v65, v41, v65, vcc
    v_max3_f32 v42, v42, v64, v65
    v_cvt_pk_bf16_f32 v43, v66, v67
    v_lshlrev_b32 v66, 16, v43
    v_and_b32 v67, 0xffff0000, v43
    v_mul_f32 v66, s35, v66
    v_mul_f32 v67, s35, v67
    v_cvt_pk_bf16_f32 v43, v66, v67
    v_lshlrev_b32 v66, 16, v43
    v_and_b32 v67, 0xffff0000, v43
    v_add_u32 v44, 34, v22
    v_cmp_le_u32 vcc, v44, v23
    s_nop 1
    v_cndmask_b32 v66, v41, v66, vcc
    v_add_u32 v44, 35, v22
    v_cmp_le_u32 vcc, v44, v23
    s_nop 1
    v_cndmask_b32 v67, v41, v67, vcc
    v_max3_f32 v42, v42, v66, v67
    v_cvt_pk_bf16_f32 v43, v68, v69
    v_lshlrev_b32 v68, 16, v43
    v_and_b32 v69, 0xffff0000, v43
    v_mul_f32 v68, s35, v68
    v_mul_f32 v69, s35, v69
    v_cvt_pk_bf16_f32 v43, v68, v69
    v_lshlrev_b32 v68, 16, v43
    v_and_b32 v69, 0xffff0000, v43
    v_add_u32 v44, 48, v22
    v_cmp_le_u32 vcc, v44, v23
    s_nop 1
    v_cndmask_b32 v68, v41, v68, vcc
    v_add_u32 v44, 49, v22
    v_cmp_le_u32 vcc, v44, v23
    s_nop 1
    v_cndmask_b32 v69, v41, v69, vcc
    v_max3_f32 v42, v42, v68, v69
    v_cvt_pk_bf16_f32 v43, v70, v71
    v_lshlrev_b32 v70, 16, v43
    v_and_b32 v71, 0xffff0000, v43
    v_mul_f32 v70, s35, v70
    v_mul_f32 v71, s35, v71
    v_cvt_pk_bf16_f32 v43, v70, v71
    v_lshlrev_b32 v70, 16, v43
    v_and_b32 v71, 0xffff0000, v43
    v_add_u32 v44, 50, v22
    v_cmp_le_u32 vcc, v44, v23
    s_nop 1
    v_cndmask_b32 v70, v41, v70, vcc
    v_add_u32 v44, 51, v22
    v_cmp_le_u32 vcc, v44, v23
    s_nop 1
    v_cndmask_b32 v71, v41, v71, vcc
    v_max3_f32 v42, v42, v70, v71
    v_cvt_pk_bf16_f32 v43, v72, v73
    v_lshlrev_b32 v72, 16, v43
    v_and_b32 v73, 0xffff0000, v43
    v_mul_f32 v72, s35, v72
    v_mul_f32 v73, s35, v73
    v_cvt_pk_bf16_f32 v43, v72, v73
    v_lshlrev_b32 v72, 16, v43
    v_and_b32 v73, 0xffff0000, v43
    v_add_u32 v44, 64, v22
    v_cmp_le_u32 vcc, v44, v23
    s_nop 1
    v_cndmask_b32 v72, v41, v72, vcc
    v_add_u32 v44, 65, v22
    v_cmp_le_u32 vcc, v44, v23
    s_nop 1
    v_cndmask_b32 v73, v41, v73, vcc
    v_max3_f32 v42, v42, v72, v73
    v_cvt_pk_bf16_f32 v43, v74, v75
    v_lshlrev_b32 v74, 16, v43
    v_and_b32 v75, 0xffff0000, v43
    v_mul_f32 v74, s35, v74
    v_mul_f32 v75, s35, v75
    v_cvt_pk_bf16_f32 v43, v74, v75
    v_lshlrev_b32 v74, 16, v43
    v_and_b32 v75, 0xffff0000, v43
    v_add_u32 v44, 66, v22
    v_cmp_le_u32 vcc, v44, v23
    s_nop 1
    v_cndmask_b32 v74, v41, v74, vcc
    v_add_u32 v44, 67, v22
    v_cmp_le_u32 vcc, v44, v23
    s_nop 1
    v_cndmask_b32 v75, v41, v75, vcc
    v_max3_f32 v42, v42, v74, v75
    v_cvt_pk_bf16_f32 v43, v76, v77
    v_lshlrev_b32 v76, 16, v43
    v_and_b32 v77, 0xffff0000, v43
    v_mul_f32 v76, s35, v76
    v_mul_f32 v77, s35, v77
    v_cvt_pk_bf16_f32 v43, v76, v77
    v_lshlrev_b32 v76, 16, v43
    v_and_b32 v77, 0xffff0000, v43
    v_add_u32 v44, 80, v22
    v_cmp_le_u32 vcc, v44, v23
    s_nop 1
    v_cndmask_b32 v76, v41, v76, vcc
    v_add_u32 v44, 81, v22
    v_cmp_le_u32 vcc, v44, v23
    s_nop 1
    v_cndmask_b32 v77, v41, v77, vcc
    v_max3_f32 v42, v42, v76, v77
    v_cvt_pk_bf16_f32 v43, v78, v79
    v_lshlrev_b32 v78, 16, v43
    v_and_b32 v79, 0xffff0000, v43
    v_mul_f32 v78, s35, v78
    v_mul_f32 v79, s35, v79
    v_cvt_pk_bf16_f32 v43, v78, v79
    v_lshlrev_b32 v78, 16, v43
    v_and_b32 v79, 0xffff0000, v43
    v_add_u32 v44, 82, v22
    v_cmp_le_u32 vcc, v44, v23
    s_nop 1
    v_cndmask_b32 v78, v41, v78, vcc
    v_add_u32 v44, 83, v22
    v_cmp_le_u32 vcc, v44, v23
    s_nop 1
    v_cndmask_b32 v79, v41, v79, vcc
    v_max3_f32 v42, v42, v78, v79
    v_cvt_pk_bf16_f32 v43, v80, v81
    v_lshlrev_b32 v80, 16, v43
    v_and_b32 v81, 0xffff0000, v43
    v_mul_f32 v80, s35, v80
    v_mul_f32 v81, s35, v81
    v_cvt_pk_bf16_f32 v43, v80, v81
    v_lshlrev_b32 v80, 16, v43
    v_and_b32 v81, 0xffff0000, v43
    v_add_u32 v44, 96, v22
    v_cmp_le_u32 vcc, v44, v23
    s_nop 1
    v_cndmask_b32 v80, v41, v80, vcc
    v_add_u32 v44, 97, v22
    v_cmp_le_u32 vcc, v44, v23
    s_nop 1
    v_cndmask_b32 v81, v41, v81, vcc
    v_max3_f32 v42, v42, v80, v81
    v_cvt_pk_bf16_f32 v43, v82, v83
    v_lshlrev_b32 v82, 16, v43
    v_and_b32 v83, 0xffff0000, v43
    v_mul_f32 v82, s35, v82
    v_mul_f32 v83, s35, v83
    v_cvt_pk_bf16_f32 v43, v82, v83
    v_lshlrev_b32 v82, 16, v43
    v_and_b32 v83, 0xffff0000, v43
    v_add_u32 v44, 98, v22
    v_cmp_le_u32 vcc, v44, v23
    s_nop 1
    v_cndmask_b32 v82, v41, v82, vcc
    v_add_u32 v44, 99, v22
    v_cmp_le_u32 vcc, v44, v23
    s_nop 1
    v_cndmask_b32 v83, v41, v83, vcc
    v_max3_f32 v42, v42, v82, v83
    v_cvt_pk_bf16_f32 v43, v84, v85
    v_lshlrev_b32 v84, 16, v43
    v_and_b32 v85, 0xffff0000, v43
    v_mul_f32 v84, s35, v84
    v_mul_f32 v85, s35, v85
    v_cvt_pk_bf16_f32 v43, v84, v85
    v_lshlrev_b32 v84, 16, v43
    v_and_b32 v85, 0xffff0000, v43
    v_add_u32 v44, 112, v22
    v_cmp_le_u32 vcc, v44, v23
    s_nop 1
    v_cndmask_b32 v84, v41, v84, vcc
    v_add_u32 v44, 113, v22
    v_cmp_le_u32 vcc, v44, v23
    s_nop 1
    v_cndmask_b32 v85, v41, v85, vcc
    v_max3_f32 v42, v42, v84, v85
    v_cvt_pk_bf16_f32 v43, v86, v87
    v_lshlrev_b32 v86, 16, v43
    v_and_b32 v87, 0xffff0000, v43
    v_mul_f32 v86, s35, v86
    v_mul_f32 v87, s35, v87
    v_cvt_pk_bf16_f32 v43, v86, v87
    v_lshlrev_b32 v86, 16, v43
    v_and_b32 v87, 0xffff0000, v43
    v_add_u32 v44, 114, v22
    v_cmp_le_u32 vcc, v44, v23
    s_nop 1
    v_cndmask_b32 v86, v41, v86, vcc
    v_add_u32 v44, 115, v22
    v_cmp_le_u32 vcc, v44, v23
    s_nop 1
    v_cndmask_b32 v87, v41, v87, vcc
    v_max3_f32 v42, v42, v86, v87
    v_cvt_pk_bf16_f32 v43, v88, v89
    v_lshlrev_b32 v88, 16, v43
    v_and_b32 v89, 0xffff0000, v43
    v_mul_f32 v88, s35, v88
    v_mul_f32 v89, s35, v89
    v_cvt_pk_bf16_f32 v43, v88, v89
    v_lshlrev_b32 v88, 16, v43
    v_and_b32 v89, 0xffff0000, v43
    v_add_u32 v44, 128, v22
    v_cmp_le_u32 vcc, v44, v23
    s_nop 1
    v_cndmask_b32 v88, v41, v88, vcc
    v_add_u32 v44, 129, v22
    v_cmp_le_u32 vcc, v44, v23
    s_nop 1
    v_cndmask_b32 v89, v41, v89, vcc
    v_max3_f32 v42, v42, v88, v89
    v_cvt_pk_bf16_f32 v43, v90, v91
    v_lshlrev_b32 v90, 16, v43
    v_and_b32 v91, 0xffff0000, v43
    v_mul_f32 v90, s35, v90
    v_mul_f32 v91, s35, v91
    v_cvt_pk_bf16_f32 v43, v90, v91
    v_lshlrev_b32 v90, 16, v43
    v_and_b32 v91, 0xffff0000, v43
    v_add_u32 v44, 130, v22
    v_cmp_le_u32 vcc, v44, v23
    s_nop 1
    v_cndmask_b32 v90, v41, v90, vcc
    v_add_u32 v44, 131, v22
    v_cmp_le_u32 vcc, v44, v23
    s_nop 1
    v_cndmask_b32 v91, v41, v91, vcc
    v_max3_f32 v42, v42, v90, v91
    v_cvt_pk_bf16_f32 v43, v92, v93
    v_lshlrev_b32 v92, 16, v43
    v_and_b32 v93, 0xffff0000, v43
    v_mul_f32 v92, s35, v92
    v_mul_f32 v93, s35, v93
    v_cvt_pk_bf16_f32 v43, v92, v93
    v_lshlrev_b32 v92, 16, v43
    v_and_b32 v93, 0xffff0000, v43
    v_add_u32 v44, 144, v22
    v_cmp_le_u32 vcc, v44, v23
    s_nop 1
    v_cndmask_b32 v92, v41, v92, vcc
    v_add_u32 v44, 145, v22
    v_cmp_le_u32 vcc, v44, v23
    s_nop 1
    v_cndmask_b32 v93, v41, v93, vcc
    v_max3_f32 v42, v42, v92, v93
    v_cvt_pk_bf16_f32 v43, v94, v95
    v_lshlrev_b32 v94, 16, v43
    v_and_b32 v95, 0xffff0000, v43
    v_mul_f32 v94, s35, v94
    v_mul_f32 v95, s35, v95
    v_cvt_pk_bf16_f32 v43, v94, v95
    v_lshlrev_b32 v94, 16, v43
    v_and_b32 v95, 0xffff0000, v43
    v_add_u32 v44, 146, v22
    v_cmp_le_u32 vcc, v44, v23
    s_nop 1
    v_cndmask_b32 v94, v41, v94, vcc
    v_add_u32 v44, 147, v22
    v_cmp_le_u32 vcc, v44, v23
    s_nop 1
    v_cndmask_b32 v95, v41, v95, vcc
    v_max3_f32 v42, v42, v94, v95
    v_cvt_pk_bf16_f32 v43, v96, v97
    v_lshlrev_b32 v96, 16, v43
    v_and_b32 v97, 0xffff0000, v43
    v_mul_f32 v96, s35, v96
    v_mul_f32 v97, s35, v97
    v_cvt_pk_bf16_f32 v43, v96, v97
    v_lshlrev_b32 v96, 16, v43
    v_and_b32 v97, 0xffff0000, v43
    v_add_u32 v44, 160, v22
    v_cmp_le_u32 vcc, v44, v23
    s_nop 1
    v_cndmask_b32 v96, v41, v96, vcc
    v_add_u32 v44, 161, v22
    v_cmp_le_u32 vcc, v44, v23
    s_nop 1
    v_cndmask_b32 v97, v41, v97, vcc
    v_max3_f32 v42, v42, v96, v97
    v_cvt_pk_bf16_f32 v43, v98, v99
    v_lshlrev_b32 v98, 16, v43
    v_and_b32 v99, 0xffff0000, v43
    v_mul_f32 v98, s35, v98
    v_mul_f32 v99, s35, v99
    v_cvt_pk_bf16_f32 v43, v98, v99
    v_lshlrev_b32 v98, 16, v43
    v_and_b32 v99, 0xffff0000, v43
    v_add_u32 v44, 162, v22
    v_cmp_le_u32 vcc, v44, v23
    s_nop 1
    v_cndmask_b32 v98, v41, v98, vcc
    v_add_u32 v44, 163, v22
    v_cmp_le_u32 vcc, v44, v23
    s_nop 1
    v_cndmask_b32 v99, v41, v99, vcc
    v_max3_f32 v42, v42, v98, v99
    v_cvt_pk_bf16_f32 v43, v100, v101
    v_lshlrev_b32 v100, 16, v43
    v_and_b32 v101, 0xffff0000, v43
    v_mul_f32 v100, s35, v100
    v_mul_f32 v101, s35, v101
    v_cvt_pk_bf16_f32 v43, v100, v101
    v_lshlrev_b32 v100, 16, v43
    v_and_b32 v101, 0xffff0000, v43
    v_add_u32 v44, 176, v22
    v_cmp_le_u32 vcc, v44, v23
    s_nop 1
    v_cndmask_b32 v100, v41, v100, vcc
    v_add_u32 v44, 177, v22
    v_cmp_le_u32 vcc, v44, v23
    s_nop 1
    v_cndmask_b32 v101, v41, v101, vcc
    v_max3_f32 v42, v42, v100, v101
    v_cvt_pk_bf16_f32 v43, v102, v103
    v_lshlrev_b32 v102, 16, v43
    v_and_b32 v103, 0xffff0000, v43
    v_mul_f32 v102, s35, v102
    v_mul_f32 v103, s35, v103
    v_cvt_pk_bf16_f32 v43, v102, v103
    v_lshlrev_b32 v102, 16, v43
    v_and_b32 v103, 0xffff0000, v43
    v_add_u32 v44, 178, v22
    v_cmp_le_u32 vcc, v44, v23
    s_nop 1
    v_cndmask_b32 v102, v41, v102, vcc
    v_add_u32 v44, 179, v22
    v_cmp_le_u32 vcc, v44, v23
    s_nop 1
    v_cndmask_b32 v103, v41, v103, vcc
    v_max3_f32 v42, v42, v102, v103
    v_cvt_pk_bf16_f32 v43, v104, v105
    v_lshlrev_b32 v104, 16, v43
    v_and_b32 v105, 0xffff0000, v43
    v_mul_f32 v104, s35, v104
    v_mul_f32 v105, s35, v105
    v_cvt_pk_bf16_f32 v43, v104, v105
    v_lshlrev_b32 v104, 16, v43
    v_and_b32 v105, 0xffff0000, v43
    v_add_u32 v44, 192, v22
    v_cmp_le_u32 vcc, v44, v23
    s_nop 1
    v_cndmask_b32 v104, v41, v104, vcc
    v_add_u32 v44, 193, v22
    v_cmp_le_u32 vcc, v44, v23
    s_nop 1
    v_cndmask_b32 v105, v41, v105, vcc
    v_max3_f32 v42, v42, v104, v105
    v_cvt_pk_bf16_f32 v43, v106, v107
    v_lshlrev_b32 v106, 16, v43
    v_and_b32 v107, 0xffff0000, v43
    v_mul_f32 v106, s35, v106
    v_mul_f32 v107, s35, v107
    v_cvt_pk_bf16_f32 v43, v106, v107
    v_lshlrev_b32 v106, 16, v43
    v_and_b32 v107, 0xffff0000, v43
    v_add_u32 v44, 194, v22
    v_cmp_le_u32 vcc, v44, v23
    s_nop 1
    v_cndmask_b32 v106, v41, v106, vcc
    v_add_u32 v44, 195, v22
    v_cmp_le_u32 vcc, v44, v23
    s_nop 1
    v_cndmask_b32 v107, v41, v107, vcc
    v_max3_f32 v42, v42, v106, v107
    v_cvt_pk_bf16_f32 v43, v108, v109
    v_lshlrev_b32 v108, 16, v43
    v_and_b32 v109, 0xffff0000, v43
    v_mul_f32 v108, s35, v108
    v_mul_f32 v109, s35, v109
    v_cvt_pk_bf16_f32 v43, v108, v109
    v_lshlrev_b32 v108, 16, v43
    v_and_b32 v109, 0xffff0000, v43
    v_add_u32 v44, 208, v22
    v_cmp_le_u32 vcc, v44, v23
    s_nop 1
    v_cndmask_b32 v108, v41, v108, vcc
    v_add_u32 v44, 209, v22
    v_cmp_le_u32 vcc, v44, v23
    s_nop 1
    v_cndmask_b32 v109, v41, v109, vcc
    v_max3_f32 v42, v42, v108, v109
    v_cvt_pk_bf16_f32 v43, v110, v111
    v_lshlrev_b32 v110, 16, v43
    v_and_b32 v111, 0xffff0000, v43
    v_mul_f32 v110, s35, v110
    v_mul_f32 v111, s35, v111
    v_cvt_pk_bf16_f32 v43, v110, v111
    v_lshlrev_b32 v110, 16, v43
    v_and_b32 v111, 0xffff0000, v43
    v_add_u32 v44, 210, v22
    v_cmp_le_u32 vcc, v44, v23
    s_nop 1
    v_cndmask_b32 v110, v41, v110, vcc
    v_add_u32 v44, 211, v22
    v_cmp_le_u32 vcc, v44, v23
    s_nop 1
    v_cndmask_b32 v111, v41, v111, vcc
    v_max3_f32 v42, v42, v110, v111
    v_cvt_pk_bf16_f32 v43, v112, v113
    v_lshlrev_b32 v112, 16, v43
    v_and_b32 v113, 0xffff0000, v43
    v_mul_f32 v112, s35, v112
    v_mul_f32 v113, s35, v113
    v_cvt_pk_bf16_f32 v43, v112, v113
    v_lshlrev_b32 v112, 16, v43
    v_and_b32 v113, 0xffff0000, v43
    v_add_u32 v44, 224, v22
    v_cmp_le_u32 vcc, v44, v23
    s_nop 1
    v_cndmask_b32 v112, v41, v112, vcc
    v_add_u32 v44, 225, v22
    v_cmp_le_u32 vcc, v44, v23
    s_nop 1
    v_cndmask_b32 v113, v41, v113, vcc
    v_max3_f32 v42, v42, v112, v113
    v_cvt_pk_bf16_f32 v43, v114, v115
    v_lshlrev_b32 v114, 16, v43
    v_and_b32 v115, 0xffff0000, v43
    v_mul_f32 v114, s35, v114
    v_mul_f32 v115, s35, v115
    v_cvt_pk_bf16_f32 v43, v114, v115
    v_lshlrev_b32 v114, 16, v43
    v_and_b32 v115, 0xffff0000, v43
    v_add_u32 v44, 226, v22
    v_cmp_le_u32 vcc, v44, v23
    s_nop 1
    v_cndmask_b32 v114, v41, v114, vcc
    v_add_u32 v44, 227, v22
    v_cmp_le_u32 vcc, v44, v23
    s_nop 1
    v_cndmask_b32 v115, v41, v115, vcc
    v_max3_f32 v42, v42, v114, v115
    v_cvt_pk_bf16_f32 v43, v116, v117
    v_lshlrev_b32 v116, 16, v43
    v_and_b32 v117, 0xffff0000, v43
    v_mul_f32 v116, s35, v116
    v_mul_f32 v117, s35, v117
    v_cvt_pk_bf16_f32 v43, v116, v117
    v_lshlrev_b32 v116, 16, v43
    v_and_b32 v117, 0xffff0000, v43
    v_add_u32 v44, 240, v22
    v_cmp_le_u32 vcc, v44, v23
    s_nop 1
    v_cndmask_b32 v116, v41, v116, vcc
    v_add_u32 v44, 241, v22
    v_cmp_le_u32 vcc, v44, v23
    s_nop 1
    v_cndmask_b32 v117, v41, v117, vcc
    v_max3_f32 v42, v42, v116, v117
    v_cvt_pk_bf16_f32 v43, v118, v119
    v_lshlrev_b32 v118, 16, v43
    v_and_b32 v119, 0xffff0000, v43
    v_mul_f32 v118, s35, v118
    v_mul_f32 v119, s35, v119
    v_cvt_pk_bf16_f32 v43, v118, v119
    v_lshlrev_b32 v118, 16, v43
    v_and_b32 v119, 0xffff0000, v43
    v_add_u32 v44, 242, v22
    v_cmp_le_u32 vcc, v44, v23
    s_nop 1
    v_cndmask_b32 v118, v41, v118, vcc
    v_add_u32 v44, 243, v22
    v_cmp_le_u32 vcc, v44, v23
    s_nop 1
    v_cndmask_b32 v119, v41, v119, vcc
    v_max3_f32 v42, v42, v118, v119
    v_cvt_pk_bf16_f32 v43, v120, v121
    v_lshlrev_b32 v120, 16, v43
    v_and_b32 v121, 0xffff0000, v43
    v_mul_f32 v120, s35, v120
    v_mul_f32 v121, s35, v121
    v_cvt_pk_bf16_f32 v43, v120, v121
    v_lshlrev_b32 v120, 16, v43
    v_and_b32 v121, 0xffff0000, v43
    v_add_u32 v44, 256, v22
    v_cmp_le_u32 vcc, v44, v23
    s_nop 1
    v_cndmask_b32 v120, v41, v120, vcc
    v_add_u32 v44, 257, v22
    v_cmp_le_u32 vcc, v44, v23
    s_nop 1
    v_cndmask_b32 v121, v41, v121, vcc
    v_max3_f32 v42, v42, v120, v121
    v_cvt_pk_bf16_f32 v43, v122, v123
    v_lshlrev_b32 v122, 16, v43
    v_and_b32 v123, 0xffff0000, v43
    v_mul_f32 v122, s35, v122
    v_mul_f32 v123, s35, v123
    v_cvt_pk_bf16_f32 v43, v122, v123
    v_lshlrev_b32 v122, 16, v43
    v_and_b32 v123, 0xffff0000, v43
    v_add_u32 v44, 258, v22
    v_cmp_le_u32 vcc, v44, v23
    s_nop 1
    v_cndmask_b32 v122, v41, v122, vcc
    v_add_u32 v44, 259, v22
    v_cmp_le_u32 vcc, v44, v23
    s_nop 1
    v_cndmask_b32 v123, v41, v123, vcc
    v_max3_f32 v42, v42, v122, v123
AT_join:
    ds_swizzle_b32 v43, v42 offset:0x401F
    s_waitcnt lgkmcnt(0)
    v_max_f32 v42, v42, v43
    v_lshlrev_b32 v45, 2, v0
    v_xor_b32 v45, 128, v45
    ds_bpermute_b32 v43, v45, v42
    s_waitcnt lgkmcnt(0)
    v_max_f32 v42, v42, v43
    s_mov_b32 s36, 0x3fb8aa3b
    v_mul_f32 v42, s36, v42
    v_mov_b32 v46, 0
    v_mov_b32 v47, s36
    v_fma_f32 v56, v56, v47, -v42
    v_exp_f32 v56, v56
    v_fma_f32 v57, v57, v47, -v42
    v_exp_f32 v57, v57
    v_fma_f32 v58, v58, v47, -v42
    v_exp_f32 v58, v58
    v_fma_f32 v59, v59, v47, -v42
    v_exp_f32 v59, v59
    v_add_f32 v46, v46, v56
    v_add_f32 v46, v46, v57
    v_add_f32 v46, v46, v58
    v_add_f32 v46, v46, v59
    v_fma_f32 v60, v60, v47, -v42
    v_exp_f32 v60, v60
    v_fma_f32 v61, v61, v47, -v42
    v_exp_f32 v61, v61
    v_fma_f32 v62, v62, v47, -v42
    v_exp_f32 v62, v62
    v_fma_f32 v63, v63, v47, -v42
    v_exp_f32 v63, v63
    v_add_f32 v46, v46, v60
    v_add_f32 v46, v46, v61
    v_add_f32 v46, v46, v62
    v_add_f32 v46, v46, v63
    v_fma_f32 v64, v64, v47, -v42
    v_exp_f32 v64, v64
    v_fma_f32 v65, v65, v47, -v42
    v_exp_f32 v65, v65
    v_fma_f32 v66, v66, v47, -v42
    v_exp_f32 v66, v66
    v_fma_f32 v67, v67, v47, -v42
    v_exp_f32 v67, v67
    v_add_f32 v46, v46, v64
    v_add_f32 v46, v46, v65
    v_add_f32 v46, v46, v66
    v_add_f32 v46, v46, v67
    v_fma_f32 v68, v68, v47, -v42
    v_exp_f32 v68, v68
    v_fma_f32 v69, v69, v47, -v42
    v_exp_f32 v69, v69
    v_fma_f32 v70, v70, v47, -v42
    v_exp_f32 v70, v70
    v_fma_f32 v71, v71, v47, -v42
    v_exp_f32 v71, v71
    v_add_f32 v46, v46, v68
    v_add_f32 v46, v46, v69
    v_add_f32 v46, v46, v70
    v_add_f32 v46, v46, v71
    v_fma_f32 v72, v72, v47, -v42
    v_exp_f32 v72, v72
    v_fma_f32 v73, v73, v47, -v42
    v_exp_f32 v73, v73
    v_fma_f32 v74, v74, v47, -v42
    v_exp_f32 v74, v74
    v_fma_f32 v75, v75, v47, -v42
    v_exp_f32 v75, v75
    v_add_f32 v46, v46, v72
    v_add_f32 v46, v46, v73
    v_add_f32 v46, v46, v74
    v_add_f32 v46, v46, v75
    v_fma_f32 v76, v76, v47, -v42
    v_exp_f32 v76, v76
    v_fma_f32 v77, v77, v47, -v42
    v_exp_f32 v77, v77
    v_fma_f32 v78, v78, v47, -v42
    v_exp_f32 v78, v78
    v_fma_f32 v79, v79, v47, -v42
    v_exp_f32 v79, v79
    v_add_f32 v46, v46, v76
    v_add_f32 v46, v46, v77
    v_add_f32 v46, v46, v78
    v_add_f32 v46, v46, v79
    v_fma_f32 v80, v80, v47, -v42
    v_exp_f32 v80, v80
    v_fma_f32 v81, v81, v47, -v42
    v_exp_f32 v81, v81
    v_fma_f32 v82, v82, v47, -v42
    v_exp_f32 v82, v82
    v_fma_f32 v83, v83, v47, -v42
    v_exp_f32 v83, v83
    v_add_f32 v46, v46, v80
    v_add_f32 v46, v46, v81
    v_add_f32 v46, v46, v82
    v_add_f32 v46, v46, v83
    v_fma_f32 v84, v84, v47, -v42
    v_exp_f32 v84, v84
    v_fma_f32 v85, v85, v47, -v42
    v_exp_f32 v85, v85
    v_fma_f32 v86, v86, v47, -v42
    v_exp_f32 v86, v86
    v_fma_f32 v87, v87, v47, -v42
    v_exp_f32 v87, v87
    v_add_f32 v46, v46, v84
    v_add_f32 v46, v46, v85
    v_add_f32 v46, v46, v86
    v_add_f32 v46, v46, v87
    v_fma_f32 v88, v88, v47, -v42
    v_exp_f32 v88, v88
    v_fma_f32 v89, v89, v47, -v42
    v_exp_f32 v89, v89
    v_fma_f32 v90, v90, v47, -v42
    v_exp_f32 v90, v90
    v_fma_f32 v91, v91, v47, -v42
    v_exp_f32 v91, v91
    v_add_f32 v46, v46, v88
    v_add_f32 v46, v46, v89
    v_add_f32 v46, v46, v90
    v_add_f32 v46, v46, v91
    v_fma_f32 v92, v92, v47, -v42
    v_exp_f32 v92, v92
    v_fma_f32 v93, v93, v47, -v42
    v_exp_f32 v93, v93
    v_fma_f32 v94, v94, v47, -v42
    v_exp_f32 v94, v94
    v_fma_f32 v95, v95, v47, -v42
    v_exp_f32 v95, v95
    v_add_f32 v46, v46, v92
    v_add_f32 v46, v46, v93
    v_add_f32 v46, v46, v94
    v_add_f32 v46, v46, v95
    v_fma_f32 v96, v96, v47, -v42
    v_exp_f32 v96, v96
    v_fma_f32 v97, v97, v47, -v42
    v_exp_f32 v97, v97
    v_fma_f32 v98, v98, v47, -v42
    v_exp_f32 v98, v98
    v_fma_f32 v99, v99, v47, -v42
    v_exp_f32 v99, v99
    v_add_f32 v46, v46, v96
    v_add_f32 v46, v46, v97
    v_add_f32 v46, v46, v98
    v_add_f32 v46, v46, v99
    v_fma_f32 v100, v100, v47, -v42
    v_exp_f32 v100, v100
    v_fma_f32 v101, v101, v47, -v42
    v_exp_f32 v101, v101
    v_fma_f32 v102, v102, v47, -v42
    v_exp_f32 v102, v102
    v_fma_f32 v103, v103, v47, -v42
    v_exp_f32 v103, v103
    v_add_f32 v46, v46, v100
    v_add_f32 v46, v46, v101
    v_add_f32 v46, v46, v102
    v_add_f32 v46, v46, v103
    v_fma_f32 v104, v104, v47, -v42
    v_exp_f32 v104, v104
    v_fma_f32 v105, v105, v47, -v42
    v_exp_f32 v105, v105
    v_fma_f32 v106, v106, v47, -v42
    v_exp_f32 v106, v106
    v_fma_f32 v107, v107, v47, -v42
    v_exp_f32 v107, v107
    v_add_f32 v46, v46, v104
    v_add_f32 v46, v46, v105
    v_add_f32 v46, v46, v106
    v_add_f32 v46, v46, v107
    v_fma_f32 v108, v108, v47, -v42
    v_exp_f32 v108, v108
    v_fma_f32 v109, v109, v47, -v42
    v_exp_f32 v109, v109
    v_fma_f32 v110, v110, v47, -v42
    v_exp_f32 v110, v110
    v_fma_f32 v111, v111, v47, -v42
    v_exp_f32 v111, v111
    v_add_f32 v46, v46, v108
    v_add_f32 v46, v46, v109
    v_add_f32 v46, v46, v110
    v_add_f32 v46, v46, v111
    v_fma_f32 v112, v112, v47, -v42
    v_exp_f32 v112, v112
    v_fma_f32 v113, v113, v47, -v42
    v_exp_f32 v113, v113
    v_fma_f32 v114, v114, v47, -v42
    v_exp_f32 v114, v114
    v_fma_f32 v115, v115, v47, -v42
    v_exp_f32 v115, v115
    v_add_f32 v46, v46, v112
    v_add_f32 v46, v46, v113
    v_add_f32 v46, v46, v114
    v_add_f32 v46, v46, v115
    v_fma_f32 v116, v116, v47, -v42
    v_exp_f32 v116, v116
    v_fma_f32 v117, v117, v47, -v42
    v_exp_f32 v117, v117
    v_fma_f32 v118, v118, v47, -v42
    v_exp_f32 v118, v118
    v_fma_f32 v119, v119, v47, -v42
    v_exp_f32 v119, v119
    v_add_f32 v46, v46, v116
    v_add_f32 v46, v46, v117
    v_add_f32 v46, v46, v118
    v_add_f32 v46, v46, v119
    v_fma_f32 v120, v120, v47, -v42
    v_exp_f32 v120, v120
    v_fma_f32 v121, v121, v47, -v42
    v_exp_f32 v121, v121
    v_fma_f32 v122, v122, v47, -v42
    v_exp_f32 v122, v122
    v_fma_f32 v123, v123, v47, -v42
    v_exp_f32 v123, v123
    v_add_f32 v46, v46, v120
    v_add_f32 v46, v46, v121
    v_add_f32 v46, v46, v122
    v_add_f32 v46, v46, v123
    ds_swizzle_b32 v43, v46 offset:0x401F
    s_waitcnt lgkmcnt(0)
    v_add_f32 v46, v46, v43
    ds_bpermute_b32 v43, v45, v46
    s_waitcnt lgkmcnt(0)
    v_add_f32 v46, v46, v43
    v_rcp_f32 v46, v46
    s_nop 0
    v_mul_f32 v56, v56, v46
    v_mul_f32 v57, v57, v46
    v_mul_f32 v58, v58, v46
    v_mul_f32 v59, v59, v46
    v_cvt_pk_bf16_f32 v56, v56, v57
    v_cvt_pk_bf16_f32 v57, v58, v59
    v_mul_f32 v60, v60, v46
    v_mul_f32 v61, v61, v46
    v_mul_f32 v62, v62, v46
    v_mul_f32 v63, v63, v46
    v_cvt_pk_bf16_f32 v58, v60, v61
    v_cvt_pk_bf16_f32 v59, v62, v63
    v_mul_f32 v64, v64, v46
    v_mul_f32 v65, v65, v46
    v_mul_f32 v66, v66, v46
    v_mul_f32 v67, v67, v46
    v_cvt_pk_bf16_f32 v60, v64, v65
    v_cvt_pk_bf16_f32 v61, v66, v67
    v_mul_f32 v68, v68, v46
    v_mul_f32 v69, v69, v46
    v_mul_f32 v70, v70, v46
    v_mul_f32 v71, v71, v46
    v_cvt_pk_bf16_f32 v62, v68, v69
    v_cvt_pk_bf16_f32 v63, v70, v71
    v_mul_f32 v72, v72, v46
    v_mul_f32 v73, v73, v46
    v_mul_f32 v74, v74, v46
    v_mul_f32 v75, v75, v46
    v_cvt_pk_bf16_f32 v64, v72, v73
    v_cvt_pk_bf16_f32 v65, v74, v75
    v_mul_f32 v76, v76, v46
    v_mul_f32 v77, v77, v46
    v_mul_f32 v78, v78, v46
    v_mul_f32 v79, v79, v46
    v_cvt_pk_bf16_f32 v66, v76, v77
    v_cvt_pk_bf16_f32 v67, v78, v79
    v_mul_f32 v80, v80, v46
    v_mul_f32 v81, v81, v46
    v_mul_f32 v82, v82, v46
    v_mul_f32 v83, v83, v46
    v_cvt_pk_bf16_f32 v68, v80, v81
    v_cvt_pk_bf16_f32 v69, v82, v83
    v_mul_f32 v84, v84, v46
    v_mul_f32 v85, v85, v46
    v_mul_f32 v86, v86, v46
    v_mul_f32 v87, v87, v46
    v_cvt_pk_bf16_f32 v70, v84, v85
    v_cvt_pk_bf16_f32 v71, v86, v87
    v_mul_f32 v88, v88, v46
    v_mul_f32 v89, v89, v46
    v_mul_f32 v90, v90, v46
    v_mul_f32 v91, v91, v46
    v_cvt_pk_bf16_f32 v72, v88, v89
    v_cvt_pk_bf16_f32 v73, v90, v91
    v_mul_f32 v92, v92, v46
    v_mul_f32 v93, v93, v46
    v_mul_f32 v94, v94, v46
    v_mul_f32 v95, v95, v46
    v_cvt_pk_bf16_f32 v74, v92, v93
    v_cvt_pk_bf16_f32 v75, v94, v95
    v_mul_f32 v96, v96, v46
    v_mul_f32 v97, v97, v46
    v_mul_f32 v98, v98, v46
    v_mul_f32 v99, v99, v46
    v_cvt_pk_bf16_f32 v76, v96, v97
    v_cvt_pk_bf16_f32 v77, v98, v99
    v_mul_f32 v100, v100, v46
    v_mul_f32 v101, v101, v46
    v_mul_f32 v102, v102, v46
    v_mul_f32 v103, v103, v46
    v_cvt_pk_bf16_f32 v78, v100, v101
    v_cvt_pk_bf16_f32 v79, v102, v103
    v_mul_f32 v104, v104, v46
    v_mul_f32 v105, v105, v46
    v_mul_f32 v106, v106, v46
    v_mul_f32 v107, v107, v46
    v_cvt_pk_bf16_f32 v80, v104, v105
    v_cvt_pk_bf16_f32 v81, v106, v107
    v_mul_f32 v108, v108, v46
    v_mul_f32 v109, v109, v46
    v_mul_f32 v110, v110, v46
    v_mul_f32 v111, v111, v46
    v_cvt_pk_bf16_f32 v82, v108, v109
    v_cvt_pk_bf16_f32 v83, v110, v111
    v_mul_f32 v112, v112, v46
    v_mul_f32 v113, v113, v46
    v_mul_f32 v114, v114, v46
    v_mul_f32 v115, v115, v46
    v_cvt_pk_bf16_f32 v84, v112, v113
    v_cvt_pk_bf16_f32 v85, v114, v115
    v_mul_f32 v116, v116, v46
    v_mul_f32 v117, v117, v46
    v_mul_f32 v118, v118, v46
    v_mul_f32 v119, v119, v46
    v_cvt_pk_bf16_f32 v86, v116, v117
    v_cvt_pk_bf16_f32 v87, v118, v119
    v_mul_f32 v120, v120, v46
    v_mul_f32 v121, v121, v46
    v_mul_f32 v122, v122, v46
    v_mul_f32 v123, v123, v46
    v_cvt_pk_bf16_f32 v88, v120, v121
    v_cvt_pk_bf16_f32 v89, v122, v123
    v_mov_b32 v48, 0
    v_mov_b32 v49, 0
    v_mov_b32 v50, 0
    v_mov_b32 v51, 0
    v_mov_b32 v52, 0
    v_mov_b32 v53, 0
    v_mov_b32 v54, 0
    v_mov_b32 v55, 0
    ds_read_b64_tr_b16 v[24:25], v21 offset:0
    ds_read_b64_tr_b16 v[26:27], v21 offset:1024
    ds_read_b64_tr_b16 v[28:29], v21 offset:32
    ds_read_b64_tr_b16 v[30:31], v21 offset:1056
    ds_read_b64_tr_b16 v[32:33], v21 offset:2048
    ds_read_b64_tr_b16 v[34:35], v21 offset:3072
    ds_read_b64_tr_b16 v[36:37], v21 offset:2080
    ds_read_b64_tr_b16 v[38:39], v21 offset:3104
    s_waitcnt lgkmcnt(4)
    v_mfma_f32_16x16x32_bf16 v[48:51], v[24:27], v[56:59], v[48:51]
    v_mfma_f32_16x16x32_bf16 v[52:55], v[28:31], v[56:59], v[52:55]
    ds_read_b64_tr_b16 v[24:25], v21 offset:4096
    ds_read_b64_tr_b16 v[26:27], v21 offset:5120
    ds_read_b64_tr_b16 v[28:29], v21 offset:4128
    ds_read_b64_tr_b16 v[30:31], v21 offset:5152
    s_waitcnt lgkmcnt(4)
    v_mfma_f32_16x16x32_bf16 v[48:51], v[32:35], v[60:63], v[48:51]
    v_mfma_f32_16x16x32_bf16 v[52:55], v[36:39], v[60:63], v[52:55]
    ds_read_b64_tr_b16 v[32:33], v21 offset:6144
    ds_read_b64_tr_b16 v[34:35], v21 offset:7168
    ds_read_b64_tr_b16 v[36:37], v21 offset:6176
    ds_read_b64_tr_b16 v[38:39], v21 offset:7200
    s_waitcnt lgkmcnt(4)
    v_mfma_f32_16x16x32_bf16 v[48:51], v[24:27], v[64:67], v[48:51]
    v_mfma_f32_16x16x32_bf16 v[52:55], v[28:31], v[64:67], v[52:55]
    ds_read_b64_tr_b16 v[24:25], v21 offset:8192
    ds_read_b64_tr_b16 v[26:27], v21 offset:9216
    ds_read_b64_tr_b16 v[28:29], v21 offset:8224
    ds_read_b64_tr_b16 v[30:31], v21 offset:9248
    s_waitcnt lgkmcnt(4)
    v_mfma_f32_16x16x32_bf16 v[48:51], v[32:35], v[68:71], v[48:51]
    v_mfma_f32_16x16x32_bf16 v[52:55], v[36:39], v[68:71], v[52:55]
    ds_read_b64_tr_b16 v[32:33], v21 offset:10240
    ds_read_b64_tr_b16 v[34:35], v21 offset:11264
    ds_read_b64_tr_b16 v[36:37], v21 offset:10272
    ds_read_b64_tr_b16 v[38:39], v21 offset:11296
    s_waitcnt lgkmcnt(4)
    v_mfma_f32_16x16x32_bf16 v[48:51], v[24:27], v[72:75], v[48:51]
    v_mfma_f32_16x16x32_bf16 v[52:55], v[28:31], v[72:75], v[52:55]
    ds_read_b64_tr_b16 v[24:25], v21 offset:12288
    ds_read_b64_tr_b16 v[26:27], v21 offset:13312
    ds_read_b64_tr_b16 v[28:29], v21 offset:12320
    ds_read_b64_tr_b16 v[30:31], v21 offset:13344
    s_waitcnt lgkmcnt(4)
    v_mfma_f32_16x16x32_bf16 v[48:51], v[32:35], v[76:79], v[48:51]
    v_mfma_f32_16x16x32_bf16 v[52:55], v[36:39], v[76:79], v[52:55]
    ds_read_b64_tr_b16 v[32:33], v21 offset:14336
    ds_read_b64_tr_b16 v[34:35], v21 offset:15360
    ds_read_b64_tr_b16 v[36:37], v21 offset:14368
    ds_read_b64_tr_b16 v[38:39], v21 offset:15392
    s_waitcnt lgkmcnt(4)
    v_mfma_f32_16x16x32_bf16 v[48:51], v[24:27], v[80:83], v[48:51]
    v_mfma_f32_16x16x32_bf16 v[52:55], v[28:31], v[80:83], v[52:55]
    s_waitcnt lgkmcnt(0)
    v_mfma_f32_16x16x32_bf16 v[48:51], v[32:35], v[84:87], v[48:51]
    v_mfma_f32_16x16x32_bf16 v[52:55], v[36:39], v[84:87], v[52:55]
    ds_read_b64_tr_b16 v[24:25], v21 offset:16384
    ds_read_b64_tr_b16 v[26:27], v21 offset:16416
    s_waitcnt lgkmcnt(0)
    v_mfma_f32_16x16x16_bf16 v[48:51], v[24:25], v[88:89], v[48:51]
    v_mfma_f32_16x16x16_bf16 v[52:55], v[26:27], v[88:89], v[52:55]
    s_nop 15
    s_mov_b32 s29, 9216
    v_mul_lo_u32 v16, v15, s29
    v_lshlrev_b32 v18, 3, v17
    v_add_u32 v16, v16, v18
    v_add_u32 v16, s30, v16
    v_cvt_pk_bf16_f32 v12, v48, v49
    v_cvt_pk_bf16_f32 v13, v50, v51
    buffer_store_dwordx2 v[12:13], v16, s[8:11], 0 offen offset:0
    s_nop 0
    v_cvt_pk_bf16_f32 v12, v52, v53
    v_cvt_pk_bf16_f32 v13, v54, v55
    buffer_store_dwordx2 v[12:13], v16, s[8:11], 0 offen offset:32
    s_nop 0
    s_branch AT_done
AT_pf:
    s_sub_u32 s3, s2, 1024
    s_cmp_ge_u32 s3, 72
    s_cbranch_scc1 AT_done
    s_mov_b32 s4, 16
    s_mov_b32 s5, 0
    s_cmp_ge_u32 s3, 16
    s_cselect_b32 s4, 48, s4
    s_cselect_b32 s5, 16, s5
    s_sub_u32 s3, s3, s5
    s_load_dwordx2 s[6:7], s[0:1], s4
    s_lshl_b32 s3, s3, 17
    s_waitcnt lgkmcnt(0)
    s_mov_b32 s8, s6
    s_mov_b32 s9, s7
    s_mov_b32 s10, 7340032
    s_mov_b32 s11, 0x00020000
    v_lshlrev_b32 v1, 4, v0
    v_add_u32 v1, s3, v1
    buffer_load_dwordx4 v[4:7], v1, s[8:11], 0 offen
    v_add_u32 v1, 4096, v1
    buffer_load_dwordx4 v[8:11], v1, s[8:11], 0 offen
    v_add_u32 v1, 4096, v1
    buffer_load_dwordx4 v[12:15], v1, s[8:11], 0 offen
    v_add_u32 v1, 4096, v1
    buffer_load_dwordx4 v[16:19], v1, s[8:11], 0 offen
    v_add_u32 v1, 4096, v1
    buffer_load_dwordx4 v[4:7], v1, s[8:11], 0 offen
    v_add_u32 v1, 4096, v1
    buffer_load_dwordx4 v[8:11], v1, s[8:11], 0 offen
    v_add_u32 v1, 4096, v1
    buffer_load_dwordx4 v[12:15], v1, s[8:11], 0 offen
    v_add_u32 v1, 4096, v1
    buffer_load_dwordx4 v[16:19], v1, s[8:11], 0 offen
    v_add_u32 v1, 4096, v1
    buffer_load_dwordx4 v[4:7], v1, s[8:11], 0 offen
    v_add_u32 v1, 4096, v1
    buffer_load_dwordx4 v[8:11], v1, s[8:11], 0 offen
    v_add_u32 v1, 4096, v1
    buffer_load_dwordx4 v[12:15], v1, s[8:11], 0 offen
    v_add_u32 v1, 4096, v1
    buffer_load_dwordx4 v[16:19], v1, s[8:11], 0 offen
    v_add_u32 v1, 4096, v1
    buffer_load_dwordx4 v[4:7], v1, s[8:11], 0 offen
    v_add_u32 v1, 4096, v1
    buffer_load_dwordx4 v[8:11], v1, s[8:11], 0 offen
    v_add_u32 v1, 4096, v1
    buffer_load_dwordx4 v[12:15], v1, s[8:11], 0 offen
    v_add_u32 v1, 4096, v1
    buffer_load_dwordx4 v[16:19], v1, s[8:11], 0 offen
    v_add_u32 v1, 4096, v1
    buffer_load_dwordx4 v[4:7], v1, s[8:11], 0 offen
    v_add_u32 v1, 4096, v1
    buffer_load_dwordx4 v[8:11], v1, s[8:11], 0 offen
    v_add_u32 v1, 4096, v1
    buffer_load_dwordx4 v[12:15], v1, s[8:11], 0 offen
    v_add_u32 v1, 4096, v1
    buffer_load_dwordx4 v[16:19], v1, s[8:11], 0 offen
    v_add_u32 v1, 4096, v1
    buffer_load_dwordx4 v[4:7], v1, s[8:11], 0 offen
    v_add_u32 v1, 4096, v1
    buffer_load_dwordx4 v[8:11], v1, s[8:11], 0 offen
    v_add_u32 v1, 4096, v1
    buffer_load_dwordx4 v[12:15], v1, s[8:11], 0 offen
    v_add_u32 v1, 4096, v1
    buffer_load_dwordx4 v[16:19], v1, s[8:11], 0 offen
    v_add_u32 v1, 4096, v1
    buffer_load_dwordx4 v[4:7], v1, s[8:11], 0 offen
    v_add_u32 v1, 4096, v1
    buffer_load_dwordx4 v[8:11], v1, s[8:11], 0 offen
    v_add_u32 v1, 4096, v1
    buffer_load_dwordx4 v[12:15], v1, s[8:11], 0 offen
    v_add_u32 v1, 4096, v1
    buffer_load_dwordx4 v[16:19], v1, s[8:11], 0 offen
    v_add_u32 v1, 4096, v1
    buffer_load_dwordx4 v[4:7], v1, s[8:11], 0 offen
    v_add_u32 v1, 4096, v1
    buffer_load_dwordx4 v[8:11], v1, s[8:11], 0 offen
    v_add_u32 v1, 4096, v1
    buffer_load_dwordx4 v[12:15], v1, s[8:11], 0 offen
    v_add_u32 v1, 4096, v1
    buffer_load_dwordx4 v[16:19], v1, s[8:11], 0 offen
    s_waitcnt vmcnt(0)
AT_done:
    s_endpgm
.globl gemm2_kernel
.p2align 8
.type gemm2_kernel,@function
gemm2_kernel:
    s_cmp_ge_u32 s2, 256
    s_cbranch_scc1 G2_done
    s_load_dwordx2 s[16:17], s[0:1], 16
    s_load_dwordx2 s[18:19], s[0:1], 48
    s_load_dwordx2 s[20:21], s[0:1], 0
    s_load_dwordx2 s[22:23], s[0:1], 72
    s_load_dwordx2 s[48:49], s[0:1], 56
    v_lshrrev_b32 v1, 6, v0
    v_and_b32 v0, 63, v0
    s_nop 0
    v_readfirstlane_b32 s24, v1
    s_and_b32 s25, s2, 7
    s_lshr_b32 s26, s2, 3
    s_and_b32 s27, s26, 1
    s_lshl_b32 s29, s25, 1
    s_add_u32 s27, s27, s29
    s_lshr_b32 s28, s26, 1
    s_lshr_b32 s30, s24, 1
    s_and_b32 s31, s24, 1
    s_waitcnt lgkmcnt(0)
    s_add_u32 s4, s22, 16777216
    s_addc_u32 s5, s23, 0
    s_mov_b32 s6, 18874368
    s_mov_b32 s7, 0x00020000
    s_mov_b32 s8, s16
    s_mov_b32 s9, s17
    s_mov_b32 s10, 2097152
    s_mov_b32 s11, 0x00020000
    s_mov_b32 s12, s48
    s_mov_b32 s13, s49
    s_mov_b32 s14, 4194304
    s_mov_b32 s15, 0x00020000
    s_mov_b32 s44, s20
    s_mov_b32 s45, s21
    s_mov_b32 s46, 4194304
    s_mov_b32 s47, 0x00020000
    v_lshrrev_b32 v10, 3, v0
    v_and_b32 v11, 7, v0
    v_lshrrev_b32 v12, 4, v0
    s_lshl_b32 s34, s27, 7
    s_lshl_b32 s35, s24, 5
    s_add_u32 s34, s34, s35
    v_add_u32 v13, s34, v10
    s_mov_b32 s36, 9216
    v_mul_lo_u32 v13, v13, s36
    v_xor_b32 v14, v11, v12
    v_lshlrev_b32 v14, 4, v14
    v_xor_b32 v15, 4, v11
    v_xor_b32 v15, v15, v12
    v_lshlrev_b32 v15, 4, v15
    v_add_u32 v2, v13, v14
    v_add_u32 v3, v13, v15
    v_add_u32 v3, 73728, v3
    v_add_u32 v4, 147456, v2
    v_add_u32 v5, 147456, v3
    s_lshl_b32 s35, s24, 4
    v_add_u32 v13, s35, v10
    v_lshlrev_b32 v13, 11, v13
    v_and_b32 v14, 1, v12
    v_lshlrev_b32 v14, 2, v14
    v_xor_b32 v14, v14, v11
    v_lshlrev_b32 v14, 4, v14
    v_add_u32 v13, v13, v14
    s_lshl_b32 s33, s28, 7
    v_add_u32 v6, s33, v13
    v_add_u32 v7, 0x4000, v6
    s_lshl_b32 s38, s24, 12
    s_lshl_b32 s39, s24, 11
    v_and_b32 v10, 31, v0
    s_lshl_b32 s35, s30, 6
    v_add_u32 v10, s35, v10
    v_lshrrev_b32 v11, 1, v10
    v_and_b32 v11, 7, v11
    v_lshrrev_b32 v12, 5, v0
    v_lshlrev_b32 v10, 7, v10
    s_lshl_b32 s35, s31, 2
    v_add_u32 v13, 0, v12
    v_add_u32 v13, s35, v13
    v_xor_b32 v13, v13, v11
    v_lshlrev_b32 v13, 4, v13
    v_add_u32 v16, v10, v13
    v_add_u32 v13, 2, v12
    v_add_u32 v13, s35, v13
    v_xor_b32 v13, v13, v11
    v_lshlrev_b32 v13, 4, v13
    v_add_u32 v17, v10, v13
    v_lshrrev_b32 v10, 4, v0
    v_and_b32 v11, 15, v0
    v_lshrrev_b32 v12, 1, v10
    v_lshlrev_b32 v12, 3, v12
    v_lshrrev_b32 v13, 2, v11
    v_add_u32 v12, v12, v13
    v_lshlrev_b32 v12, 7, v12
    v_and_b32 v13, 1, v10
    v_lshlrev_b32 v13, 1, v13
    v_bfe_u32 v14, v11, 1, 1
    v_add_u32 v13, v13, v14
    v_bfe_u32 v14, v11, 3, 1
    v_lshlrev_b32 v14, 2, v14
    v_and_b32 v15, 1, v11
    v_lshlrev_b32 v15, 3, v15
    v_add_u32 v12, v12, v15
    s_lshl_b32 s35, s31, 12
    v_add_u32 v12, s35, v12
    v_add_u32 v12, 16384, v12
    v_add_u32 v15, 0, v13
    v_xor_b32 v15, v15, v14
    v_lshlrev_b32 v15, 4, v15
    v_add_u32 v20, v12, v15
    v_add_u32 v15, 4, v13
    v_xor_b32 v15, v15, v14
    v_lshlrev_b32 v15, 4, v15
    v_add_u32 v21, v12, v15
    v_add_u32 v18, 49152, v16
    v_add_u32 v19, 49152, v17
    v_add_u32 v22, 49152, v20
    v_add_u32 v23, 49152, v21
    v_mov_b32 v64, 0
    v_mov_b32 v65, 0
    v_mov_b32 v66, 0
    v_mov_b32 v67, 0
    v_mov_b32 v68, 0
    v_mov_b32 v69, 0
    v_mov_b32 v70, 0
    v_mov_b32 v71, 0
    v_mov_b32 v72, 0
    v_mov_b32 v73, 0
    v_mov_b32 v74, 0
    v_mov_b32 v75, 0
    v_mov_b32 v76, 0
    v_mov_b32 v77, 0
    v_mov_b32 v78, 0
    v_mov_b32 v79, 0
    v_mov_b32 v80, 0
    v_mov_b32 v81, 0
    v_mov_b32 v82, 0
    v_mov_b32 v83, 0
    v_mov_b32 v84, 0
    v_mov_b32 v85, 0
    v_mov_b32 v86, 0
    v_mov_b32 v87, 0
    v_mov_b32 v88, 0
    v_mov_b32 v89, 0
    v_mov_b32 v90, 0
    v_mov_b32 v91, 0
    v_mov_b32 v92, 0
    v_mov_b32 v93, 0
    v_mov_b32 v94, 0
    v_mov_b32 v95, 0
    v_mov_b32 v96, 0
    v_mov_b32 v97, 0
    v_mov_b32 v98, 0
    v_mov_b32 v99, 0
    v_mov_b32 v100, 0
    v_mov_b32 v101, 0
    v_mov_b32 v102, 0
    v_mov_b32 v103, 0
    v_mov_b32 v104, 0
    v_mov_b32 v105, 0
    v_mov_b32 v106, 0
    v_mov_b32 v107, 0
    v_mov_b32 v108, 0
    v_mov_b32 v109, 0
    v_mov_b32 v110, 0
    v_mov_b32 v111, 0
    v_mov_b32 v112, 0
    v_mov_b32 v113, 0
    v_mov_b32 v114, 0
    v_mov_b32 v115, 0
    v_mov_b32 v116, 0
    v_mov_b32 v117, 0
    v_mov_b32 v118, 0
    v_mov_b32 v119, 0
    v_mov_b32 v120, 0
    v_mov_b32 v121, 0
    v_mov_b32 v122, 0
    v_mov_b32 v123, 0
    v_mov_b32 v124, 0
    v_mov_b32 v125, 0
    v_mov_b32 v126, 0
    v_mov_b32 v127, 0
    s_mov_b32 s40, 0
    s_mov_b32 s41, 0
    s_mov_b32 s43, 0
    s_cmp_eq_u32 s43, 16
    s_cselect_b32 s8, s18, s8
    s_cselect_b32 s9, s19, s9
    s_cselect_b32 s10, 7340032, s10
    s_cselect_b32 s41, 0, s41
    s_add_u32 m0, s38, 0
    s_nop 0
    buffer_load_dwordx4 v2, s[4:7], s40 offen lds
    s_add_u32 m0, s38, 1024
    s_nop 0
    buffer_load_dwordx4 v3, s[4:7], s40 offen lds
    s_add_u32 m0, s38, 2048
    s_nop 0
    buffer_load_dwordx4 v4, s[4:7], s40 offen lds
    s_add_u32 m0, s38, 3072
    s_nop 0
    buffer_load_dwordx4 v5, s[4:7], s40 offen lds
    s_add_u32 m0, s39, 16384
    s_nop 0
    buffer_load_dwordx4 v6, s[8:11], s41 offen lds
    s_add_u32 m0, s39, 17408
    s_nop 0
    buffer_load_dwordx4 v7, s[8:11], s41 offen lds
    s_add_u32 s40, s40, 128
    s_add_u32 s41, s41, 0x20000
    s_add_u32 s43, s43, 1
    s_cmp_eq_u32 s43, 16
    s_cselect_b32 s8, s18, s8
    s_cselect_b32 s9, s19, s9
    s_cselect_b32 s10, 7340032, s10
    s_cselect_b32 s41, 0, s41
    s_add_u32 m0, s38, 24576
    s_nop 0
    buffer_load_dwordx4 v2, s[4:7], s40 offen lds
    s_add_u32 m0, s38, 25600
    s_nop 0
    buffer_load_dwordx4 v3, s[4:7], s40 offen lds
    s_add_u32 m0, s38, 26624
    s_nop 0
    buffer_load_dwordx4 v4, s[4:7], s40 offen lds
    s_add_u32 m0, s38, 27648
    s_nop 0
    buffer_load_dwordx4 v5, s[4:7], s40 offen lds
    s_add_u32 m0, s39, 40960
    s_nop 0
    buffer_load_dwordx4 v6, s[8:11], s41 offen lds
    s_add_u32 m0, s39, 41984
    s_nop 0
    buffer_load_dwordx4 v7, s[8:11], s41 offen lds
    s_add_u32 s40, s40, 128
    s_add_u32 s41, s41, 0x20000
    s_add_u32 s43, s43, 1
    s_cmp_eq_u32 s43, 16
    s_cselect_b32 s8, s18, s8
    s_cselect_b32 s9, s19, s9
    s_cselect_b32 s10, 7340032, s10
    s_cselect_b32 s41, 0, s41
    s_add_u32 m0, s38, 49152
    s_nop 0
    buffer_load_dwordx4 v2, s[4:7], s40 offen lds
    s_add_u32 m0, s38, 50176
    s_nop 0
    buffer_load_dwordx4 v3, s[4:7], s40 offen lds
    s_add_u32 m0, s38, 51200
    s_nop 0
    buffer_load_dwordx4 v4, s[4:7], s40 offen lds
    s_add_u32 m0, s38, 52224
    s_nop 0
    buffer_load_dwordx4 v5, s[4:7], s40 offen lds
    s_add_u32 m0, s39, 65536
    s_nop 0
    buffer_load_dwordx4 v6, s[8:11], s41 offen lds
    s_add_u32 m0, s39, 66560
    s_nop 0
    buffer_load_dwordx4 v7, s[8:11], s41 offen lds
    s_add_u32 s40, s40, 128
    s_add_u32 s41, s41, 0x20000
    s_add_u32 s43, s43, 1
    s_mov_b32 s42, 0
G2_loop:
    s_waitcnt vmcnt(12)
    s_barrier
    s_cmp_ge_u32 s43, 72
    s_cbranch_scc1 G2_nl0
    ds_read_b128 v[32:35], v16 offset:0
    ds_read_b128 v[36:39], v16 offset:4096
    ds_read_b64_tr_b16 v[40:41], v20 offset:0
    ds_read_b64_tr_b16 v[42:43], v20 offset:512
    ds_read_b64_tr_b16 v[44:45], v21 offset:0
    ds_read_b64_tr_b16 v[46:47], v21 offset:512
    ds_read_b128 v[48:51], v17 offset:0
    ds_read_b128 v[52:55], v17 offset:4096
    ds_read_b64_tr_b16 v[56:57], v20 offset:2048
    ds_read_b64_tr_b16 v[58:59], v20 offset:2560
    ds_read_b64_tr_b16 v[60:61], v21 offset:2048
    ds_read_b64_tr_b16 v[62:63], v21 offset:2560
    s_cmp_eq_u32 s43, 16
    s_cselect_b32 s8, s18, s8
    s_cselect_b32 s9, s19, s9
    s_cselect_b32 s10, 7340032, s10
    s_cselect_b32 s41, 0, s41
    s_add_u32 m0, s38, 73728
    s_nop 0
    buffer_load_dwordx4 v2, s[4:7], s40 offen lds
    s_waitcnt lgkmcnt(6)
    v_mfma_f32_32x32x16_bf16 v[64:79], v[40:43], v[32:35], v[64:79]
    s_add_u32 m0, s38, 74752
    s_nop 0
    buffer_load_dwordx4 v3, s[4:7], s40 offen lds
    v_mfma_f32_32x32x16_bf16 v[80:95], v[40:43], v[36:39], v[80:95]
    s_add_u32 m0, s38, 75776
    s_nop 0
    buffer_load_dwordx4 v4, s[4:7], s40 offen lds
    v_mfma_f32_32x32x16_bf16 v[96:111], v[44:47], v[32:35], v[96:111]
    s_add_u32 m0, s38, 76800
    s_nop 0
    buffer_load_dwordx4 v5, s[4:7], s40 offen lds
    v_mfma_f32_32x32x16_bf16 v[112:127], v[44:47], v[36:39], v[112:127]
    s_add_u32 m0, s39, 90112
    s_nop 0
    buffer_load_dwordx4 v6, s[8:11], s41 offen lds
    s_waitcnt lgkmcnt(0)
    v_mfma_f32_32x32x16_bf16 v[64:79], v[56:59], v[48:51], v[64:79]
    s_add_u32 m0, s39, 91136
    s_nop 0
    buffer_load_dwordx4 v7, s[8:11], s41 offen lds
    s_add_u32 s40, s40, 128
    s_add_u32 s41, s41, 0x20000
    s_add_u32 s43, s43, 1
    v_mfma_f32_32x32x16_bf16 v[80:95], v[56:59], v[52:55], v[80:95]
    v_mfma_f32_32x32x16_bf16 v[96:111], v[60:63], v[48:51], v[96:111]
    v_mfma_f32_32x32x16_bf16 v[112:127], v[60:63], v[52:55], v[112:127]
    s_branch G2_e0
    s_branch G2_c0
G2_nl0:
    s_waitcnt vmcnt(0)
    s_barrier
G2_c0:
    ds_read_b128 v[32:35], v16 offset:0
    ds_read_b128 v[36:39], v16 offset:4096
    ds_read_b64_tr_b16 v[40:41], v20 offset:0
    ds_read_b64_tr_b16 v[42:43], v20 offset:512
    ds_read_b64_tr_b16 v[44:45], v21 offset:0
    ds_read_b64_tr_b16 v[46:47], v21 offset:512
    ds_read_b128 v[48:51], v17 offset:0
    ds_read_b128 v[52:55], v17 offset:4096
    ds_read_b64_tr_b16 v[56:57], v20 offset:2048
    ds_read_b64_tr_b16 v[58:59], v20 offset:2560
    ds_read_b64_tr_b16 v[60:61], v21 offset:2048
    ds_read_b64_tr_b16 v[62:63], v21 offset:2560
    s_waitcnt lgkmcnt(6)
    v_mfma_f32_32x32x16_bf16 v[64:79], v[40:43], v[32:35], v[64:79]
    v_mfma_f32_32x32x16_bf16 v[80:95], v[40:43], v[36:39], v[80:95]
    v_mfma_f32_32x32x16_bf16 v[96:111], v[44:47], v[32:35], v[96:111]
    v_mfma_f32_32x32x16_bf16 v[112:127], v[44:47], v[36:39], v[112:127]
    s_waitcnt lgkmcnt(0)
    v_mfma_f32_32x32x16_bf16 v[64:79], v[56:59], v[48:51], v[64:79]
    v_mfma_f32_32x32x16_bf16 v[80:95], v[56:59], v[52:55], v[80:95]
    v_mfma_f32_32x32x16_bf16 v[96:111], v[60:63], v[48:51], v[96:111]
    v_mfma_f32_32x32x16_bf16 v[112:127], v[60:63], v[52:55], v[112:127]
G2_e0:
    s_waitcnt vmcnt(12)
    s_barrier
    s_cmp_ge_u32 s43, 72
    s_cbranch_scc1 G2_nl1
    ds_read_b128 v[32:35], v16 offset:24576
    ds_read_b128 v[36:39], v16 offset:28672
    ds_read_b64_tr_b16 v[40:41], v20 offset:24576
    ds_read_b64_tr_b16 v[42:43], v20 offset:25088
    ds_read_b64_tr_b16 v[44:45], v21 offset:24576
    ds_read_b64_tr_b16 v[46:47], v21 offset:25088
    ds_read_b128 v[48:51], v17 offset:24576
    ds_read_b128 v[52:55], v17 offset:28672
    ds_read_b64_tr_b16 v[56:57], v20 offset:26624
    ds_read_b64_tr_b16 v[58:59], v20 offset:27136
    ds_read_b64_tr_b16 v[60:61], v21 offset:26624
    ds_read_b64_tr_b16 v[62:63], v21 offset:27136
    s_cmp_eq_u32 s43, 16
    s_cselect_b32 s8, s18, s8
    s_cselect_b32 s9, s19, s9
    s_cselect_b32 s10, 7340032, s10
    s_cselect_b32 s41, 0, s41
    s_add_u32 m0, s38, 0
    s_nop 0
    buffer_load_dwordx4 v2, s[4:7], s40 offen lds
    s_waitcnt lgkmcnt(6)
    v_mfma_f32_32x32x16_bf16 v[64:79], v[40:43], v[32:35], v[64:79]
    s_add_u32 m0, s38, 1024
    s_nop 0
    buffer_load_dwordx4 v3, s[4:7], s40 offen lds
    v_mfma_f32_32x32x16_bf16 v[80:95], v[40:43], v[36:39], v[80:95]
    s_add_u32 m0, s38, 2048
    s_nop 0
    buffer_load_dwordx4 v4, s[4:7], s40 offen lds
    v_mfma_f32_32x32x16_bf16 v[96:111], v[44:47], v[32:35], v[96:111]
    s_add_u32 m0, s38, 3072
    s_nop 0
    buffer_load_dwordx4 v5, s[4:7], s40 offen lds
    v_mfma_f32_32x32x16_bf16 v[112:127], v[44:47], v[36:39], v[112:127]
    s_add_u32 m0, s39, 16384
    s_nop 0
    buffer_load_dwordx4 v6, s[8:11], s41 offen lds
    s_waitcnt lgkmcnt(0)
    v_mfma_f32_32x32x16_bf16 v[64:79], v[56:59], v[48:51], v[64:79]
    s_add_u32 m0, s39, 17408
    s_nop 0
    buffer_load_dwordx4 v7, s[8:11], s41 offen lds
    s_add_u32 s40, s40, 128
    s_add_u32 s41, s41, 0x20000
    s_add_u32 s43, s43, 1
    v_mfma_f32_32x32x16_bf16 v[80:95], v[56:59], v[52:55], v[80:95]
    v_mfma_f32_32x32x16_bf16 v[96:111], v[60:63], v[48:51], v[96:111]
    v_mfma_f32_32x32x16_bf16 v[112:127], v[60:63], v[52:55], v[112:127]
    s_branch G2_e1
    s_branch G2_c1
G2_nl1:
    s_waitcnt vmcnt(0)
    s_barrier
G2_c1:
    ds_read_b128 v[32:35], v16 offset:24576
    ds_read_b128 v[36:39], v16 offset:28672
    ds_read_b64_tr_b16 v[40:41], v20 offset:24576
    ds_read_b64_tr_b16 v[42:43], v20 offset:25088
    ds_read_b64_tr_b16 v[44:45], v21 offset:24576
    ds_read_b64_tr_b16 v[46:47], v21 offset:25088
    ds_read_b128 v[48:51], v17 offset:24576
    ds_read_b128 v[52:55], v17 offset:28672
    ds_read_b64_tr_b16 v[56:57], v20 offset:26624
    ds_read_b64_tr_b16 v[58:59], v20 offset:27136
    ds_read_b64_tr_b16 v[60:61], v21 offset:26624
    ds_read_b64_tr_b16 v[62:63], v21 offset:27136
    s_waitcnt lgkmcnt(6)
    v_mfma_f32_32x32x16_bf16 v[64:79], v[40:43], v[32:35], v[64:79]
    v_mfma_f32_32x32x16_bf16 v[80:95], v[40:43], v[36:39], v[80:95]
    v_mfma_f32_32x32x16_bf16 v[96:111], v[44:47], v[32:35], v[96:111]
    v_mfma_f32_32x32x16_bf16 v[112:127], v[44:47], v[36:39], v[112:127]
    s_waitcnt lgkmcnt(0)
    v_mfma_f32_32x32x16_bf16 v[64:79], v[56:59], v[48:51], v[64:79]
    v_mfma_f32_32x32x16_bf16 v[80:95], v[56:59], v[52:55], v[80:95]
    v_mfma_f32_32x32x16_bf16 v[96:111], v[60:63], v[48:51], v[96:111]
    v_mfma_f32_32x32x16_bf16 v[112:127], v[60:63], v[52:55], v[112:127]
G2_e1:
    s_waitcnt vmcnt(12)
    s_barrier
    s_cmp_ge_u32 s43, 72
    s_cbranch_scc1 G2_nl2
    ds_read_b128 v[32:35], v18 offset:0
    ds_read_b128 v[36:39], v18 offset:4096
    ds_read_b64_tr_b16 v[40:41], v22 offset:0
    ds_read_b64_tr_b16 v[42:43], v22 offset:512
    ds_read_b64_tr_b16 v[44:45], v23 offset:0
    ds_read_b64_tr_b16 v[46:47], v23 offset:512
    ds_read_b128 v[48:51], v19 offset:0
    ds_read_b128 v[52:55], v19 offset:4096
    ds_read_b64_tr_b16 v[56:57], v22 offset:2048
    ds_read_b64_tr_b16 v[58:59], v22 offset:2560
    ds_read_b64_tr_b16 v[60:61], v23 offset:2048
    ds_read_b64_tr_b16 v[62:63], v23 offset:2560
    s_cmp_eq_u32 s43, 16
    s_cselect_b32 s8, s18, s8
    s_cselect_b32 s9, s19, s9
    s_cselect_b32 s10, 7340032, s10
    s_cselect_b32 s41, 0, s41
    s_add_u32 m0, s38, 24576
    s_nop 0
    buffer_load_dwordx4 v2, s[4:7], s40 offen lds
    s_waitcnt lgkmcnt(6)
    v_mfma_f32_32x32x16_bf16 v[64:79], v[40:43], v[32:35], v[64:79]
    s_add_u32 m0, s38, 25600
    s_nop 0
    buffer_load_dwordx4 v3, s[4:7], s40 offen lds
    v_mfma_f32_32x32x16_bf16 v[80:95], v[40:43], v[36:39], v[80:95]
    s_add_u32 m0, s38, 26624
    s_nop 0
    buffer_load_dwordx4 v4, s[4:7], s40 offen lds
    v_mfma_f32_32x32x16_bf16 v[96:111], v[44:47], v[32:35], v[96:111]
    s_add_u32 m0, s38, 27648
    s_nop 0
    buffer_load_dwordx4 v5, s[4:7], s40 offen lds
    v_mfma_f32_32x32x16_bf16 v[112:127], v[44:47], v[36:39], v[112:127]
    s_add_u32 m0, s39, 40960
    s_nop 0
    buffer_load_dwordx4 v6, s[8:11], s41 offen lds
    s_waitcnt lgkmcnt(0)
    v_mfma_f32_32x32x16_bf16 v[64:79], v[56:59], v[48:51], v[64:79]
    s_add_u32 m0, s39, 41984
    s_nop 0
    buffer_load_dwordx4 v7, s[8:11], s41 offen lds
    s_add_u32 s40, s40, 128
    s_add_u32 s41, s41, 0x20000
    s_add_u32 s43, s43, 1
    v_mfma_f32_32x32x16_bf16 v[80:95], v[56:59], v[52:55], v[80:95]
    v_mfma_f32_32x32x16_bf16 v[96:111], v[60:63], v[48:51], v[96:111]
    v_mfma_f32_32x32x16_bf16 v[112:127], v[60:63], v[52:55], v[112:127]
    s_branch G2_e2
    s_branch G2_c2
G2_nl2:
    s_waitcnt vmcnt(0)
    s_barrier
G2_c2:
    ds_read_b128 v[32:35], v18 offset:0
    ds_read_b128 v[36:39], v18 offset:4096
    ds_read_b64_tr_b16 v[40:41], v22 offset:0
    ds_read_b64_tr_b16 v[42:43], v22 offset:512
    ds_read_b64_tr_b16 v[44:45], v23 offset:0
    ds_read_b64_tr_b16 v[46:47], v23 offset:512
    ds_read_b128 v[48:51], v19 offset:0
    ds_read_b128 v[52:55], v19 offset:4096
    ds_read_b64_tr_b16 v[56:57], v22 offset:2048
    ds_read_b64_tr_b16 v[58:59], v22 offset:2560
    ds_read_b64_tr_b16 v[60:61], v23 offset:2048
    ds_read_b64_tr_b16 v[62:63], v23 offset:2560
    s_waitcnt lgkmcnt(6)
    v_mfma_f32_32x32x16_bf16 v[64:79], v[40:43], v[32:35], v[64:79]
    v_mfma_f32_32x32x16_bf16 v[80:95], v[40:43], v[36:39], v[80:95]
    v_mfma_f32_32x32x16_bf16 v[96:111], v[44:47], v[32:35], v[96:111]
    v_mfma_f32_32x32x16_bf16 v[112:127], v[44:47], v[36:39], v[112:127]
    s_waitcnt lgkmcnt(0)
    v_mfma_f32_32x32x16_bf16 v[64:79], v[56:59], v[48:51], v[64:79]
    v_mfma_f32_32x32x16_bf16 v[80:95], v[56:59], v[52:55], v[80:95]
    v_mfma_f32_32x32x16_bf16 v[96:111], v[60:63], v[48:51], v[96:111]
    v_mfma_f32_32x32x16_bf16 v[112:127], v[60:63], v[52:55], v[112:127]
G2_e2:
    s_waitcnt vmcnt(12)
    s_barrier
    s_cmp_ge_u32 s43, 72
    s_cbranch_scc1 G2_nl3
    ds_read_b128 v[32:35], v18 offset:24576
    ds_read_b128 v[36:39], v18 offset:28672
    ds_read_b64_tr_b16 v[40:41], v22 offset:24576
    ds_read_b64_tr_b16 v[42:43], v22 offset:25088
    ds_read_b64_tr_b16 v[44:45], v23 offset:24576
    ds_read_b64_tr_b16 v[46:47], v23 offset:25088
    ds_read_b128 v[48:51], v19 offset:24576
    ds_read_b128 v[52:55], v19 offset:28672
    ds_read_b64_tr_b16 v[56:57], v22 offset:26624
    ds_read_b64_tr_b16 v[58:59], v22 offset:27136
    ds_read_b64_tr_b16 v[60:61], v23 offset:26624
    ds_read_b64_tr_b16 v[62:63], v23 offset:27136
    s_cmp_eq_u32 s43, 16
    s_cselect_b32 s8, s18, s8
    s_cselect_b32 s9, s19, s9
    s_cselect_b32 s10, 7340032, s10
    s_cselect_b32 s41, 0, s41
    s_add_u32 m0, s38, 49152
    s_nop 0
    buffer_load_dwordx4 v2, s[4:7], s40 offen lds
    s_waitcnt lgkmcnt(6)
    v_mfma_f32_32x32x16_bf16 v[64:79], v[40:43], v[32:35], v[64:79]
    s_add_u32 m0, s38, 50176
    s_nop 0
    buffer_load_dwordx4 v3, s[4:7], s40 offen lds
    v_mfma_f32_32x32x16_bf16 v[80:95], v[40:43], v[36:39], v[80:95]
    s_add_u32 m0, s38, 51200
    s_nop 0
    buffer_load_dwordx4 v4, s[4:7], s40 offen lds
    v_mfma_f32_32x32x16_bf16 v[96:111], v[44:47], v[32:35], v[96:111]
    s_add_u32 m0, s38, 52224
    s_nop 0
    buffer_load_dwordx4 v5, s[4:7], s40 offen lds
    v_mfma_f32_32x32x16_bf16 v[112:127], v[44:47], v[36:39], v[112:127]
    s_add_u32 m0, s39, 65536
    s_nop 0
    buffer_load_dwordx4 v6, s[8:11], s41 offen lds
    s_waitcnt lgkmcnt(0)
    v_mfma_f32_32x32x16_bf16 v[64:79], v[56:59], v[48:51], v[64:79]
    s_add_u32 m0, s39, 66560
    s_nop 0
    buffer_load_dwordx4 v7, s[8:11], s41 offen lds
    s_add_u32 s40, s40, 128
    s_add_u32 s41, s41, 0x20000
    s_add_u32 s43, s43, 1
    v_mfma_f32_32x32x16_bf16 v[80:95], v[56:59], v[52:55], v[80:95]
    v_mfma_f32_32x32x16_bf16 v[96:111], v[60:63], v[48:51], v[96:111]
    v_mfma_f32_32x32x16_bf16 v[112:127], v[60:63], v[52:55], v[112:127]
    s_branch G2_e3
    s_branch G2_c3
G2_nl3:
    s_waitcnt vmcnt(0)
    s_barrier
G2_c3:
    ds_read_b128 v[32:35], v18 offset:24576
    ds_read_b128 v[36:39], v18 offset:28672
    ds_read_b64_tr_b16 v[40:41], v22 offset:24576
    ds_read_b64_tr_b16 v[42:43], v22 offset:25088
    ds_read_b64_tr_b16 v[44:45], v23 offset:24576
    ds_read_b64_tr_b16 v[46:47], v23 offset:25088
    ds_read_b128 v[48:51], v19 offset:24576
    ds_read_b128 v[52:55], v19 offset:28672
    ds_read_b64_tr_b16 v[56:57], v22 offset:26624
    ds_read_b64_tr_b16 v[58:59], v22 offset:27136
    ds_read_b64_tr_b16 v[60:61], v23 offset:26624
    ds_read_b64_tr_b16 v[62:63], v23 offset:27136
    s_waitcnt lgkmcnt(6)
    v_mfma_f32_32x32x16_bf16 v[64:79], v[40:43], v[32:35], v[64:79]
    v_mfma_f32_32x32x16_bf16 v[80:95], v[40:43], v[36:39], v[80:95]
    v_mfma_f32_32x32x16_bf16 v[96:111], v[44:47], v[32:35], v[96:111]
    v_mfma_f32_32x32x16_bf16 v[112:127], v[44:47], v[36:39], v[112:127]
    s_waitcnt lgkmcnt(0)
    v_mfma_f32_32x32x16_bf16 v[64:79], v[56:59], v[48:51], v[64:79]
    v_mfma_f32_32x32x16_bf16 v[80:95], v[56:59], v[52:55], v[80:95]
    v_mfma_f32_32x32x16_bf16 v[96:111], v[60:63], v[48:51], v[96:111]
    v_mfma_f32_32x32x16_bf16 v[112:127], v[60:63], v[52:55], v[112:127]
G2_e3:
    s_add_u32 s42, s42, 4
    s_cmp_lt_u32 s42, 72
    s_cbranch_scc1 G2_loop
    s_nop 15
    s_barrier
    v_lshlrev_b32 v10, 2, v0
    s_xor_b32 s35, s24, 1
    s_lshl_b32 s35, s35, 13
    v_add_u32 v10, s35, v10
    v_lshlrev_b32 v11, 2, v0
    s_lshl_b32 s35, s24, 13
    v_add_u32 v11, s35, v11
    s_cmp_eq_u32 s31, 0
    s_cbranch_scc0 G2_x1
    ds_write_b32 v10, v80 offset:0
    ds_write_b32 v10, v81 offset:256
    ds_write_b32 v10, v82 offset:512
    ds_write_b32 v10, v83 offset:768
    ds_write_b32 v10, v84 offset:1024
    ds_write_b32 v10, v85 offset:1280
    ds_write_b32 v10, v86 offset:1536
    ds_write_b32 v10, v87 offset:1792
    ds_write_b32 v10, v88 offset:2048
    ds_write_b32 v10, v89 offset:2304
    ds_write_b32 v10, v90 offset:2560
    ds_write_b32 v10, v91 offset:2816
    ds_write_b32 v10, v92 offset:3072
    ds_write_b32 v10, v93 offset:3328
    ds_write_b32 v10, v94 offset:3584
    ds_write_b32 v10, v95 offset:3840
    ds_write_b32 v10, v112 offset:4096
    ds_write_b32 v10, v113 offset:4352
    ds_write_b32 v10, v114 offset:4608
    ds_write_b32 v10, v115 offset:4864
    ds_write_b32 v10, v116 offset:5120
    ds_write_b32 v10, v117 offset:5376
    ds_write_b32 v10, v118 offset:5632
    ds_write_b32 v10, v119 offset:5888
    ds_write_b32 v10, v120 offset:6144
    ds_write_b32 v10, v121 offset:6400
    ds_write_b32 v10, v122 offset:6656
    ds_write_b32 v10, v123 offset:6912
    ds_write_b32 v10, v124 offset:7168
    ds_write_b32 v10, v125 offset:7424
    ds_write_b32 v10, v126 offset:7680
    ds_write_b32 v10, v127 offset:7936
    s_branch G2_x2
G2_x1:
    ds_write_b32 v10, v64 offset:0
    ds_write_b32 v10, v65 offset:256
    ds_write_b32 v10, v66 offset:512
    ds_write_b32 v10, v67 offset:768
    ds_write_b32 v10, v68 offset:1024
    ds_write_b32 v10, v69 offset:1280
    ds_write_b32 v10, v70 offset:1536
    ds_write_b32 v10, v71 offset:1792
    ds_write_b32 v10, v72 offset:2048
    ds_write_b32 v10, v73 offset:2304
    ds_write_b32 v10, v74 offset:2560
    ds_write_b32 v10, v75 offset:2816
    ds_write_b32 v10, v76 offset:3072
    ds_write_b32 v10, v77 offset:3328
    ds_write_b32 v10, v78 offset:3584
    ds_write_b32 v10, v79 offset:3840
    ds_write_b32 v10, v96 offset:4096
    ds_write_b32 v10, v97 offset:4352
    ds_write_b32 v10, v98 offset:4608
    ds_write_b32 v10, v99 offset:4864
    ds_write_b32 v10, v100 offset:5120
    ds_write_b32 v10, v101 offset:5376
    ds_write_b32 v10, v102 offset:5632
    ds_write_b32 v10, v103 offset:5888
    ds_write_b32 v10, v104 offset:6144
    ds_write_b32 v10, v105 offset:6400
    ds_write_b32 v10, v106 offset:6656
    ds_write_b32 v10, v107 offset:6912
    ds_write_b32 v10, v108 offset:7168
    ds_write_b32 v10, v109 offset:7424
    ds_write_b32 v10, v110 offset:7680
    ds_write_b32 v10, v111 offset:7936
    v_mov_b32 v64, v80
    v_mov_b32 v65, v81
    v_mov_b32 v66, v82
    v_mov_b32 v67, v83
    v_mov_b32 v68, v84
    v_mov_b32 v69, v85
    v_mov_b32 v70, v86
    v_mov_b32 v71, v87
    v_mov_b32 v72, v88
    v_mov_b32 v73, v89
    v_mov_b32 v74, v90
    v_mov_b32 v75, v91
    v_mov_b32 v76, v92
    v_mov_b32 v77, v93
    v_mov_b32 v78, v94
    v_mov_b32 v79, v95
    v_mov_b32 v96, v112
    v_mov_b32 v97, v113
    v_mov_b32 v98, v114
    v_mov_b32 v99, v115
    v_mov_b32 v100, v116
    v_mov_b32 v101, v117
    v_mov_b32 v102, v118
    v_mov_b32 v103, v119
    v_mov_b32 v104, v120
    v_mov_b32 v105, v121
    v_mov_b32 v106, v122
    v_mov_b32 v107, v123
    v_mov_b32 v108, v124
    v_mov_b32 v109, v125
    v_mov_b32 v110, v126
    v_mov_b32 v111, v127
G2_x2:
    s_waitcnt lgkmcnt(0)
    s_barrier
    ds_read_b32 v32, v11 offset:0
    ds_read_b32 v33, v11 offset:256
    ds_read_b32 v34, v11 offset:512
    ds_read_b32 v35, v11 offset:768
    ds_read_b32 v36, v11 offset:1024
    ds_read_b32 v37, v11 offset:1280
    ds_read_b32 v38, v11 offset:1536
    ds_read_b32 v39, v11 offset:1792
    s_waitcnt lgkmcnt(0)
    v_add_f32 v64, v64, v32
    v_add_f32 v65, v65, v33
    v_add_f32 v66, v66, v34
    v_add_f32 v67, v67, v35
    v_add_f32 v68, v68, v36
    v_add_f32 v69, v69, v37
    v_add_f32 v70, v70, v38
    v_add_f32 v71, v71, v39
    ds_read_b32 v32, v11 offset:2048
    ds_read_b32 v33, v11 offset:2304
    ds_read_b32 v34, v11 offset:2560
    ds_read_b32 v35, v11 offset:2816
    ds_read_b32 v36, v11 offset:3072
    ds_read_b32 v37, v11 offset:3328
    ds_read_b32 v38, v11 offset:3584
    ds_read_b32 v39, v11 offset:3840
    s_waitcnt lgkmcnt(0)
    v_add_f32 v72, v72, v32
    v_add_f32 v73, v73, v33
    v_add_f32 v74, v74, v34
    v_add_f32 v75, v75, v35
    v_add_f32 v76, v76, v36
    v_add_f32 v77, v77, v37
    v_add_f32 v78, v78, v38
    v_add_f32 v79, v79, v39
    ds_read_b32 v32, v11 offset:4096
    ds_read_b32 v33, v11 offset:4352
    ds_read_b32 v34, v11 offset:4608
    ds_read_b32 v35, v11 offset:4864
    ds_read_b32 v36, v11 offset:5120
    ds_read_b32 v37, v11 offset:5376
    ds_read_b32 v38, v11 offset:5632
    ds_read_b32 v39, v11 offset:5888
    s_waitcnt lgkmcnt(0)
    v_add_f32 v96, v96, v32
    v_add_f32 v97, v97, v33
    v_add_f32 v98, v98, v34
    v_add_f32 v99, v99, v35
    v_add_f32 v100, v100, v36
    v_add_f32 v101, v101, v37
    v_add_f32 v102, v102, v38
    v_add_f32 v103, v103, v39
    ds_read_b32 v32, v11 offset:6144
    ds_read_b32 v33, v11 offset:6400
    ds_read_b32 v34, v11 offset:6656
    ds_read_b32 v35, v11 offset:6912
    ds_read_b32 v36, v11 offset:7168
    ds_read_b32 v37, v11 offset:7424
    ds_read_b32 v38, v11 offset:7680
    ds_read_b32 v39, v11 offset:7936
    s_waitcnt lgkmcnt(0)
    v_add_f32 v104, v104, v32
    v_add_f32 v105, v105, v33
    v_add_f32 v106, v106, v34
    v_add_f32 v107, v107, v35
    v_add_f32 v108, v108, v36
    v_add_f32 v109, v109, v37
    v_add_f32 v110, v110, v38
    v_add_f32 v111, v111, v39
    v_and_b32 v10, 31, v0
    s_lshl_b32 s34, s27, 7
    s_lshl_b32 s35, s30, 6
    s_add_u32 s34, s34, s35
    s_lshl_b32 s35, s31, 5
    s_add_u32 s34, s34, s35
    v_add_u32 v10, s34, v10
    v_lshlrev_b32 v10, 11, v10
    v_lshrrev_b32 v11, 5, v0
    v_lshlrev_b32 v11, 3, v11
    v_add_u32 v10, v10, v11
    v_add_u32 v10, s33, v10
    buffer_load_dwordx2 v[32:33], v10, s[44:47], 0 offen offset:0
    buffer_load_dwordx2 v[34:35], v10, s[44:47], 0 offen offset:16
    buffer_load_dwordx2 v[36:37], v10, s[44:47], 0 offen offset:32
    buffer_load_dwordx2 v[38:39], v10, s[44:47], 0 offen offset:48
    buffer_load_dwordx2 v[40:41], v10, s[44:47], 0 offen offset:64
    buffer_load_dwordx2 v[42:43], v10, s[44:47], 0 offen offset:80
    buffer_load_dwordx2 v[44:45], v10, s[44:47], 0 offen offset:96
    buffer_load_dwordx2 v[46:47], v10, s[44:47], 0 offen offset:112
    s_waitcnt vmcnt(0)
    v_lshlrev_b32 v12, 16, v32
    v_and_b32 v13, 0xffff0000, v32
    v_lshlrev_b32 v14, 16, v33
    v_and_b32 v15, 0xffff0000, v33
    v_add_f32 v12, v12, v64
    v_add_f32 v13, v13, v65
    v_add_f32 v14, v14, v66
    v_add_f32 v15, v15, v67
    v_cvt_pk_bf16_f32 v12, v12, v13
    v_cvt_pk_bf16_f32 v13, v14, v15
    buffer_store_dwordx2 v[12:13], v10, s[12:15], 0 offen offset:0
    s_nop 0
    v_lshlrev_b32 v12, 16, v34
    v_and_b32 v13, 0xffff0000, v34
    v_lshlrev_b32 v14, 16, v35
    v_and_b32 v15, 0xffff0000, v35
    v_add_f32 v12, v12, v68
    v_add_f32 v13, v13, v69
    v_add_f32 v14, v14, v70
    v_add_f32 v15, v15, v71
    v_cvt_pk_bf16_f32 v12, v12, v13
    v_cvt_pk_bf16_f32 v13, v14, v15
    buffer_store_dwordx2 v[12:13], v10, s[12:15], 0 offen offset:16
    s_nop 0
    v_lshlrev_b32 v12, 16, v36
    v_and_b32 v13, 0xffff0000, v36
    v_lshlrev_b32 v14, 16, v37
    v_and_b32 v15, 0xffff0000, v37
    v_add_f32 v12, v12, v72
    v_add_f32 v13, v13, v73
    v_add_f32 v14, v14, v74
    v_add_f32 v15, v15, v75
    v_cvt_pk_bf16_f32 v12, v12, v13
    v_cvt_pk_bf16_f32 v13, v14, v15
    buffer_store_dwordx2 v[12:13], v10, s[12:15], 0 offen offset:32
    s_nop 0
    v_lshlrev_b32 v12, 16, v38
    v_and_b32 v13, 0xffff0000, v38
    v_lshlrev_b32 v14, 16, v39
    v_and_b32 v15, 0xffff0000, v39
    v_add_f32 v12, v12, v76
    v_add_f32 v13, v13, v77
    v_add_f32 v14, v14, v78
    v_add_f32 v15, v15, v79
    v_cvt_pk_bf16_f32 v12, v12, v13
    v_cvt_pk_bf16_f32 v13, v14, v15
    buffer_store_dwordx2 v[12:13], v10, s[12:15], 0 offen offset:48
    s_nop 0
    v_lshlrev_b32 v12, 16, v40
    v_and_b32 v13, 0xffff0000, v40
    v_lshlrev_b32 v14, 16, v41
    v_and_b32 v15, 0xffff0000, v41
    v_add_f32 v12, v12, v96
    v_add_f32 v13, v13, v97
    v_add_f32 v14, v14, v98
    v_add_f32 v15, v15, v99
    v_cvt_pk_bf16_f32 v12, v12, v13
    v_cvt_pk_bf16_f32 v13, v14, v15
    buffer_store_dwordx2 v[12:13], v10, s[12:15], 0 offen offset:64
    s_nop 0
    v_lshlrev_b32 v12, 16, v42
    v_and_b32 v13, 0xffff0000, v42
    v_lshlrev_b32 v14, 16, v43
    v_and_b32 v15, 0xffff0000, v43
    v_add_f32 v12, v12, v100
    v_add_f32 v13, v13, v101
    v_add_f32 v14, v14, v102
    v_add_f32 v15, v15, v103
    v_cvt_pk_bf16_f32 v12, v12, v13
    v_cvt_pk_bf16_f32 v13, v14, v15
    buffer_store_dwordx2 v[12:13], v10, s[12:15], 0 offen offset:80
    s_nop 0
    v_lshlrev_b32 v12, 16, v44
    v_and_b32 v13, 0xffff0000, v44
    v_lshlrev_b32 v14, 16, v45
    v_and_b32 v15, 0xffff0000, v45
    v_add_f32 v12, v12, v104
    v_add_f32 v13, v13, v105
    v_add_f32 v14, v14, v106
    v_add_f32 v15, v15, v107
    v_cvt_pk_bf16_f32 v12, v12, v13
    v_cvt_pk_bf16_f32 v13, v14, v15
    buffer_store_dwordx2 v[12:13], v10, s[12:15], 0 offen offset:96
    s_nop 0
    v_lshlrev_b32 v12, 16, v46
    v_and_b32 v13, 0xffff0000, v46
    v_lshlrev_b32 v14, 16, v47
    v_and_b32 v15, 0xffff0000, v47
    v_add_f32 v12, v12, v108
    v_add_f32 v13, v13, v109
    v_add_f32 v14, v14, v110
    v_add_f32 v15, v15, v111
    v_cvt_pk_bf16_f32 v12, v12, v13
    v_cvt_pk_bf16_f32 v13, v14, v15
    buffer_store_dwordx2 v[12:13], v10, s[12:15], 0 offen offset:112
    s_nop 0
G2_done:
    s_endpgm
.section .rodata,"a"
.p2align 6
.amdhsa_kernel ln_kernel
  .amdhsa_next_free_vgpr 32
  .amdhsa_next_free_sgpr 32
  .amdhsa_accum_offset 32
  .amdhsa_group_segment_fixed_size 0
  .amdhsa_kernarg_size 80
  .amdhsa_user_sgpr_count 2
  .amdhsa_user_sgpr_kernarg_segment_ptr 1
  .amdhsa_system_sgpr_workgroup_id_x 1
.end_amdhsa_kernel
.p2align 6
.amdhsa_kernel gemm1_kernel
  .amdhsa_next_free_vgpr 256
  .amdhsa_next_free_sgpr 48
  .amdhsa_accum_offset 256
  .amdhsa_group_segment_fixed_size 0
  .amdhsa_kernarg_size 80
  .amdhsa_user_sgpr_count 2
  .amdhsa_user_sgpr_kernarg_segment_ptr 1
  .amdhsa_system_sgpr_workgroup_id_x 1
.end_amdhsa_kernel
.p2align 6
.amdhsa_kernel attn_kernel
  .amdhsa_next_free_vgpr 128
  .amdhsa_next_free_sgpr 48
  .amdhsa_accum_offset 128
  .amdhsa_group_segment_fixed_size 0
  .amdhsa_kernarg_size 80
  .amdhsa_user_sgpr_count 2
  .amdhsa_user_sgpr_kernarg_segment_ptr 1
  .amdhsa_system_sgpr_workgroup_id_x 1
.end_amdhsa_kernel
.p2align 6
.amdhsa_kernel gemm2_kernel
  .amdhsa_next_free_vgpr 128
  .amdhsa_next_free_sgpr 56
  .amdhsa_accum_offset 128
  .amdhsa_group_segment_fixed_size 0
  .amdhsa_kernarg_size 80
  .amdhsa_user_sgpr_count 2
  .amdhsa_user_sgpr_kernarg_segment_ptr 1
  .amdhsa_system_sgpr_workgroup_id_x 1
.end_amdhsa_kernel
```
